```python
import torch

def _softmax(x, axis=-1):
    return torch.softmax(x, dim=axis)
def _gelu(x):
    return torch.nn.functional.gelu(x, approximate="tanh")
def _silu(x):
    return torch.nn.functional.silu(x)
def _sigmoid(x):
    return torch.sigmoid(x)
def _layernorm(x, axis=-1, eps=1e-5):
    m = x.mean(dim=axis, keepdim=True)
    v = x.var(dim=axis, keepdim=True, unbiased=False)
    return (x - m) / torch.sqrt(v + eps)
def _scatter_add(tgt, idx, src, axis=0):
    return tgt.clone().index_add_(axis, idx, src)
def _segment_sum(src, seg, n):
    out = torch.zeros((n,) + src.shape[1:], dtype=src.dtype)
    return out.index_add_(0, seg, src)
def _pad(x, pw):
    flat = tuple(v for pair in reversed(pw) for v in pair)
    return torch.nn.functional.pad(x, flat)

kernel_name = 'interleave_layers__sliding_block__mixer_token_mlp__prompt'

def setup_inputs():

    _w = (lambda a: (lambda t: t.to(torch.bfloat16) if t.is_floating_point() else t)(torch.as_tensor(a)))
    def _A_setup():
        B, S, D = 1, 2048, 448
        return {
            "x": _w((lambda *s: torch.randn(*s, dtype=torch.bfloat16) * 0.05)(B, S, D)),
            "wqkv": _w((lambda *s: torch.randn(*s, dtype=torch.bfloat16) * 0.05)(D, 3 * D)),
            "wo": _w((lambda *s: torch.randn(*s, dtype=torch.bfloat16) * 0.05)(D, D)),
        }
    _A_in = _A_setup()

    def _B_setup():
        B, S, D, F = 1, 2048, 448, 1792
        return {
            "x": _w((lambda *s: torch.randn(*s, dtype=torch.bfloat16) * 0.05)(B, S, D)),
            "w1": _w((lambda *s: torch.randn(*s, dtype=torch.bfloat16) * 1.6)(S, F) * (S ** -0.5)),
            "b1": _w((lambda *s: torch.randn(*s, dtype=torch.bfloat16) * 12.8)(F) * 0.02),
            "w2": _w((lambda *s: torch.randn(*s, dtype=torch.bfloat16) * 0.8)(F, S) * (F ** -0.5)),
            "b2": _w((lambda *s: torch.randn(*s, dtype=torch.bfloat16) * 12.8)(S) * 0.02),
        }
    _B_in = _B_setup()

    return {
        "A_x": _A_in["x"],
        "A_wqkv": _A_in["wqkv"],
        "A_wo": _A_in["wo"],
        "B_x": _B_in["x"],
        "B_w1": _B_in["w1"],
        "B_b1": _B_in["b1"],
        "B_w2": _B_in["w2"],
        "B_b2": _B_in["b2"],
    }

def reference(A_x, A_wqkv, A_wo, B_x, B_w1, B_b1, B_w2, B_b2):
    def _A_ref(x, wqkv, wo):
        B, S, D = x.shape
        H = 16; Dh = D // H; W = 256
        qkv = (lambda x, *d: x.permute(*d))((x @ wqkv).reshape(B, S, 3, H, Dh), 2, 0, 3, 1, 4)
        q, k, v = qkv[0], qkv[1], qkv[2]
        scores = torch.einsum("bhqd,bhkd->bhqk", q, k) * (Dh ** -0.5)
        idx = torch.arange(S)
        mask = (idx[:, None] - idx[None, :] >= 0) & (idx[:, None] - idx[None, :] < W)
        scores = torch.where(mask[None, None], scores, -1e9)
        p = _softmax(scores, axis=-1)
        o = torch.einsum("bhqk,bhkd->bhqd", p, v)
        return (lambda x, *d: x.permute(*d))(o, 0, 2, 1, 3).reshape(B, S, D) @ wo

    def _B_ref(x, w1, b1, w2, b2):
        B, S, D = x.shape
        h = _layernorm(x, axis=-1)
        u = torch.einsum("bsd,sf->bdf", h, w1) + b1
        u = _gelu(u)
        y = torch.einsum("bdf,fs->bds", u, w2) + b2
        return (lambda x, *d: x.permute(*d))(y, 0, 2, 1)

    x = A_x
    x = x + _A_ref(_layernorm(x, axis=-1), A_wqkv, A_wo)
    x = x + _B_ref(_layernorm(x, axis=-1), B_w1, B_b1, B_w2, B_b2)
    x = x + _A_ref(_layernorm(x, axis=-1), A_wqkv, A_wo)
    x = x + _B_ref(_layernorm(x, axis=-1), B_w1, B_b1, B_w2, B_b2)
    return x
```

```asm
; @launch grid=(256,1,1) block=(512,1,1) lds=163840
.amdgcn_target "amdgcn-amd-amdhsa--gfx950"
.text
.globl interleave_layers__sliding_block__mixer_token_mlp__prompt_kernel
.p2align 8
.type interleave_layers__sliding_block__mixer_token_mlp__prompt_kernel,@function
interleave_layers__sliding_block__mixer_token_mlp__prompt_kernel:
    s_cmp_ge_u32 s2, 256
    s_cbranch_scc1 L_interleave_layers__sliding_block__mixer_token_mlp__prompt_kernel_end
    s_nop 1
    s_load_dwordx2 s[4:5], s[0:1], 0
    s_load_dwordx2 s[8:9], s[0:1], 8
    s_load_dwordx2 s[60:61], s[0:1], 72
    s_load_dwordx2 s[20:21], s[0:1], 80
    v_and_b32 v1, 63, v0
    v_lshrrev_b32 v2, 6, v0
    s_nop 0
    v_readfirstlane_b32 s22, v2
    s_lshr_b32 s23, s2, 4
    s_and_b32 s24, s2, 15
    s_and_b32 s47, s22, 3
    s_lshr_b32 s48, s22, 2
    s_lshl_b32 s25, s23, 7
    s_lshl_b32 s26, s47, 5
    s_add_u32 s49, s25, s26
    v_lshrrev_b32 v16, 3, v1
    v_lshrrev_b32 v17, 4, v1
    v_and_b32 v18, 7, v1
    s_lshl_b32 s26, s48, 4
    s_add_u32 s25, s49, s26
    s_mul_i32 s25, s25, 896
    v_mul_u32_u24 v16, 896, v16
    v_xor_b32 v19, v18, v17
    v_lshl_add_u32 v2, v19, 4, v16
    v_xor_b32 v19, 4, v19
    v_lshl_add_u32 v3, v19, 4, v16
    v_add_u32 v2, s25, v2
    v_add_u32 v3, s25, v3
    v_add_u32 v3, 6144, v3
    s_lshl_b32 s26, s22, 3
    s_mul_i32 s26, s26, 2688
    s_mul_i32 s27, s24, 56
    s_add_u32 s26, s26, s27
    v_add_u32 v16, 0, v1
    s_mov_b32 s27, 87382
    v_mul_lo_u32 v17, v16, s27
    v_lshrrev_b32 v17, 20, v17
    v_mul_u32_u24 v18, 12, v17
    v_sub_u32 v18, v16, v18
    v_mul_u32_u24 v17, 2688, v17
    v_lshrrev_b32 v19, 2, v18
    v_mul_u32_u24 v19, 896, v19
    v_and_b32 v18, 3, v18
    v_lshl_add_u32 v17, v18, 4, v17
    v_add_u32 v17, v17, v19
    v_add_u32 v4, s26, v17
    v_add_u32 v16, 64, v1
    s_mov_b32 s27, 87382
    v_mul_lo_u32 v17, v16, s27
    v_lshrrev_b32 v17, 20, v17
    v_mul_u32_u24 v18, 12, v17
    v_sub_u32 v18, v16, v18
    v_mul_u32_u24 v17, 2688, v17
    v_lshrrev_b32 v19, 2, v18
    v_mul_u32_u24 v19, 896, v19
    v_and_b32 v18, 3, v18
    v_lshl_add_u32 v17, v18, 4, v17
    v_add_u32 v17, v17, v19
    v_add_u32 v5, s26, v17
    v_subrev_u32 v5, 1024, v5
    s_waitcnt lgkmcnt(0)
    s_and_b32 s5, s5, 0xffff
    s_mov_b32 s6, 0x1c0000
    s_mov_b32 s7, 0x00020000
    s_and_b32 s9, s9, 0xffff
    s_mov_b32 s10, 0x126000
    s_mov_b32 s11, 0x00020000
    s_mov_b32 s12, s20
    s_and_b32 s13, s21, 0xffff
    s_mov_b32 s14, 0x4000000
    s_mov_b32 s15, 0x00020000
    s_lshl_b32 s28, s47, 12
    s_lshl_b32 s29, s48, 11
    s_add_u32 s28, s28, s29
    s_mul_i32 s29, s22, 1536
    s_add_u32 s29, s29, 16384
    s_add_u32 s35, s23, s24
    s_mul_i32 s34, s35, 9363
    s_lshr_b32 s34, s34, 16
    s_mul_i32 s34, s34, 7
    s_sub_u32 s34, s35, s34
    s_add_u32 s52, s34, 0
    s_cmp_ge_u32 s52, 7
    s_cselect_b32 s35, 7, 0
    s_sub_u32 s52, s52, s35
    s_add_u32 s53, s34, 1
    s_cmp_ge_u32 s53, 7
    s_cselect_b32 s35, 7, 0
    s_sub_u32 s53, s53, s35
    s_add_u32 s54, s34, 2
    s_cmp_ge_u32 s54, 7
    s_cselect_b32 s35, 7, 0
    s_sub_u32 s54, s54, s35
    s_add_u32 s55, s34, 3
    s_cmp_ge_u32 s55, 7
    s_cselect_b32 s35, 7, 0
    s_sub_u32 s55, s55, s35
    s_add_u32 s56, s34, 4
    s_cmp_ge_u32 s56, 7
    s_cselect_b32 s35, 7, 0
    s_sub_u32 s56, s56, s35
    s_add_u32 s57, s34, 5
    s_cmp_ge_u32 s57, 7
    s_cselect_b32 s35, 7, 0
    s_sub_u32 s57, s57, s35
    s_add_u32 s58, s34, 6
    s_cmp_ge_u32 s58, 7
    s_cselect_b32 s35, 7, 0
    s_sub_u32 s58, s58, s35
    s_add_u32 m0, s28, 0
    s_lshl_b32 s30, s52, 7
    buffer_load_dwordx4 v2, s[4:7], s30 offen sc1 lds
    buffer_load_dwordx4 v3, s[4:7], s30 offen offset:1024 sc1 lds
    s_add_u32 m0, s29, 0
    s_mul_i32 s31, s52, 172032
    buffer_load_dwordx4 v4, s[8:11], s31 offen sc1 lds
    s_mov_b64 exec, 0xffffffff
    buffer_load_dwordx4 v5, s[8:11], s31 offen offset:1024 sc1 lds
    s_mov_b64 exec, -1
    s_barrier
    s_lshl_b32 s32, s2, 13
    s_add_u32 s32, s32, 0x1000000
    s_cmp_lt_u32 s2, 8
    s_cselect_b32 s32, s32, 0x7fff0000
    v_lshlrev_b32 v16, 4, v0
    v_mov_b32 v12, 0
    v_mov_b32 v13, 0
    v_mov_b32 v14, 0
    v_mov_b32 v15, 0
    buffer_store_dwordx4 v[12:15], v16, s[12:15], s32 offen sc0 sc1
    s_add_u32 m0, s28, 28672
    s_lshl_b32 s30, s53, 7
    buffer_load_dwordx4 v2, s[4:7], s30 offen sc1 lds
    buffer_load_dwordx4 v3, s[4:7], s30 offen offset:1024 sc1 lds
    s_add_u32 m0, s29, 28672
    s_mul_i32 s31, s53, 172032
    buffer_load_dwordx4 v4, s[8:11], s31 offen sc1 lds
    s_mov_b64 exec, 0xffffffff
    buffer_load_dwordx4 v5, s[8:11], s31 offen offset:1024 sc1 lds
    s_mov_b64 exec, -1
    s_add_u32 m0, s28, 57344
    s_lshl_b32 s30, s54, 7
    buffer_load_dwordx4 v2, s[4:7], s30 offen sc1 lds
    buffer_load_dwordx4 v3, s[4:7], s30 offen offset:1024 sc1 lds
    s_add_u32 m0, s29, 57344
    s_mul_i32 s31, s54, 172032
    buffer_load_dwordx4 v4, s[8:11], s31 offen sc1 lds
    s_mov_b64 exec, 0xffffffff
    buffer_load_dwordx4 v5, s[8:11], s31 offen offset:1024 sc1 lds
    s_mov_b64 exec, -1
    v_and_b32 v16, 31, v1
    v_lshrrev_b32 v17, 5, v1
    v_bfe_u32 v18, v1, 1, 3
    v_xor_b32 v18, v18, v17
    v_lshlrev_b32 v19, 7, v16
    s_lshl_b32 s32, s47, 12
    v_add_u32 v19, s32, v19
    v_xor_b32 v20, 0, v18
    v_lshl_add_u32 v100, v20, 4, v19
    v_xor_b32 v20, 2, v18
    v_lshl_add_u32 v101, v20, 4, v19
    v_xor_b32 v20, 4, v18
    v_lshl_add_u32 v102, v20, 4, v19
    v_xor_b32 v20, 6, v18
    v_lshl_add_u32 v103, v20, 4, v19
    v_bfe_u32 v18, v1, 2, 2
    v_bfe_u32 v19, v1, 4, 1
    v_and_b32 v20, 3, v1
    v_lshlrev_b32 v22, 5, v19
    v_lshl_add_u32 v22, v20, 3, v22
    v_lshl_add_u32 v21, v17, 3, v18
    v_mul_u32_u24 v21, 192, v21
    v_add_u32 v21, v21, v22
    s_lshl_b32 s34, s48, 7
    s_add_u32 s34, s34, 16384
    v_add_u32 v21, s34, v21
    s_min_u32 s35, s47, 2
    s_lshl_b32 s35, s35, 6
    s_sub_u32 s35, s35, 128
    v_add_u32 v22, s35, v21
    v_mul_u32_u24 v24, 192, v1
    v_add_u32 v24, s29, v24
    v_add_u32 v24, 56, v24
    v_mov_b32 v26, 0x3f80
    v_mov_b32 v27, 0
    v_mov_b32 v28, 0x3f803f80
    v_mov_b32 v36, 0
    v_mov_b32 v29, 0x3f803f80
    v_mov_b32 v37, 0
    v_mov_b32 v30, 0x3f803f80
    v_mov_b32 v38, 0
    v_mov_b32 v31, 0x3f803f80
    v_mov_b32 v39, 0
    v_lshlrev_b32 v33, 4, v1
    v_add_u32 v34, s29, v33
    s_mul_i32 s50, s24, 86016
    s_mul_i32 s51, s22, 1536
    s_add_u32 s50, s50, s51
    s_add_u32 s50, s50, 0x1200000
    s_cmp_eq_u32 s48, 0
    s_cbranch_scc0 L_pk1a_t1
    v_add_u32 v104, 0, v100
    v_add_u32 v105, 0, v101
    v_add_u32 v106, 0, v102
    v_add_u32 v107, 0, v103
    v_add_u32 v108, 0, v21
    v_add_u32 v109, 0, v22
    s_waitcnt vmcnt(9)
    v_add_u32 v49, 0, v24
    v_add_u32 v35, 0, v34
    ds_read_b128 v[152:155], v35
    ds_read_b128 v[156:159], v35 offset:1024
    s_mul_i32 s51, s52, 12288
    s_add_u32 s51, s51, s50
    s_cmp_lt_u32 s23, 7
    s_cselect_b32 s51, s51, 0x7fff0000
    s_waitcnt lgkmcnt(1)
    buffer_store_dwordx4 v[152:155], v33, s[12:15], s51 offen sc0 sc1
    s_mov_b64 exec, 0xffffffff
    s_waitcnt lgkmcnt(0)
    buffer_store_dwordx4 v[156:159], v33, s[12:15], s51 offen offset:1024 sc0 sc1
    s_mov_b64 exec, 0xff
    ds_write_b64 v49, v[26:27]
    s_mov_b64 exec, -1
    s_waitcnt lgkmcnt(0)
    s_barrier
    ds_read_b128 v[64:67], v104
    ds_read_b64_tr_b16 v[76:77], v108 offset:0
    ds_read_b64_tr_b16 v[78:79], v108 offset:768
    ds_read_b64_tr_b16 v[80:81], v108 offset:64
    ds_read_b64_tr_b16 v[82:83], v108 offset:832
    ds_read_b128 v[68:71], v105
    ds_read_b64_tr_b16 v[84:85], v108 offset:3072
    ds_read_b64_tr_b16 v[86:87], v108 offset:3840
    ds_read_b64_tr_b16 v[88:89], v108 offset:3136
    ds_read_b64_tr_b16 v[90:91], v108 offset:3904
    s_waitcnt lgkmcnt(7)
    v_mfma_f32_32x32x16_bf16 a[0:15], v[76:79], v[64:67], 0
    ds_read_b128 v[72:75], v106
    ds_read_b64_tr_b16 v[92:93], v108 offset:6144
    s_waitcnt lgkmcnt(7)
    v_mfma_f32_32x32x16_bf16 a[16:31], v[80:83], v[64:67], 0
    ds_read_b64_tr_b16 v[94:95], v108 offset:6912
    ds_read_b64_tr_b16 v[96:97], v108 offset:6208
    ds_read_b64_tr_b16 v[98:99], v108 offset:6976
    s_waitcnt lgkmcnt(7)
    v_mfma_f32_32x32x16_bf16 a[0:15], v[84:87], v[68:71], a[0:15]
    ds_read_b128 v[64:67], v107
    ds_read_b64_tr_b16 v[76:77], v108 offset:9216
    s_waitcnt lgkmcnt(7)
    v_mfma_f32_32x32x16_bf16 a[16:31], v[88:91], v[68:71], a[16:31]
    ds_read_b64_tr_b16 v[78:79], v108 offset:9984
    ds_read_b64_tr_b16 v[80:81], v108 offset:9280
    ds_read_b64_tr_b16 v[82:83], v108 offset:10048
    s_waitcnt lgkmcnt(7)
    v_mfma_f32_32x32x16_bf16 a[0:15], v[92:95], v[72:75], a[0:15]
    v_add_u32 v110, 28672, v100
    v_add_u32 v111, 28672, v101
    v_add_u32 v112, 28672, v102
    v_add_u32 v113, 28672, v103
    v_add_u32 v114, 28672, v21
    v_add_u32 v115, 28672, v22
    s_waitcnt vmcnt(6)
    v_add_u32 v49, 28672, v24
    s_mov_b64 exec, 0xff
    ds_write_b64 v49, v[26:27]
    s_mov_b64 exec, -1
    s_waitcnt lgkmcnt(0)
    s_barrier
    s_and_b32 s61, s61, 0xffff
    s_mov_b32 s62, 0x100
    s_mov_b32 s63, 0x00020000
    s_cmp_ge_u32 s2, 8
    s_cbranch_scc1 L_nz1
    v_mov_b32 v10, 0
    v_mov_b32 v11, 1
    v_cmp_eq_u32 vcc, 0, v0
    s_and_saveexec_b64 s[44:45], vcc
    s_cbranch_execz L_nzb1
    buffer_atomic_add v11, v10, s[60:63], 0 offen sc1
L_nzb1:
    s_mov_b64 exec, -1
L_nz1:
    ds_read_b128 v[68:71], v110
    ds_read_b64_tr_b16 v[84:85], v114 offset:0
    v_mfma_f32_32x32x16_bf16 a[16:31], v[96:99], v[72:75], a[16:31]
    ds_read_b64_tr_b16 v[86:87], v114 offset:768
    ds_read_b64_tr_b16 v[88:89], v114 offset:64
    ds_read_b64_tr_b16 v[90:91], v114 offset:832
    v_mfma_f32_32x32x16_bf16 a[0:15], v[76:79], v[64:67], a[0:15]
    ds_read_b128 v[72:75], v111
    ds_read_b64_tr_b16 v[92:93], v114 offset:3072
    ds_read_b64_tr_b16 v[94:95], v114 offset:3840
    v_mfma_f32_32x32x16_bf16 a[16:31], v[80:83], v[64:67], a[16:31]
    ds_read_b64_tr_b16 v[96:97], v114 offset:3136
    ds_read_b64_tr_b16 v[98:99], v114 offset:3904
    s_add_u32 m0, s29, 86016
    s_mul_i32 s31, s55, 172032
    buffer_load_dwordx4 v4, s[8:11], s31 offen sc1 lds
    s_mov_b64 exec, 0xffffffff
    buffer_load_dwordx4 v5, s[8:11], s31 offen offset:1024 sc1 lds
    s_mov_b64 exec, -1
    s_add_u32 m0, s28, 86016
    s_lshl_b32 s30, s55, 7
    buffer_load_dwordx4 v2, s[4:7], s30 offen sc1 lds
    buffer_load_dwordx4 v3, s[4:7], s30 offen offset:1024 sc1 lds
    s_waitcnt lgkmcnt(7)
    v_mfma_f32_32x32x16_bf16 a[0:15], v[84:87], v[68:71], a[0:15]
    ds_read_b128 v[64:67], v112
    ds_read_b64_tr_b16 v[76:77], v114 offset:6144
    s_waitcnt lgkmcnt(7)
    v_mfma_f32_32x32x16_bf16 a[16:31], v[88:91], v[68:71], a[16:31]
    ds_read_b64_tr_b16 v[78:79], v114 offset:6912
    ds_read_b64_tr_b16 v[80:81], v114 offset:6208
    ds_read_b64_tr_b16 v[82:83], v114 offset:6976
    s_waitcnt lgkmcnt(7)
    v_mfma_f32_32x32x16_bf16 a[0:15], v[92:95], v[72:75], a[0:15]
    ds_read_b128 v[68:71], v113
    ds_read_b64_tr_b16 v[84:85], v114 offset:9216
    s_waitcnt lgkmcnt(7)
    v_mfma_f32_32x32x16_bf16 a[16:31], v[96:99], v[72:75], a[16:31]
    ds_read_b64_tr_b16 v[86:87], v114 offset:9984
    ds_read_b64_tr_b16 v[88:89], v114 offset:9280
    ds_read_b64_tr_b16 v[90:91], v114 offset:10048
    s_waitcnt lgkmcnt(7)
    v_mfma_f32_32x32x16_bf16 a[0:15], v[76:79], v[64:67], a[0:15]
    v_add_u32 v104, 57344, v100
    v_add_u32 v105, 57344, v101
    v_add_u32 v106, 57344, v102
    v_add_u32 v107, 57344, v103
    v_add_u32 v108, 57344, v21
    v_add_u32 v109, 57344, v22
    s_waitcnt vmcnt(6)
    v_add_u32 v49, 57344, v24
    s_mov_b64 exec, 0xff
    ds_write_b64 v49, v[26:27]
    s_mov_b64 exec, -1
    s_waitcnt lgkmcnt(0)
    s_barrier
    ds_read_b128 v[72:75], v104
    ds_read_b64_tr_b16 v[92:93], v108 offset:0
    v_mfma_f32_32x32x16_bf16 a[16:31], v[80:83], v[64:67], a[16:31]
    ds_read_b64_tr_b16 v[94:95], v108 offset:768
    ds_read_b64_tr_b16 v[96:97], v108 offset:64
    ds_read_b64_tr_b16 v[98:99], v108 offset:832
    v_mfma_f32_32x32x16_bf16 a[0:15], v[84:87], v[68:71], a[0:15]
    ds_read_b128 v[64:67], v105
    ds_read_b64_tr_b16 v[76:77], v108 offset:3072
    ds_read_b64_tr_b16 v[78:79], v108 offset:3840
    v_mfma_f32_32x32x16_bf16 a[16:31], v[88:91], v[68:71], a[16:31]
    ds_read_b64_tr_b16 v[80:81], v108 offset:3136
    ds_read_b64_tr_b16 v[82:83], v108 offset:3904
    s_add_u32 m0, s29, 114688
    s_mul_i32 s31, s56, 172032
    buffer_load_dwordx4 v4, s[8:11], s31 offen sc1 lds
    s_mov_b64 exec, 0xffffffff
    buffer_load_dwordx4 v5, s[8:11], s31 offen offset:1024 sc1 lds
    s_mov_b64 exec, -1
    s_add_u32 m0, s28, 114688
    s_lshl_b32 s30, s56, 7
    buffer_load_dwordx4 v2, s[4:7], s30 offen sc1 lds
    buffer_load_dwordx4 v3, s[4:7], s30 offen offset:1024 sc1 lds
    s_waitcnt lgkmcnt(7)
    v_mfma_f32_32x32x16_bf16 a[0:15], v[92:95], v[72:75], a[0:15]
    ds_read_b128 v[68:71], v106
    ds_read_b64_tr_b16 v[84:85], v108 offset:6144
    s_waitcnt lgkmcnt(7)
    v_mfma_f32_32x32x16_bf16 a[16:31], v[96:99], v[72:75], a[16:31]
    ds_read_b64_tr_b16 v[86:87], v108 offset:6912
    ds_read_b64_tr_b16 v[88:89], v108 offset:6208
    ds_read_b64_tr_b16 v[90:91], v108 offset:6976
    s_waitcnt lgkmcnt(7)
    v_mfma_f32_32x32x16_bf16 a[0:15], v[76:79], v[64:67], a[0:15]
    ds_read_b128 v[72:75], v107
    ds_read_b64_tr_b16 v[92:93], v108 offset:9216
    s_waitcnt lgkmcnt(7)
    v_mfma_f32_32x32x16_bf16 a[16:31], v[80:83], v[64:67], a[16:31]
    ds_read_b64_tr_b16 v[94:95], v108 offset:9984
    ds_read_b64_tr_b16 v[96:97], v108 offset:9280
    ds_read_b64_tr_b16 v[98:99], v108 offset:10048
    s_waitcnt lgkmcnt(7)
    v_mfma_f32_32x32x16_bf16 a[0:15], v[84:87], v[68:71], a[0:15]
    v_add_u32 v110, 86016, v100
    v_add_u32 v111, 86016, v101
    v_add_u32 v112, 86016, v102
    v_add_u32 v113, 86016, v103
    v_add_u32 v114, 86016, v21
    v_add_u32 v115, 86016, v22
    s_waitcnt vmcnt(4)
    v_add_u32 v49, 86016, v24
    s_mov_b64 exec, 0xff
    ds_write_b64 v49, v[26:27]
    s_mov_b64 exec, -1
    s_waitcnt lgkmcnt(0)
    s_barrier
    ds_read_b128 v[64:67], v110
    ds_read_b64_tr_b16 v[76:77], v114 offset:0
    v_mfma_f32_32x32x16_bf16 a[16:31], v[88:91], v[68:71], a[16:31]
    ds_read_b64_tr_b16 v[78:79], v114 offset:768
    ds_read_b64_tr_b16 v[80:81], v114 offset:64
    ds_read_b64_tr_b16 v[82:83], v114 offset:832
    v_mfma_f32_32x32x16_bf16 a[0:15], v[92:95], v[72:75], a[0:15]
    ds_read_b128 v[68:71], v111
    ds_read_b64_tr_b16 v[84:85], v114 offset:3072
    ds_read_b64_tr_b16 v[86:87], v114 offset:3840
    v_mfma_f32_32x32x16_bf16 a[16:31], v[96:99], v[72:75], a[16:31]
    ds_read_b64_tr_b16 v[88:89], v114 offset:3136
    ds_read_b64_tr_b16 v[90:91], v114 offset:3904
    s_add_u32 m0, s29, 0
    s_mul_i32 s31, s57, 172032
    buffer_load_dwordx4 v4, s[8:11], s31 offen sc1 lds
    s_mov_b64 exec, 0xffffffff
    buffer_load_dwordx4 v5, s[8:11], s31 offen offset:1024 sc1 lds
    s_mov_b64 exec, -1
    s_add_u32 m0, s28, 0
    s_lshl_b32 s30, s57, 7
    buffer_load_dwordx4 v2, s[4:7], s30 offen sc1 lds
    buffer_load_dwordx4 v3, s[4:7], s30 offen offset:1024 sc1 lds
    s_waitcnt lgkmcnt(7)
    v_mfma_f32_32x32x16_bf16 a[0:15], v[76:79], v[64:67], a[0:15]
    ds_read_b128 v[72:75], v112
    ds_read_b64_tr_b16 v[92:93], v114 offset:6144
    s_waitcnt lgkmcnt(7)
    v_mfma_f32_32x32x16_bf16 a[16:31], v[80:83], v[64:67], a[16:31]
    ds_read_b64_tr_b16 v[94:95], v114 offset:6912
    ds_read_b64_tr_b16 v[96:97], v114 offset:6208
    ds_read_b64_tr_b16 v[98:99], v114 offset:6976
    s_waitcnt lgkmcnt(7)
    v_mfma_f32_32x32x16_bf16 a[0:15], v[84:87], v[68:71], a[0:15]
    ds_read_b128 v[64:67], v113
    ds_read_b64_tr_b16 v[76:77], v114 offset:9216
    s_waitcnt lgkmcnt(7)
    v_mfma_f32_32x32x16_bf16 a[16:31], v[88:91], v[68:71], a[16:31]
    ds_read_b64_tr_b16 v[78:79], v114 offset:9984
    ds_read_b64_tr_b16 v[80:81], v114 offset:9280
    ds_read_b64_tr_b16 v[82:83], v114 offset:10048
    s_waitcnt lgkmcnt(7)
    v_mfma_f32_32x32x16_bf16 a[0:15], v[92:95], v[72:75], a[0:15]
    v_add_u32 v104, 114688, v100
    v_add_u32 v105, 114688, v101
    v_add_u32 v106, 114688, v102
    v_add_u32 v107, 114688, v103
    v_add_u32 v108, 114688, v21
    v_add_u32 v109, 114688, v22
    s_waitcnt vmcnt(4)
    v_add_u32 v49, 114688, v24
    s_mov_b64 exec, 0xff
    ds_write_b64 v49, v[26:27]
    s_mov_b64 exec, -1
    s_waitcnt lgkmcnt(0)
    s_barrier
    ds_read_b128 v[68:71], v104
    ds_read_b64_tr_b16 v[84:85], v108 offset:0
    v_mfma_f32_32x32x16_bf16 a[16:31], v[96:99], v[72:75], a[16:31]
    ds_read_b64_tr_b16 v[86:87], v108 offset:768
    ds_read_b64_tr_b16 v[88:89], v108 offset:64
    ds_read_b64_tr_b16 v[90:91], v108 offset:832
    v_mfma_f32_32x32x16_bf16 a[0:15], v[76:79], v[64:67], a[0:15]
    ds_read_b128 v[72:75], v105
    ds_read_b64_tr_b16 v[92:93], v108 offset:3072
    ds_read_b64_tr_b16 v[94:95], v108 offset:3840
    v_mfma_f32_32x32x16_bf16 a[16:31], v[80:83], v[64:67], a[16:31]
    ds_read_b64_tr_b16 v[96:97], v108 offset:3136
    ds_read_b64_tr_b16 v[98:99], v108 offset:3904
    s_add_u32 m0, s29, 28672
    s_mul_i32 s31, s58, 172032
    buffer_load_dwordx4 v4, s[8:11], s31 offen sc1 lds
    s_mov_b64 exec, 0xffffffff
    buffer_load_dwordx4 v5, s[8:11], s31 offen offset:1024 sc1 lds
    s_mov_b64 exec, -1
    s_add_u32 m0, s28, 28672
    s_lshl_b32 s30, s58, 7
    buffer_load_dwordx4 v2, s[4:7], s30 offen sc1 lds
    buffer_load_dwordx4 v3, s[4:7], s30 offen offset:1024 sc1 lds
    s_waitcnt lgkmcnt(7)
    v_mfma_f32_32x32x16_bf16 a[0:15], v[84:87], v[68:71], a[0:15]
    ds_read_b128 v[64:67], v106
    ds_read_b64_tr_b16 v[76:77], v108 offset:6144
    s_waitcnt lgkmcnt(7)
    v_mfma_f32_32x32x16_bf16 a[16:31], v[88:91], v[68:71], a[16:31]
    ds_read_b64_tr_b16 v[78:79], v108 offset:6912
    ds_read_b64_tr_b16 v[80:81], v108 offset:6208
    ds_read_b64_tr_b16 v[82:83], v108 offset:6976
    s_waitcnt lgkmcnt(7)
    v_mfma_f32_32x32x16_bf16 a[0:15], v[92:95], v[72:75], a[0:15]
    ds_read_b128 v[68:71], v107
    ds_read_b64_tr_b16 v[84:85], v108 offset:9216
    s_waitcnt lgkmcnt(7)
    v_mfma_f32_32x32x16_bf16 a[16:31], v[96:99], v[72:75], a[16:31]
    ds_read_b64_tr_b16 v[86:87], v108 offset:9984
    ds_read_b64_tr_b16 v[88:89], v108 offset:9280
    ds_read_b64_tr_b16 v[90:91], v108 offset:10048
    s_waitcnt lgkmcnt(7)
    v_mfma_f32_32x32x16_bf16 a[0:15], v[76:79], v[64:67], a[0:15]
    v_add_u32 v110, 0, v100
    v_add_u32 v111, 0, v101
    v_add_u32 v112, 0, v102
    v_add_u32 v113, 0, v103
    v_add_u32 v114, 0, v21
    v_add_u32 v115, 0, v22
    s_waitcnt vmcnt(4)
    v_add_u32 v49, 0, v24
    s_mov_b64 exec, 0xff
    ds_write_b64 v49, v[26:27]
    s_mov_b64 exec, -1
    s_waitcnt lgkmcnt(0)
    s_barrier
    ds_read_b128 v[72:75], v110
    ds_read_b64_tr_b16 v[92:93], v114 offset:0
    v_mfma_f32_32x32x16_bf16 a[16:31], v[80:83], v[64:67], a[16:31]
    ds_read_b64_tr_b16 v[94:95], v114 offset:768
    ds_read_b64_tr_b16 v[96:97], v114 offset:64
    ds_read_b64_tr_b16 v[98:99], v114 offset:832
    v_mfma_f32_32x32x16_bf16 a[0:15], v[84:87], v[68:71], a[0:15]
    ds_read_b128 v[64:67], v111
    ds_read_b64_tr_b16 v[76:77], v114 offset:3072
    v_mfma_f32_32x32x16_bf16 a[16:31], v[88:91], v[68:71], a[16:31]
    ds_read_b64_tr_b16 v[78:79], v114 offset:3840
    ds_read_b64_tr_b16 v[80:81], v114 offset:3136
    ds_read_b64_tr_b16 v[82:83], v114 offset:3904
    s_waitcnt lgkmcnt(7)
    v_mfma_f32_32x32x16_bf16 a[0:15], v[92:95], v[72:75], a[0:15]
    ds_read_b128 v[68:71], v112
    ds_read_b64_tr_b16 v[84:85], v114 offset:6144
    s_waitcnt lgkmcnt(7)
    v_mfma_f32_32x32x16_bf16 a[16:31], v[96:99], v[72:75], a[16:31]
    ds_read_b64_tr_b16 v[86:87], v114 offset:6912
    ds_read_b64_tr_b16 v[88:89], v114 offset:6208
    ds_read_b64_tr_b16 v[90:91], v114 offset:6976
    s_waitcnt lgkmcnt(7)
    v_mfma_f32_32x32x16_bf16 a[0:15], v[76:79], v[64:67], a[0:15]
    ds_read_b128 v[72:75], v113
    ds_read_b64_tr_b16 v[92:93], v114 offset:9216
    s_waitcnt lgkmcnt(7)
    v_mfma_f32_32x32x16_bf16 a[16:31], v[80:83], v[64:67], a[16:31]
    ds_read_b64_tr_b16 v[94:95], v114 offset:9984
    ds_read_b64_tr_b16 v[96:97], v114 offset:9280
    ds_read_b64_tr_b16 v[98:99], v114 offset:10048
    s_waitcnt lgkmcnt(7)
    v_mfma_f32_32x32x16_bf16 a[0:15], v[84:87], v[68:71], a[0:15]
    v_add_u32 v104, 28672, v100
    v_add_u32 v105, 28672, v101
    v_add_u32 v106, 28672, v102
    v_add_u32 v107, 28672, v103
    v_add_u32 v108, 28672, v21
    v_add_u32 v109, 28672, v22
    s_waitcnt vmcnt(0)
    v_add_u32 v49, 28672, v24
    s_mov_b64 exec, 0xff
    ds_write_b64 v49, v[26:27]
    s_mov_b64 exec, -1
    s_waitcnt lgkmcnt(0)
    s_barrier
    ds_read_b128 v[64:67], v104
    ds_read_b64_tr_b16 v[76:77], v108 offset:0
    v_mfma_f32_32x32x16_bf16 a[16:31], v[88:91], v[68:71], a[16:31]
    ds_read_b64_tr_b16 v[78:79], v108 offset:768
    ds_read_b64_tr_b16 v[80:81], v108 offset:64
    ds_read_b64_tr_b16 v[82:83], v108 offset:832
    v_mfma_f32_32x32x16_bf16 a[0:15], v[92:95], v[72:75], a[0:15]
    ds_read_b128 v[68:71], v105
    ds_read_b64_tr_b16 v[84:85], v108 offset:3072
    v_mfma_f32_32x32x16_bf16 a[16:31], v[96:99], v[72:75], a[16:31]
    ds_read_b64_tr_b16 v[86:87], v108 offset:3840
    ds_read_b64_tr_b16 v[88:89], v108 offset:3136
    ds_read_b64_tr_b16 v[90:91], v108 offset:3904
    s_waitcnt lgkmcnt(7)
    v_mfma_f32_32x32x16_bf16 a[0:15], v[76:79], v[64:67], a[0:15]
    ds_read_b128 v[72:75], v106
    ds_read_b64_tr_b16 v[92:93], v108 offset:6144
    s_waitcnt lgkmcnt(7)
    v_mfma_f32_32x32x16_bf16 a[16:31], v[80:83], v[64:67], a[16:31]
    ds_read_b64_tr_b16 v[94:95], v108 offset:6912
    ds_read_b64_tr_b16 v[96:97], v108 offset:6208
    ds_read_b64_tr_b16 v[98:99], v108 offset:6976
    s_waitcnt lgkmcnt(7)
    v_mfma_f32_32x32x16_bf16 a[0:15], v[84:87], v[68:71], a[0:15]
    ds_read_b128 v[64:67], v107
    ds_read_b64_tr_b16 v[76:77], v108 offset:9216
    s_waitcnt lgkmcnt(7)
    v_mfma_f32_32x32x16_bf16 a[16:31], v[88:91], v[68:71], a[16:31]
    ds_read_b64_tr_b16 v[78:79], v108 offset:9984
    ds_read_b64_tr_b16 v[80:81], v108 offset:9280
    ds_read_b64_tr_b16 v[82:83], v108 offset:10048
    s_waitcnt lgkmcnt(7)
    v_mfma_f32_32x32x16_bf16 a[0:15], v[92:95], v[72:75], a[0:15]
    s_waitcnt lgkmcnt(5)
    v_mfma_f32_32x32x16_bf16 a[16:31], v[96:99], v[72:75], a[16:31]
    s_waitcnt lgkmcnt(2)
    v_mfma_f32_32x32x16_bf16 a[0:15], v[76:79], v[64:67], a[0:15]
    s_waitcnt lgkmcnt(0)
    v_mfma_f32_32x32x16_bf16 a[16:31], v[80:83], v[64:67], a[16:31]
    s_lshl_b32 s36, s24, 6
    s_lshl_b32 s37, s23, 2
    s_add_u32 s36, s36, s37
    s_add_u32 s36, s36, s47
    s_lshl_b32 s36, s36, 11
    v_lshlrev_b32 v59, 4, v1
    v_add_u32 v59, s36, v59
    v_mov_b32 v10, 0
    s_mov_b64 exec, 0x1
    buffer_load_dword v116, v10, s[60:63], 0 offen sc0 sc1
    s_mov_b64 exec, -1
    v_and_b32 v47, 31, v1
    v_lshlrev_b32 v47, 2, v47
    s_lshl_b32 s35, s47, 8
    s_add_u32 s35, s35, 146432
    v_add_u32 v46, s35, v47
    v_accvgpr_read_b32 v52, a12
    v_mov_b32 v57, v52
    s_nop 1
    v_permlane32_swap_b32 v57, v52
    s_mov_b64 exec, 0xffffffff
    ds_write_b32 v46, v52
    s_mov_b64 exec, -1
    s_waitcnt lgkmcnt(0)
    s_barrier
    ds_read_b32 v48, v46 offset:128
    v_lshlrev_b32 v54, 4, v17
    v_add_u32 v55, 143360, v54
    ds_read_b128 v[120:123], v55 offset:0
    ds_read_b128 v[124:127], v55 offset:32
    ds_read_b128 v[128:131], v55 offset:64
    ds_read_b128 v[132:135], v55 offset:96
    ds_read_b128 v[136:139], v55 offset:128
    ds_read_b128 v[140:143], v55 offset:160
    ds_read_b128 v[144:147], v55 offset:192
    ds_read_b128 v[148:151], v55 offset:224
    v_mul_f32 v52, 0x3b124925, v52
    s_waitcnt lgkmcnt(8)
    v_mul_f32 v48, 0x3b124925, v48
    v_fma_f32 v48, -v52, v52, v48
    v_max_f32 v48, 0, v48
    v_add_f32 v48, 0x3727c5ac, v48
    v_rsq_f32 v48, v48
    s_nop 0
    v_mul_f32 v52, -v52, v48
    v_mul_f32 v50, 0x3e8b97f6, v48
    v_mul_f32 v51, 0x3e8b97f6, v52
    s_waitcnt lgkmcnt(7)
    v_mul_f32 v120, v120, v51
    s_waitcnt lgkmcnt(3)
    v_mul_f32 v136, v136, v52
    v_mul_f32 v121, v121, v51
    v_mul_f32 v137, v137, v52
    v_mul_f32 v122, v122, v51
    v_mul_f32 v138, v138, v52
    v_mul_f32 v123, v123, v51
    v_mul_f32 v139, v139, v52
    v_mul_f32 v124, v124, v51
    s_waitcnt lgkmcnt(2)
    v_mul_f32 v140, v140, v52
    v_mul_f32 v125, v125, v51
    v_mul_f32 v141, v141, v52
    v_mul_f32 v126, v126, v51
    v_mul_f32 v142, v142, v52
    v_mul_f32 v127, v127, v51
    v_mul_f32 v143, v143, v52
    v_mul_f32 v128, v128, v51
    s_waitcnt lgkmcnt(1)
    v_mul_f32 v144, v144, v52
    v_mul_f32 v129, v129, v51
    v_mul_f32 v145, v145, v52
    v_mul_f32 v130, v130, v51
    v_mul_f32 v146, v146, v52
    v_mul_f32 v131, v131, v51
    v_mul_f32 v147, v147, v52
    v_mul_f32 v132, v132, v51
    s_waitcnt lgkmcnt(0)
    v_mul_f32 v148, v148, v52
    v_mul_f32 v133, v133, v51
    v_mul_f32 v149, v149, v52
    v_mul_f32 v134, v134, v51
    v_mul_f32 v150, v150, v52
    v_mul_f32 v135, v135, v51
    v_mul_f32 v151, v151, v52
    v_cmp_eq_u32 s[38:39], 0, v17
    v_accvgpr_read_b32 v64, a0
    v_accvgpr_read_b32 v65, a1
    v_accvgpr_read_b32 v66, a2
    v_accvgpr_read_b32 v67, a3
    v_accvgpr_read_b32 v68, a4
    v_accvgpr_read_b32 v69, a5
    v_accvgpr_read_b32 v70, a6
    v_accvgpr_read_b32 v71, a7
    v_accvgpr_read_b32 v72, a8
    v_accvgpr_read_b32 v73, a9
    v_accvgpr_read_b32 v74, a10
    v_accvgpr_read_b32 v75, a11
    v_accvgpr_read_b32 v76, a12
    v_accvgpr_read_b32 v77, a13
    v_accvgpr_read_b32 v78, a14
    v_accvgpr_read_b32 v79, a15
    v_fma_f32 v64, v64, v50, v120
    v_fma_f32 v65, v65, v50, v121
    v_fma_f32 v66, v66, v50, v122
    v_fma_f32 v67, v67, v50, v123
    v_fma_f32 v68, v68, v50, v124
    v_fma_f32 v69, v69, v50, v125
    v_fma_f32 v70, v70, v50, v126
    v_fma_f32 v71, v71, v50, v127
    v_fma_f32 v72, v72, v50, v128
    v_fma_f32 v73, v73, v50, v129
    v_fma_f32 v74, v74, v50, v130
    v_fma_f32 v75, v75, v50, v131
    v_fma_f32 v76, v76, v50, v132
    v_fma_f32 v77, v77, v50, v133
    v_fma_f32 v78, v78, v50, v134
    v_fma_f32 v79, v79, v50, v135
    v_cvt_pk_bf16_f32 v96, v64, v65
    v_cvt_pk_bf16_f32 v97, v66, v67
    v_cvt_pk_bf16_f32 v98, v68, v69
    v_cvt_pk_bf16_f32 v99, v70, v71
    v_cvt_pk_bf16_f32 v100, v72, v73
    v_cvt_pk_bf16_f32 v101, v74, v75
    v_cvt_pk_bf16_f32 v102, v76, v77
    v_cvt_pk_bf16_f32 v103, v78, v79
    v_mov_b32 v62, 0x3f80
    v_cndmask_b32 v102, v62, v102, s[38:39]
    v_cndmask_b32 v103, 0, v103, s[38:39]
    s_mov_b32 s40, 0x0
    buffer_store_dwordx4 v[96:99], v59, s[12:15], s40 offen sc0 sc1
    buffer_store_dwordx4 v[100:103], v59, s[12:15], s40 offen offset:1024 sc0 sc1
    v_accvgpr_read_b32 v64, a16
    v_accvgpr_read_b32 v65, a17
    v_accvgpr_read_b32 v66, a18
    v_accvgpr_read_b32 v67, a19
    v_accvgpr_read_b32 v68, a20
    v_accvgpr_read_b32 v69, a21
    v_accvgpr_read_b32 v70, a22
    v_accvgpr_read_b32 v71, a23
    v_accvgpr_read_b32 v72, a24
    v_accvgpr_read_b32 v73, a25
    v_accvgpr_read_b32 v74, a26
    v_accvgpr_read_b32 v75, a27
    v_accvgpr_read_b32 v76, a28
    v_accvgpr_read_b32 v77, a29
    v_accvgpr_read_b32 v78, a30
    v_accvgpr_read_b32 v79, a31
    v_fma_f32 v64, v64, v48, v136
    v_fma_f32 v65, v65, v48, v137
    v_fma_f32 v66, v66, v48, v138
    v_fma_f32 v67, v67, v48, v139
    v_fma_f32 v68, v68, v48, v140
    v_fma_f32 v69, v69, v48, v141
    v_fma_f32 v70, v70, v48, v142
    v_fma_f32 v71, v71, v48, v143
    v_fma_f32 v72, v72, v48, v144
    v_fma_f32 v73, v73, v48, v145
    v_fma_f32 v74, v74, v48, v146
    v_fma_f32 v75, v75, v48, v147
    v_fma_f32 v76, v76, v48, v148
    v_fma_f32 v77, v77, v48, v149
    v_fma_f32 v78, v78, v48, v150
    v_fma_f32 v79, v79, v48, v151
    v_cvt_pk_bf16_f32 v104, v64, v65
    v_cvt_pk_bf16_f32 v105, v66, v67
    v_cvt_pk_bf16_f32 v106, v68, v69
    v_cvt_pk_bf16_f32 v107, v70, v71
    v_cvt_pk_bf16_f32 v108, v72, v73
    v_cvt_pk_bf16_f32 v109, v74, v75
    v_cvt_pk_bf16_f32 v110, v76, v77
    v_cvt_pk_bf16_f32 v111, v78, v79
    v_cndmask_b32 v110, 0, v110, s[38:39]
    v_cndmask_b32 v111, 0, v111, s[38:39]
    s_mov_b32 s40, 0x200000
    buffer_store_dwordx4 v[104:107], v59, s[12:15], s40 offen sc0 sc1
    buffer_store_dwordx4 v[108:111], v59, s[12:15], s40 offen offset:1024 sc0 sc1
    s_branch L_pk1a_e2
L_pk1a_t1:
    s_nop 1
    v_add_u32 v104, 0, v100
    v_add_u32 v105, 0, v101
    v_add_u32 v106, 0, v102
    v_add_u32 v107, 0, v103
    v_add_u32 v108, 0, v21
    v_add_u32 v109, 0, v22
    s_waitcnt vmcnt(9)
    v_add_u32 v49, 0, v24
    v_add_u32 v35, 0, v34
    ds_read_b128 v[152:155], v35
    ds_read_b128 v[156:159], v35 offset:1024
    s_mul_i32 s51, s52, 12288
    s_add_u32 s51, s51, s50
    s_cmp_lt_u32 s23, 7
    s_cselect_b32 s51, s51, 0x7fff0000
    s_waitcnt lgkmcnt(1)
    buffer_store_dwordx4 v[152:155], v33, s[12:15], s51 offen sc0 sc1
    s_mov_b64 exec, 0xffffffff
    s_waitcnt lgkmcnt(0)
    buffer_store_dwordx4 v[156:159], v33, s[12:15], s51 offen offset:1024 sc0 sc1
    s_mov_b64 exec, 0xff
    ds_write_b64 v49, v[26:27]
    s_mov_b64 exec, -1
    s_waitcnt lgkmcnt(0)
    s_barrier
    ds_read_b128 v[64:67], v104
    ds_read_b64_tr_b16 v[76:77], v108 offset:0
    ds_read_b64_tr_b16 v[78:79], v108 offset:768
    ds_read_b64_tr_b16 v[80:81], v109 offset:0
    ds_read_b64_tr_b16 v[82:83], v109 offset:768
    ds_read_b128 v[68:71], v105
    ds_read_b64_tr_b16 v[84:85], v108 offset:3072
    ds_read_b64_tr_b16 v[86:87], v108 offset:3840
    ds_read_b64_tr_b16 v[88:89], v109 offset:3072
    ds_read_b64_tr_b16 v[90:91], v109 offset:3840
    s_waitcnt lgkmcnt(7)
    v_mfma_f32_32x32x16_bf16 a[0:15], v[64:67], v[76:79], 0
    ds_read_b128 v[72:75], v106
    ds_read_b64_tr_b16 v[92:93], v108 offset:6144
    ds_read_b64_tr_b16 v[94:95], v108 offset:6912
    ds_read_b64_tr_b16 v[96:97], v109 offset:6144
    s_waitcnt lgkmcnt(9)
    v_mfma_f32_32x32x16_bf16 a[16:31], v[28:31], v[80:83], 0
    ds_read_b64_tr_b16 v[98:99], v109 offset:6912
    v_dot2_f32_bf16 v36, v64, v64, v36
    v_dot2_f32_bf16 v37, v65, v65, v37
    v_dot2_f32_bf16 v38, v66, v66, v38
    v_dot2_f32_bf16 v39, v67, v67, v39
    s_waitcnt lgkmcnt(7)
    v_mfma_f32_32x32x16_bf16 a[0:15], v[68:71], v[84:87], a[0:15]
    ds_read_b128 v[64:67], v107
    ds_read_b64_tr_b16 v[76:77], v108 offset:9216
    ds_read_b64_tr_b16 v[78:79], v108 offset:9984
    ds_read_b64_tr_b16 v[80:81], v109 offset:9216
    s_waitcnt lgkmcnt(9)
    v_mfma_f32_32x32x16_bf16 a[16:31], v[28:31], v[88:91], a[16:31]
    ds_read_b64_tr_b16 v[82:83], v109 offset:9984
    v_dot2_f32_bf16 v36, v68, v68, v36
    v_dot2_f32_bf16 v37, v69, v69, v37
    v_dot2_f32_bf16 v38, v70, v70, v38
    v_dot2_f32_bf16 v39, v71, v71, v39
    s_waitcnt lgkmcnt(7)
    v_mfma_f32_32x32x16_bf16 a[0:15], v[72:75], v[92:95], a[0:15]
    v_add_u32 v110, 28672, v100
    v_add_u32 v111, 28672, v101
    v_add_u32 v112, 28672, v102
    v_add_u32 v113, 28672, v103
    v_add_u32 v114, 28672, v21
    v_add_u32 v115, 28672, v22
    s_waitcnt vmcnt(6)
    v_add_u32 v49, 28672, v24
    s_mov_b64 exec, 0xff
    ds_write_b64 v49, v[26:27]
    s_mov_b64 exec, -1
    s_waitcnt lgkmcnt(0)
    s_barrier
    s_and_b32 s61, s61, 0xffff
    s_mov_b32 s62, 0x100
    s_mov_b32 s63, 0x00020000
    s_cmp_ge_u32 s2, 8
    s_cbranch_scc1 L_nz2
    v_mov_b32 v10, 0
    v_mov_b32 v11, 1
    v_cmp_eq_u32 vcc, 0, v0
    s_and_saveexec_b64 s[44:45], vcc
    s_cbranch_execz L_nzb2
    buffer_atomic_add v11, v10, s[60:63], 0 offen sc1
L_nzb2:
    s_mov_b64 exec, -1
L_nz2:
    ds_read_b128 v[68:71], v110
    ds_read_b64_tr_b16 v[84:85], v114 offset:0
    ds_read_b64_tr_b16 v[86:87], v114 offset:768
    ds_read_b64_tr_b16 v[88:89], v115 offset:0
    v_mfma_f32_32x32x16_bf16 a[16:31], v[28:31], v[96:99], a[16:31]
    ds_read_b64_tr_b16 v[90:91], v115 offset:768
    v_dot2_f32_bf16 v36, v72, v72, v36
    v_dot2_f32_bf16 v37, v73, v73, v37
    v_dot2_f32_bf16 v38, v74, v74, v38
    v_dot2_f32_bf16 v39, v75, v75, v39
    v_mfma_f32_32x32x16_bf16 a[0:15], v[64:67], v[76:79], a[0:15]
    ds_read_b128 v[72:75], v111
    ds_read_b64_tr_b16 v[92:93], v114 offset:3072
    ds_read_b64_tr_b16 v[94:95], v114 offset:3840
    ds_read_b64_tr_b16 v[96:97], v115 offset:3072
    ds_read_b64_tr_b16 v[98:99], v115 offset:3840
    v_mfma_f32_32x32x16_bf16 a[16:31], v[28:31], v[80:83], a[16:31]
    v_dot2_f32_bf16 v36, v64, v64, v36
    v_dot2_f32_bf16 v37, v65, v65, v37
    v_dot2_f32_bf16 v38, v66, v66, v38
    v_dot2_f32_bf16 v39, v67, v67, v39
    s_add_u32 m0, s29, 86016
    s_mul_i32 s31, s55, 172032
    buffer_load_dwordx4 v4, s[8:11], s31 offen sc1 lds
    s_mov_b64 exec, 0xffffffff
    buffer_load_dwordx4 v5, s[8:11], s31 offen offset:1024 sc1 lds
    s_mov_b64 exec, -1
    s_add_u32 m0, s28, 86016
    s_lshl_b32 s30, s55, 7
    buffer_load_dwordx4 v2, s[4:7], s30 offen sc1 lds
    buffer_load_dwordx4 v3, s[4:7], s30 offen offset:1024 sc1 lds
    s_waitcnt lgkmcnt(7)
    v_mfma_f32_32x32x16_bf16 a[0:15], v[68:71], v[84:87], a[0:15]
    ds_read_b128 v[64:67], v112
    ds_read_b64_tr_b16 v[76:77], v114 offset:6144
    ds_read_b64_tr_b16 v[78:79], v114 offset:6912
    ds_read_b64_tr_b16 v[80:81], v115 offset:6144
    s_waitcnt lgkmcnt(9)
    v_mfma_f32_32x32x16_bf16 a[16:31], v[28:31], v[88:91], a[16:31]
    ds_read_b64_tr_b16 v[82:83], v115 offset:6912
    v_dot2_f32_bf16 v36, v68, v68, v36
    v_dot2_f32_bf16 v37, v69, v69, v37
    v_dot2_f32_bf16 v38, v70, v70, v38
    v_dot2_f32_bf16 v39, v71, v71, v39
    s_waitcnt lgkmcnt(7)
    v_mfma_f32_32x32x16_bf16 a[0:15], v[72:75], v[92:95], a[0:15]
    ds_read_b128 v[68:71], v113
    ds_read_b64_tr_b16 v[84:85], v114 offset:9216
    ds_read_b64_tr_b16 v[86:87], v114 offset:9984
    ds_read_b64_tr_b16 v[88:89], v115 offset:9216
    s_waitcnt lgkmcnt(9)
    v_mfma_f32_32x32x16_bf16 a[16:31], v[28:31], v[96:99], a[16:31]
    ds_read_b64_tr_b16 v[90:91], v115 offset:9984
    v_dot2_f32_bf16 v36, v72, v72, v36
    v_dot2_f32_bf16 v37, v73, v73, v37
    v_dot2_f32_bf16 v38, v74, v74, v38
    v_dot2_f32_bf16 v39, v75, v75, v39
    s_waitcnt lgkmcnt(7)
    v_mfma_f32_32x32x16_bf16 a[0:15], v[64:67], v[76:79], a[0:15]
    v_add_u32 v104, 57344, v100
    v_add_u32 v105, 57344, v101
    v_add_u32 v106, 57344, v102
    v_add_u32 v107, 57344, v103
    v_add_u32 v108, 57344, v21
    v_add_u32 v109, 57344, v22
    s_waitcnt vmcnt(6)
    v_add_u32 v49, 57344, v24
    s_mov_b64 exec, 0xff
    ds_write_b64 v49, v[26:27]
    s_mov_b64 exec, -1
    s_waitcnt lgkmcnt(0)
    s_barrier
    ds_read_b128 v[72:75], v104
    ds_read_b64_tr_b16 v[92:93], v108 offset:0
    ds_read_b64_tr_b16 v[94:95], v108 offset:768
    ds_read_b64_tr_b16 v[96:97], v109 offset:0
    v_mfma_f32_32x32x16_bf16 a[16:31], v[28:31], v[80:83], a[16:31]
    ds_read_b64_tr_b16 v[98:99], v109 offset:768
    v_dot2_f32_bf16 v36, v64, v64, v36
    v_dot2_f32_bf16 v37, v65, v65, v37
    v_dot2_f32_bf16 v38, v66, v66, v38
    v_dot2_f32_bf16 v39, v67, v67, v39
    v_mfma_f32_32x32x16_bf16 a[0:15], v[68:71], v[84:87], a[0:15]
    ds_read_b128 v[64:67], v105
    ds_read_b64_tr_b16 v[76:77], v108 offset:3072
    ds_read_b64_tr_b16 v[78:79], v108 offset:3840
    ds_read_b64_tr_b16 v[80:81], v109 offset:3072
    ds_read_b64_tr_b16 v[82:83], v109 offset:3840
    v_mfma_f32_32x32x16_bf16 a[16:31], v[28:31], v[88:91], a[16:31]
    v_dot2_f32_bf16 v36, v68, v68, v36
    v_dot2_f32_bf16 v37, v69, v69, v37
    v_dot2_f32_bf16 v38, v70, v70, v38
    v_dot2_f32_bf16 v39, v71, v71, v39
    s_add_u32 m0, s29, 114688
    s_mul_i32 s31, s56, 172032
    buffer_load_dwordx4 v4, s[8:11], s31 offen sc1 lds
    s_mov_b64 exec, 0xffffffff
    buffer_load_dwordx4 v5, s[8:11], s31 offen offset:1024 sc1 lds
    s_mov_b64 exec, -1
    s_add_u32 m0, s28, 114688
    s_lshl_b32 s30, s56, 7
    buffer_load_dwordx4 v2, s[4:7], s30 offen sc1 lds
    buffer_load_dwordx4 v3, s[4:7], s30 offen offset:1024 sc1 lds
    s_waitcnt lgkmcnt(7)
    v_mfma_f32_32x32x16_bf16 a[0:15], v[72:75], v[92:95], a[0:15]
    ds_read_b128 v[68:71], v106
    ds_read_b64_tr_b16 v[84:85], v108 offset:6144
    ds_read_b64_tr_b16 v[86:87], v108 offset:6912
    ds_read_b64_tr_b16 v[88:89], v109 offset:6144
    s_waitcnt lgkmcnt(9)
    v_mfma_f32_32x32x16_bf16 a[16:31], v[28:31], v[96:99], a[16:31]
    ds_read_b64_tr_b16 v[90:91], v109 offset:6912
    v_dot2_f32_bf16 v36, v72, v72, v36
    v_dot2_f32_bf16 v37, v73, v73, v37
    v_dot2_f32_bf16 v38, v74, v74, v38
    v_dot2_f32_bf16 v39, v75, v75, v39
    s_waitcnt lgkmcnt(7)
    v_mfma_f32_32x32x16_bf16 a[0:15], v[64:67], v[76:79], a[0:15]
    ds_read_b128 v[72:75], v107
    ds_read_b64_tr_b16 v[92:93], v108 offset:9216
    ds_read_b64_tr_b16 v[94:95], v108 offset:9984
    ds_read_b64_tr_b16 v[96:97], v109 offset:9216
    s_waitcnt lgkmcnt(9)
    v_mfma_f32_32x32x16_bf16 a[16:31], v[28:31], v[80:83], a[16:31]
    ds_read_b64_tr_b16 v[98:99], v109 offset:9984
    v_dot2_f32_bf16 v36, v64, v64, v36
    v_dot2_f32_bf16 v37, v65, v65, v37
    v_dot2_f32_bf16 v38, v66, v66, v38
    v_dot2_f32_bf16 v39, v67, v67, v39
    s_waitcnt lgkmcnt(7)
    v_mfma_f32_32x32x16_bf16 a[0:15], v[68:71], v[84:87], a[0:15]
    v_add_u32 v110, 86016, v100
    v_add_u32 v111, 86016, v101
    v_add_u32 v112, 86016, v102
    v_add_u32 v113, 86016, v103
    v_add_u32 v114, 86016, v21
    v_add_u32 v115, 86016, v22
    s_waitcnt vmcnt(4)
    v_add_u32 v49, 86016, v24
    s_mov_b64 exec, 0xff
    ds_write_b64 v49, v[26:27]
    s_mov_b64 exec, -1
    s_waitcnt lgkmcnt(0)
    s_barrier
    ds_read_b128 v[64:67], v110
    ds_read_b64_tr_b16 v[76:77], v114 offset:0
    ds_read_b64_tr_b16 v[78:79], v114 offset:768
    ds_read_b64_tr_b16 v[80:81], v115 offset:0
    v_mfma_f32_32x32x16_bf16 a[16:31], v[28:31], v[88:91], a[16:31]
    ds_read_b64_tr_b16 v[82:83], v115 offset:768
    v_dot2_f32_bf16 v36, v68, v68, v36
    v_dot2_f32_bf16 v37, v69, v69, v37
    v_dot2_f32_bf16 v38, v70, v70, v38
    v_dot2_f32_bf16 v39, v71, v71, v39
    v_mfma_f32_32x32x16_bf16 a[0:15], v[72:75], v[92:95], a[0:15]
    ds_read_b128 v[68:71], v111
    ds_read_b64_tr_b16 v[84:85], v114 offset:3072
    ds_read_b64_tr_b16 v[86:87], v114 offset:3840
    ds_read_b64_tr_b16 v[88:89], v115 offset:3072
    ds_read_b64_tr_b16 v[90:91], v115 offset:3840
    v_mfma_f32_32x32x16_bf16 a[16:31], v[28:31], v[96:99], a[16:31]
    v_dot2_f32_bf16 v36, v72, v72, v36
    v_dot2_f32_bf16 v37, v73, v73, v37
    v_dot2_f32_bf16 v38, v74, v74, v38
    v_dot2_f32_bf16 v39, v75, v75, v39
    s_add_u32 m0, s29, 0
    s_mul_i32 s31, s57, 172032
    buffer_load_dwordx4 v4, s[8:11], s31 offen sc1 lds
    s_mov_b64 exec, 0xffffffff
    buffer_load_dwordx4 v5, s[8:11], s31 offen offset:1024 sc1 lds
    s_mov_b64 exec, -1
    s_add_u32 m0, s28, 0
    s_lshl_b32 s30, s57, 7
    buffer_load_dwordx4 v2, s[4:7], s30 offen sc1 lds
    buffer_load_dwordx4 v3, s[4:7], s30 offen offset:1024 sc1 lds
    s_waitcnt lgkmcnt(7)
    v_mfma_f32_32x32x16_bf16 a[0:15], v[64:67], v[76:79], a[0:15]
    ds_read_b128 v[72:75], v112
    ds_read_b64_tr_b16 v[92:93], v114 offset:6144
    ds_read_b64_tr_b16 v[94:95], v114 offset:6912
    ds_read_b64_tr_b16 v[96:97], v115 offset:6144
    s_waitcnt lgkmcnt(9)
    v_mfma_f32_32x32x16_bf16 a[16:31], v[28:31], v[80:83], a[16:31]
    ds_read_b64_tr_b16 v[98:99], v115 offset:6912
    v_dot2_f32_bf16 v36, v64, v64, v36
    v_dot2_f32_bf16 v37, v65, v65, v37
    v_dot2_f32_bf16 v38, v66, v66, v38
    v_dot2_f32_bf16 v39, v67, v67, v39
    s_waitcnt lgkmcnt(7)
    v_mfma_f32_32x32x16_bf16 a[0:15], v[68:71], v[84:87], a[0:15]
    ds_read_b128 v[64:67], v113
    ds_read_b64_tr_b16 v[76:77], v114 offset:9216
    ds_read_b64_tr_b16 v[78:79], v114 offset:9984
    ds_read_b64_tr_b16 v[80:81], v115 offset:9216
    s_waitcnt lgkmcnt(9)
    v_mfma_f32_32x32x16_bf16 a[16:31], v[28:31], v[88:91], a[16:31]
    ds_read_b64_tr_b16 v[82:83], v115 offset:9984
    v_dot2_f32_bf16 v36, v68, v68, v36
    v_dot2_f32_bf16 v37, v69, v69, v37
    v_dot2_f32_bf16 v38, v70, v70, v38
    v_dot2_f32_bf16 v39, v71, v71, v39
    s_waitcnt lgkmcnt(7)
    v_mfma_f32_32x32x16_bf16 a[0:15], v[72:75], v[92:95], a[0:15]
    v_add_u32 v104, 114688, v100
    v_add_u32 v105, 114688, v101
    v_add_u32 v106, 114688, v102
    v_add_u32 v107, 114688, v103
    v_add_u32 v108, 114688, v21
    v_add_u32 v109, 114688, v22
    s_waitcnt vmcnt(4)
    v_add_u32 v49, 114688, v24
    s_mov_b64 exec, 0xff
    ds_write_b64 v49, v[26:27]
    s_mov_b64 exec, -1
    s_waitcnt lgkmcnt(0)
    s_barrier
    ds_read_b128 v[68:71], v104
    ds_read_b64_tr_b16 v[84:85], v108 offset:0
    ds_read_b64_tr_b16 v[86:87], v108 offset:768
    ds_read_b64_tr_b16 v[88:89], v109 offset:0
    v_mfma_f32_32x32x16_bf16 a[16:31], v[28:31], v[96:99], a[16:31]
    ds_read_b64_tr_b16 v[90:91], v109 offset:768
    v_dot2_f32_bf16 v36, v72, v72, v36
    v_dot2_f32_bf16 v37, v73, v73, v37
    v_dot2_f32_bf16 v38, v74, v74, v38
    v_dot2_f32_bf16 v39, v75, v75, v39
    v_mfma_f32_32x32x16_bf16 a[0:15], v[64:67], v[76:79], a[0:15]
    ds_read_b128 v[72:75], v105
    ds_read_b64_tr_b16 v[92:93], v108 offset:3072
    ds_read_b64_tr_b16 v[94:95], v108 offset:3840
    ds_read_b64_tr_b16 v[96:97], v109 offset:3072
    ds_read_b64_tr_b16 v[98:99], v109 offset:3840
    v_mfma_f32_32x32x16_bf16 a[16:31], v[28:31], v[80:83], a[16:31]
    v_dot2_f32_bf16 v36, v64, v64, v36
    v_dot2_f32_bf16 v37, v65, v65, v37
    v_dot2_f32_bf16 v38, v66, v66, v38
    v_dot2_f32_bf16 v39, v67, v67, v39
    s_add_u32 m0, s29, 28672
    s_mul_i32 s31, s58, 172032
    buffer_load_dwordx4 v4, s[8:11], s31 offen sc1 lds
    s_mov_b64 exec, 0xffffffff
    buffer_load_dwordx4 v5, s[8:11], s31 offen offset:1024 sc1 lds
    s_mov_b64 exec, -1
    s_add_u32 m0, s28, 28672
    s_lshl_b32 s30, s58, 7
    buffer_load_dwordx4 v2, s[4:7], s30 offen sc1 lds
    buffer_load_dwordx4 v3, s[4:7], s30 offen offset:1024 sc1 lds
    s_waitcnt lgkmcnt(7)
    v_mfma_f32_32x32x16_bf16 a[0:15], v[68:71], v[84:87], a[0:15]
    ds_read_b128 v[64:67], v106
    ds_read_b64_tr_b16 v[76:77], v108 offset:6144
    ds_read_b64_tr_b16 v[78:79], v108 offset:6912
    ds_read_b64_tr_b16 v[80:81], v109 offset:6144
    s_waitcnt lgkmcnt(9)
    v_mfma_f32_32x32x16_bf16 a[16:31], v[28:31], v[88:91], a[16:31]
    ds_read_b64_tr_b16 v[82:83], v109 offset:6912
    v_dot2_f32_bf16 v36, v68, v68, v36
    v_dot2_f32_bf16 v37, v69, v69, v37
    v_dot2_f32_bf16 v38, v70, v70, v38
    v_dot2_f32_bf16 v39, v71, v71, v39
    s_waitcnt lgkmcnt(7)
    v_mfma_f32_32x32x16_bf16 a[0:15], v[72:75], v[92:95], a[0:15]
    ds_read_b128 v[68:71], v107
    ds_read_b64_tr_b16 v[84:85], v108 offset:9216
    ds_read_b64_tr_b16 v[86:87], v108 offset:9984
    ds_read_b64_tr_b16 v[88:89], v109 offset:9216
    s_waitcnt lgkmcnt(9)
    v_mfma_f32_32x32x16_bf16 a[16:31], v[28:31], v[96:99], a[16:31]
    ds_read_b64_tr_b16 v[90:91], v109 offset:9984
    v_dot2_f32_bf16 v36, v72, v72, v36
    v_dot2_f32_bf16 v37, v73, v73, v37
    v_dot2_f32_bf16 v38, v74, v74, v38
    v_dot2_f32_bf16 v39, v75, v75, v39
    s_waitcnt lgkmcnt(7)
    v_mfma_f32_32x32x16_bf16 a[0:15], v[64:67], v[76:79], a[0:15]
    v_add_u32 v110, 0, v100
    v_add_u32 v111, 0, v101
    v_add_u32 v112, 0, v102
    v_add_u32 v113, 0, v103
    v_add_u32 v114, 0, v21
    v_add_u32 v115, 0, v22
    s_waitcnt vmcnt(4)
    v_add_u32 v49, 0, v24
    s_mov_b64 exec, 0xff
    ds_write_b64 v49, v[26:27]
    s_mov_b64 exec, -1
    s_waitcnt lgkmcnt(0)
    s_barrier
    ds_read_b128 v[72:75], v110
    ds_read_b64_tr_b16 v[92:93], v114 offset:0
    ds_read_b64_tr_b16 v[94:95], v114 offset:768
    ds_read_b64_tr_b16 v[96:97], v115 offset:0
    v_mfma_f32_32x32x16_bf16 a[16:31], v[28:31], v[80:83], a[16:31]
    ds_read_b64_tr_b16 v[98:99], v115 offset:768
    v_dot2_f32_bf16 v36, v64, v64, v36
    v_dot2_f32_bf16 v37, v65, v65, v37
    v_dot2_f32_bf16 v38, v66, v66, v38
    v_dot2_f32_bf16 v39, v67, v67, v39
    v_mfma_f32_32x32x16_bf16 a[0:15], v[68:71], v[84:87], a[0:15]
    ds_read_b128 v[64:67], v111
    ds_read_b64_tr_b16 v[76:77], v114 offset:3072
    ds_read_b64_tr_b16 v[78:79], v114 offset:3840
    ds_read_b64_tr_b16 v[80:81], v115 offset:3072
    v_mfma_f32_32x32x16_bf16 a[16:31], v[28:31], v[88:91], a[16:31]
    ds_read_b64_tr_b16 v[82:83], v115 offset:3840
    v_dot2_f32_bf16 v36, v68, v68, v36
    v_dot2_f32_bf16 v37, v69, v69, v37
    v_dot2_f32_bf16 v38, v70, v70, v38
    v_dot2_f32_bf16 v39, v71, v71, v39
    s_waitcnt lgkmcnt(7)
    v_mfma_f32_32x32x16_bf16 a[0:15], v[72:75], v[92:95], a[0:15]
    ds_read_b128 v[68:71], v112
    ds_read_b64_tr_b16 v[84:85], v114 offset:6144
    ds_read_b64_tr_b16 v[86:87], v114 offset:6912
    ds_read_b64_tr_b16 v[88:89], v115 offset:6144
    s_waitcnt lgkmcnt(9)
    v_mfma_f32_32x32x16_bf16 a[16:31], v[28:31], v[96:99], a[16:31]
    ds_read_b64_tr_b16 v[90:91], v115 offset:6912
    v_dot2_f32_bf16 v36, v72, v72, v36
    v_dot2_f32_bf16 v37, v73, v73, v37
    v_dot2_f32_bf16 v38, v74, v74, v38
    v_dot2_f32_bf16 v39, v75, v75, v39
    s_waitcnt lgkmcnt(7)
    v_mfma_f32_32x32x16_bf16 a[0:15], v[64:67], v[76:79], a[0:15]
    ds_read_b128 v[72:75], v113
    ds_read_b64_tr_b16 v[92:93], v114 offset:9216
    ds_read_b64_tr_b16 v[94:95], v114 offset:9984
    ds_read_b64_tr_b16 v[96:97], v115 offset:9216
    s_waitcnt lgkmcnt(9)
    v_mfma_f32_32x32x16_bf16 a[16:31], v[28:31], v[80:83], a[16:31]
    ds_read_b64_tr_b16 v[98:99], v115 offset:9984
    v_dot2_f32_bf16 v36, v64, v64, v36
    v_dot2_f32_bf16 v37, v65, v65, v37
    v_dot2_f32_bf16 v38, v66, v66, v38
    v_dot2_f32_bf16 v39, v67, v67, v39
    s_waitcnt lgkmcnt(7)
    v_mfma_f32_32x32x16_bf16 a[0:15], v[68:71], v[84:87], a[0:15]
    v_add_u32 v104, 28672, v100
    v_add_u32 v105, 28672, v101
    v_add_u32 v106, 28672, v102
    v_add_u32 v107, 28672, v103
    v_add_u32 v108, 28672, v21
    v_add_u32 v109, 28672, v22
    s_waitcnt vmcnt(0)
    v_add_u32 v49, 28672, v24
    s_mov_b64 exec, 0xff
    ds_write_b64 v49, v[26:27]
    s_mov_b64 exec, -1
    s_waitcnt lgkmcnt(0)
    s_barrier
    ds_read_b128 v[64:67], v104
    ds_read_b64_tr_b16 v[76:77], v108 offset:0
    ds_read_b64_tr_b16 v[78:79], v108 offset:768
    ds_read_b64_tr_b16 v[80:81], v109 offset:0
    v_mfma_f32_32x32x16_bf16 a[16:31], v[28:31], v[88:91], a[16:31]
    ds_read_b64_tr_b16 v[82:83], v109 offset:768
    v_dot2_f32_bf16 v36, v68, v68, v36
    v_dot2_f32_bf16 v37, v69, v69, v37
    v_dot2_f32_bf16 v38, v70, v70, v38
    v_dot2_f32_bf16 v39, v71, v71, v39
    v_mfma_f32_32x32x16_bf16 a[0:15], v[72:75], v[92:95], a[0:15]
    ds_read_b128 v[68:71], v105
    ds_read_b64_tr_b16 v[84:85], v108 offset:3072
    ds_read_b64_tr_b16 v[86:87], v108 offset:3840
    ds_read_b64_tr_b16 v[88:89], v109 offset:3072
    v_mfma_f32_32x32x16_bf16 a[16:31], v[28:31], v[96:99], a[16:31]
    ds_read_b64_tr_b16 v[90:91], v109 offset:3840
    v_dot2_f32_bf16 v36, v72, v72, v36
    v_dot2_f32_bf16 v37, v73, v73, v37
    v_dot2_f32_bf16 v38, v74, v74, v38
    v_dot2_f32_bf16 v39, v75, v75, v39
    s_waitcnt lgkmcnt(7)
    v_mfma_f32_32x32x16_bf16 a[0:15], v[64:67], v[76:79], a[0:15]
    ds_read_b128 v[72:75], v106
    ds_read_b64_tr_b16 v[92:93], v108 offset:6144
    ds_read_b64_tr_b16 v[94:95], v108 offset:6912
    ds_read_b64_tr_b16 v[96:97], v109 offset:6144
    s_waitcnt lgkmcnt(9)
    v_mfma_f32_32x32x16_bf16 a[16:31], v[28:31], v[80:83], a[16:31]
    ds_read_b64_tr_b16 v[98:99], v109 offset:6912
    v_dot2_f32_bf16 v36, v64, v64, v36
    v_dot2_f32_bf16 v37, v65, v65, v37
    v_dot2_f32_bf16 v38, v66, v66, v38
    v_dot2_f32_bf16 v39, v67, v67, v39
    s_waitcnt lgkmcnt(7)
    v_mfma_f32_32x32x16_bf16 a[0:15], v[68:71], v[84:87], a[0:15]
    ds_read_b128 v[64:67], v107
    ds_read_b64_tr_b16 v[76:77], v108 offset:9216
    ds_read_b64_tr_b16 v[78:79], v108 offset:9984
    ds_read_b64_tr_b16 v[80:81], v109 offset:9216
    s_waitcnt lgkmcnt(9)
    v_mfma_f32_32x32x16_bf16 a[16:31], v[28:31], v[88:91], a[16:31]
    ds_read_b64_tr_b16 v[82:83], v109 offset:9984
    v_dot2_f32_bf16 v36, v68, v68, v36
    v_dot2_f32_bf16 v37, v69, v69, v37
    v_dot2_f32_bf16 v38, v70, v70, v38
    v_dot2_f32_bf16 v39, v71, v71, v39
    s_waitcnt lgkmcnt(7)
    v_mfma_f32_32x32x16_bf16 a[0:15], v[72:75], v[92:95], a[0:15]
    v_dot2_f32_bf16 v36, v72, v72, v36
    v_dot2_f32_bf16 v37, v73, v73, v37
    s_waitcnt lgkmcnt(5)
    v_mfma_f32_32x32x16_bf16 a[16:31], v[28:31], v[96:99], a[16:31]
    v_dot2_f32_bf16 v38, v74, v74, v38
    v_dot2_f32_bf16 v39, v75, v75, v39
    s_waitcnt lgkmcnt(2)
    v_mfma_f32_32x32x16_bf16 a[0:15], v[64:67], v[76:79], a[0:15]
    v_dot2_f32_bf16 v36, v64, v64, v36
    v_dot2_f32_bf16 v37, v65, v65, v37
    s_waitcnt lgkmcnt(0)
    v_mfma_f32_32x32x16_bf16 a[16:31], v[28:31], v[80:83], a[16:31]
    v_dot2_f32_bf16 v38, v66, v66, v38
    v_dot2_f32_bf16 v39, v67, v67, v39
    s_lshl_b32 s36, s24, 6
    s_lshl_b32 s37, s23, 2
    s_add_u32 s36, s36, s37
    s_add_u32 s36, s36, s47
    s_lshl_b32 s36, s36, 11
    v_lshlrev_b32 v59, 4, v1
    v_add_u32 v59, s36, v59
    v_mov_b32 v10, 0
    s_mov_b64 exec, 0x1
    buffer_load_dword v116, v10, s[60:63], 0 offen sc0 sc1
    s_mov_b64 exec, -1
    v_and_b32 v47, 31, v1
    v_lshlrev_b32 v47, 2, v47
    s_lshl_b32 s35, s47, 8
    s_add_u32 s35, s35, 146432
    v_add_u32 v46, s35, v47
    v_add_f32 v36, v36, v37
    v_add_f32 v38, v38, v39
    v_add_f32 v36, v36, v38
    v_mov_b32 v48, v36
    s_nop 1
    v_permlane32_swap_b32 v48, v36
    v_add_f32 v48, v48, v36
    s_min_u32 s35, s47, 2
    s_lshl_b32 s35, s35, 7
    s_add_u32 s35, s35, 143360
    v_add_u32 v45, s35, v47
    s_mov_b64 exec, 0xffffffff
    ds_write_b32 v46, v48 offset:128
    ds_write_b32 v45, a16
    s_mov_b64 exec, -1
    s_waitcnt lgkmcnt(0)
    s_barrier
    ds_read_b32 v52, v46
    v_add_u32 v55, 143360, v47
    ds_read_b32 v56, v55 offset:256
    s_mul_i32 s40, s24, 384
    s_add_u32 s40, s40, 0x1380000
    s_or_b32 s41, s23, s47
    s_cmp_eq_u32 s41, 0
    s_cselect_b32 s40, s40, 0x7fff0000
    v_lshlrev_b32 v60, 2, v1
    v_add_u32 v61, 143360, v60
    ds_read_b32 v45, v61
    s_waitcnt lgkmcnt(0)
    buffer_store_dword v45, v60, s[12:15], s40 offen sc0 sc1
    s_mov_b64 exec, 0xffffffff
    buffer_store_dword v56, v60, s[12:15], s40 offen offset:256 sc0 sc1
    s_mov_b64 exec, -1
    v_mul_f32 v52, 0x3b124925, v52
    v_mul_f32 v48, 0x3b124925, v48
    v_fma_f32 v48, -v52, v52, v48
    v_max_f32 v48, 0, v48
    v_add_f32 v48, 0x3727c5ac, v48
    v_rsq_f32 v48, v48
    s_nop 0
    v_mul_f32 v52, -v52, v48
    v_and_b32 v57, 31, v1
    v_lshlrev_b32 v57, 2, v57
    s_lshl_b32 s35, s22, 8
    s_add_u32 s35, s35, 144384
    v_add_u32 v57, s35, v57
    s_mov_b64 exec, 0xffffffff
    ds_write_b32 v57, v48
    ds_write_b32 v57, v52 offset:128
    s_mov_b64 exec, -1
    v_lshlrev_b32 v58, 4, v17
    v_add_u32 v58, s35, v58
    ds_read_b128 v[120:123], v58 offset:0
    ds_read_b128 v[136:139], v58 offset:128
    ds_read_b128 v[124:127], v58 offset:32
    ds_read_b128 v[140:143], v58 offset:160
    ds_read_b128 v[128:131], v58 offset:64
    ds_read_b128 v[144:147], v58 offset:192
    ds_read_b128 v[132:135], v58 offset:96
    ds_read_b128 v[148:151], v58 offset:224
    s_waitcnt lgkmcnt(6)
    v_mul_f32 v136, v136, v56
    v_mul_f32 v137, v137, v56
    v_mul_f32 v138, v138, v56
    v_mul_f32 v139, v139, v56
    s_waitcnt lgkmcnt(4)
    v_mul_f32 v140, v140, v56
    v_mul_f32 v141, v141, v56
    v_mul_f32 v142, v142, v56
    v_mul_f32 v143, v143, v56
    s_waitcnt lgkmcnt(2)
    v_mul_f32 v144, v144, v56
    v_mul_f32 v145, v145, v56
    v_mul_f32 v146, v146, v56
    v_mul_f32 v147, v147, v56
    s_waitcnt lgkmcnt(0)
    v_mul_f32 v148, v148, v56
    v_mul_f32 v149, v149, v56
    v_mul_f32 v150, v150, v56
    v_mul_f32 v151, v151, v56
    v_and_b32 v62, 31, v1
    v_cmp_gt_u32 s[42:43], 28, v62
    v_cmp_eq_u32 vcc, 28, v62
    v_mov_b32 v63, 0x3f803f80
    s_nop 0
    v_cndmask_b32 v63, 0, v63, vcc
    v_accvgpr_read_b32 v64, a0
    v_accvgpr_read_b32 v65, a1
    v_accvgpr_read_b32 v66, a2
    v_accvgpr_read_b32 v67, a3
    v_accvgpr_read_b32 v68, a4
    v_accvgpr_read_b32 v69, a5
    v_accvgpr_read_b32 v70, a6
    v_accvgpr_read_b32 v71, a7
    v_accvgpr_read_b32 v72, a8
    v_accvgpr_read_b32 v73, a9
    v_accvgpr_read_b32 v74, a10
    v_accvgpr_read_b32 v75, a11
    v_accvgpr_read_b32 v76, a12
    v_accvgpr_read_b32 v77, a13
    v_accvgpr_read_b32 v78, a14
    v_accvgpr_read_b32 v79, a15
    v_fma_f32 v64, v64, v120, v136
    v_fma_f32 v65, v65, v121, v137
    v_fma_f32 v66, v66, v122, v138
    v_fma_f32 v67, v67, v123, v139
    v_fma_f32 v68, v68, v124, v140
    v_fma_f32 v69, v69, v125, v141
    v_fma_f32 v70, v70, v126, v142
    v_fma_f32 v71, v71, v127, v143
    v_fma_f32 v72, v72, v128, v144
    v_fma_f32 v73, v73, v129, v145
    v_fma_f32 v74, v74, v130, v146
    v_fma_f32 v75, v75, v131, v147
    v_fma_f32 v76, v76, v132, v148
    v_fma_f32 v77, v77, v133, v149
    v_fma_f32 v78, v78, v134, v150
    v_fma_f32 v79, v79, v135, v151
    v_cvt_pk_bf16_f32 v96, v64, v65
    v_cndmask_b32 v96, v63, v96, s[42:43]
    v_cvt_pk_bf16_f32 v97, v66, v67
    v_cndmask_b32 v97, v63, v97, s[42:43]
    v_cvt_pk_bf16_f32 v98, v68, v69
    v_cndmask_b32 v98, v63, v98, s[42:43]
    v_cvt_pk_bf16_f32 v99, v70, v71
    v_cndmask_b32 v99, v63, v99, s[42:43]
    v_cvt_pk_bf16_f32 v100, v72, v73
    v_cndmask_b32 v100, v63, v100, s[42:43]
    v_cvt_pk_bf16_f32 v101, v74, v75
    v_cndmask_b32 v101, v63, v101, s[42:43]
    v_cvt_pk_bf16_f32 v102, v76, v77
    v_cndmask_b32 v102, v63, v102, s[42:43]
    v_cvt_pk_bf16_f32 v103, v78, v79
    v_cndmask_b32 v103, v63, v103, s[42:43]
    s_mov_b32 s40, 0x400000
    buffer_store_dwordx4 v[96:99], v59, s[12:15], s40 offen sc0 sc1
    buffer_store_dwordx4 v[100:103], v59, s[12:15], s40 offen offset:1024 sc0 sc1
L_pk1a_e2:
    s_nop 1
    s_mov_b32 s34, 0
    v_mov_b32 v10, 0
    s_cmp_lg_u32 s22, 0
    s_cbranch_scc1 L_aww3
    s_mov_b64 exec, 0x1
    s_mov_b32 s45, 0x40000
    s_waitcnt vmcnt(0)
    v_cmp_gt_u32 vcc, 8, v116
    s_cbranch_vccz L_awd3
L_awp3:
    buffer_load_dword v168, v10, s[60:63], s34 offen sc0 sc1
    s_waitcnt vmcnt(0)
    v_cmp_gt_u32 vcc, 8, v168
    s_cbranch_vccz L_awd3
    s_sub_u32 s45, s45, 1
    s_cmp_lg_u32 s45, 0
    s_cbranch_scc1 L_awp3
L_awd3:
    s_mov_b64 exec, -1
L_aww3:
    s_nop 0
    s_barrier
    s_lshl_b32 s34, s24, 7
    s_lshl_b32 s35, s23, 2
    s_add_u32 s34, s34, s35
    s_add_u32 s34, s34, 0x100f000
    s_waitcnt vmcnt(0) lgkmcnt(0)
    s_barrier
    v_mov_b32 v10, 0
    v_mov_b32 v11, 1
    v_cmp_eq_u32 vcc, 0, v0
    s_and_saveexec_b64 s[44:45], vcc
    s_cbranch_execz L_pub4
    buffer_atomic_add v11, v10, s[12:15], s34 offen sc1
L_pub4:
    s_mov_b64 exec, -1
    s_nop 1
    s_load_dwordx2 s[20:21], s[0:1], 80
    s_load_dwordx2 s[88:89], s[0:1], 48
    s_load_dwordx2 s[84:85], s[0:1], 32
    v_and_b32 v1, 63, v0
    v_lshrrev_b32 v2, 6, v0
    s_nop 0
    v_readfirstlane_b32 s22, v2
    s_lshr_b32 s23, s2, 4
    s_and_b32 s24, s2, 15
    s_and_b32 s38, s22, 3
    s_lshr_b32 s39, s22, 2
    v_lshlrev_b32 v2, 4, v1
    s_lshl_b32 s25, s24, 17
    s_lshl_b32 s26, s23, 2
    s_sub_u32 s26, s26, 8
    s_mul_i32 s27, s22, 3
    s_add_u32 s34, s27, 0
    s_lshr_b32 s35, s34, 1
    s_add_i32 s35, s35, s26
    s_lshl_b32 s36, s35, 11
    s_and_b32 s37, s34, 1
    s_lshl_b32 s37, s37, 10
    s_add_u32 s36, s36, s37
    s_cmp_lt_i32 s35, 0
    s_cselect_b32 s72, 0x40000000, s36
    s_add_u32 s34, s27, 1
    s_lshr_b32 s35, s34, 1
    s_add_i32 s35, s35, s26
    s_lshl_b32 s36, s35, 11
    s_and_b32 s37, s34, 1
    s_lshl_b32 s37, s37, 10
    s_add_u32 s36, s36, s37
    s_cmp_lt_i32 s35, 0
    s_cselect_b32 s73, 0x40000000, s36
    s_add_u32 s34, s27, 2
    s_lshr_b32 s35, s34, 1
    s_add_i32 s35, s35, s26
    s_lshl_b32 s36, s35, 11
    s_and_b32 s37, s34, 1
    s_lshl_b32 s37, s37, 10
    s_add_u32 s36, s36, s37
    s_cmp_lt_i32 s35, 0
    s_cselect_b32 s74, 0x40000000, s36
    s_lshl_b32 s29, s27, 10
    s_waitcnt lgkmcnt(0)
    s_add_u32 s28, s25, 0x0
    s_add_u32 s4, s20, s28
    s_addc_u32 s5, s21, 0
    s_and_b32 s5, s5, 0xffff
    s_mov_b32 s6, 0x20000
    s_mov_b32 s7, 0x00020000
    s_add_u32 s28, s25, 0x200000
    s_add_u32 s8, s20, s28
    s_addc_u32 s9, s21, 0
    s_and_b32 s9, s9, 0xffff
    s_mov_b32 s10, 0x20000
    s_mov_b32 s11, 0x00020000
    s_add_u32 s28, s25, 0x400000
    s_add_u32 s12, s20, s28
    s_addc_u32 s13, s21, 0
    s_and_b32 s13, s13, 0xffff
    s_mov_b32 s14, 0x20000
    s_mov_b32 s15, 0x00020000
    s_mov_b32 s92, s20
    s_and_b32 s93, s21, 0xffff
    s_mov_b32 s94, 0x4000000
    s_mov_b32 s95, 0x00020000
    s_lshl_b32 s34, s24, 7
    s_add_u32 s34, s34, 0x100f000
    v_add_u32 v10, s23, v1
    v_subrev_u32 v10, 2, v10
    v_max_i32 v10, 0, v10
    v_lshlrev_b32 v10, 2, v10
    s_cmp_lg_u32 s22, 0
    s_cbranch_scc1 L_aww5
    s_mov_b64 exec, 0x7
    s_mov_b32 s45, 0x40000
L_awp5:
    buffer_load_dword v168, v10, s[92:95], s34 offen sc0 sc1
    s_waitcnt vmcnt(0)
    v_cmp_gt_u32 vcc, 1, v168
    s_cbranch_vccz L_awd5
    s_sub_u32 s45, s45, 1
    s_cmp_lg_u32 s45, 0
    s_cbranch_scc1 L_awp5
L_awd5:
    s_mov_b64 exec, -1
L_aww5:
    s_nop 0
    s_barrier
    s_add_u32 m0, s29, 0
    s_nop 0
    buffer_load_dwordx4 v2, s[8:11], s72 offen sc1 lds
    s_add_u32 m0, s29, 1024
    s_nop 0
    buffer_load_dwordx4 v2, s[8:11], s73 offen sc1 lds
    s_add_u32 m0, s29, 2048
    s_nop 0
    buffer_load_dwordx4 v2, s[8:11], s74 offen sc1 lds
    s_lshl_b32 s30, s23, 13
    s_lshl_b32 s31, s22, 10
    s_add_u32 s30, s30, s31
    s_add_u32 m0, s31, 49152
    s_nop 0
    buffer_load_dwordx4 v2, s[4:7], s30 offen sc1 lds
    s_barrier
    s_add_u32 m0, s29, 24576
    s_nop 0
    buffer_load_dwordx4 v2, s[12:15], s72 offen sc1 lds
    s_add_u32 m0, s29, 25600
    s_nop 0
    buffer_load_dwordx4 v2, s[12:15], s73 offen sc1 lds
    s_add_u32 m0, s29, 26624
    s_nop 0
    buffer_load_dwordx4 v2, s[12:15], s74 offen sc1 lds
    s_add_u32 s16, s20, 0x600000
    s_addc_u32 s17, s21, 0
    s_and_b32 s17, s17, 0xffff
    s_mov_b32 s18, 0x200000
    s_mov_b32 s19, 0x00020000
    s_lshl_b32 s34, s2, 3
    s_add_u32 s34, s34, s22
    s_mul_i32 s34, s34, 3584
    v_lshlrev_b32 v40, 7, v1
    v_add_u32 v40, s34, v40
    s_and_b32 s89, s89, 0xffff
    s_mov_b32 s90, 0x700000
    s_mov_b32 s91, 0x00020000
    s_and_b32 s85, s85, 0xffff
    s_mov_b32 s86, 0x700000
    s_mov_b32 s87, 0x00020000
    v_and_b32 v4, 31, v1
    v_lshrrev_b32 v5, 5, v1
    v_mov_b32 v18, 0xf14a
    v_mul_lo_u32 v18, v18, v5
    v_add_u32 v19, s29, v2
    v_lshlrev_b32 v6, 2, v5
    v_sub_u32 v6, v4, v6
    v_cmp_ge_i32 s[40:41], v6, 0
    v_cmp_ge_i32 s[42:43], v6, 1
    v_cmp_ge_i32 s[44:45], v6, 2
    v_cmp_ge_i32 s[46:47], v6, 3
    v_cmp_ge_i32 s[48:49], v6, 8
    v_cmp_ge_i32 s[50:51], v6, 9
    v_cmp_ge_i32 s[52:53], v6, 10
    v_cmp_ge_i32 s[54:55], v6, 11
    v_cmp_ge_i32 s[56:57], v6, 16
    v_cmp_ge_i32 s[58:59], v6, 17
    v_cmp_ge_i32 s[60:61], v6, 18
    v_cmp_ge_i32 s[62:63], v6, 19
    v_cmp_ge_i32 s[64:65], v6, 24
    v_cmp_ge_i32 s[66:67], v6, 25
    v_cmp_ge_i32 s[68:69], v6, 26
    v_cmp_ge_i32 s[70:71], v6, 27
    v_mov_b32 v7, 0xffff
    v_mov_b32 v16, 0xffff0000
    v_cndmask_b32 v8, 0, v7, s[40:41]
    v_cndmask_b32 v17, 0, v16, s[42:43]
    v_or_b32 v8, v8, v17
    v_cndmask_b32 v9, 0, v7, s[44:45]
    v_cndmask_b32 v17, 0, v16, s[46:47]
    v_or_b32 v9, v9, v17
    v_cndmask_b32 v10, 0, v7, s[48:49]
    v_cndmask_b32 v17, 0, v16, s[50:51]
    v_or_b32 v10, v10, v17
    v_cndmask_b32 v11, 0, v7, s[52:53]
    v_cndmask_b32 v17, 0, v16, s[54:55]
    v_or_b32 v11, v11, v17
    v_cndmask_b32 v12, 0, v7, s[56:57]
    v_cndmask_b32 v17, 0, v16, s[58:59]
    v_or_b32 v12, v12, v17
    v_cndmask_b32 v13, 0, v7, s[60:61]
    v_cndmask_b32 v17, 0, v16, s[62:63]
    v_or_b32 v13, v13, v17
    v_cndmask_b32 v14, 0, v7, s[64:65]
    v_cndmask_b32 v17, 0, v16, s[66:67]
    v_or_b32 v14, v14, v17
    v_cndmask_b32 v15, 0, v7, s[68:69]
    v_cndmask_b32 v17, 0, v16, s[70:71]
    v_or_b32 v15, v15, v17
    s_waitcnt vmcnt(3)
    s_add_u32 s34, s27, 0
    s_and_b32 s34, s34, 1
    s_cmp_eq_u32 s72, 0x40000000
    s_cselect_b32 s35, s34, 0
    s_cmp_eq_u32 s35, 0
    s_cbranch_scc1 L_pk2a_np0
    ds_write_b32 v19, v18 offset:8
L_pk2a_np0:
    s_add_u32 s34, s27, 1
    s_and_b32 s34, s34, 1
    s_cmp_eq_u32 s73, 0x40000000
    s_cselect_b32 s35, s34, 0
    s_cmp_eq_u32 s35, 0
    s_cbranch_scc1 L_pk2a_np1
    ds_write_b32 v19, v18 offset:1032
L_pk2a_np1:
    s_add_u32 s34, s27, 2
    s_and_b32 s34, s34, 1
    s_cmp_eq_u32 s74, 0x40000000
    s_cselect_b32 s35, s34, 0
    s_cmp_eq_u32 s35, 0
    s_cbranch_scc1 L_pk2a_np2
    ds_write_b32 v19, v18 offset:2056
L_pk2a_np2:
    s_waitcnt lgkmcnt(0)
    s_barrier
    s_lshl_b32 s35, s38, 11
    v_add_u32 v28, s35, v2
    ds_read_b128 v[20:23], v28 offset:49152
    ds_read_b128 v[24:27], v28 offset:50176
    s_mul_i32 s36, s22, 4096
    s_add_u32 s36, s36, 57344
    v_add_u32 v44, s36, v2
    s_xor_b32 s37, s22, 4
    s_mul_i32 s37, s37, 4096
    s_add_u32 s37, s37, 57344
    v_add_u32 v45, s37, v2
    s_cmp_eq_u32 s39, 0
    s_cbranch_scc0 L_pk2a_h1
    ds_read_b128 a[0:3], v28 offset:0
    ds_read_b128 a[4:7], v28 offset:1024
    ds_read_b128 a[8:11], v28 offset:16384
    ds_read_b128 a[12:15], v28 offset:17408
    ds_read_b128 a[16:19], v28 offset:2048
    ds_read_b128 a[20:23], v28 offset:3072
    ds_read_b128 a[24:27], v28 offset:4096
    ds_read_b128 a[28:31], v28 offset:5120
    ds_read_b128 a[32:35], v28 offset:6144
    ds_read_b128 a[36:39], v28 offset:7168
    s_waitcnt lgkmcnt(9)
    v_mfma_f32_32x32x16_bf16 v[48:63], a[0:3], v[20:23], 0
    s_waitcnt lgkmcnt(8)
    v_mfma_f32_32x32x16_bf16 v[48:63], a[4:7], v[24:27], v[48:63]
    s_waitcnt lgkmcnt(7)
    v_mfma_f32_32x32x16_bf16 v[64:79], a[8:11], v[20:23], 0
    s_waitcnt lgkmcnt(6)
    v_mfma_f32_32x32x16_bf16 v[64:79], a[12:15], v[24:27], v[64:79]
    s_waitcnt lgkmcnt(5)
    v_mfma_f32_32x32x16_bf16 v[80:95], a[16:19], v[20:23], 0
    s_waitcnt lgkmcnt(4)
    v_mfma_f32_32x32x16_bf16 v[80:95], a[20:23], v[24:27], v[80:95]
    s_waitcnt lgkmcnt(3)
    v_mfma_f32_32x32x16_bf16 v[96:111], a[24:27], v[20:23], 0
    s_waitcnt lgkmcnt(2)
    v_mfma_f32_32x32x16_bf16 v[96:111], a[28:31], v[24:27], v[96:111]
    s_nop 3
    v_cndmask_b32 v48, v48, v64, s[40:41]
    v_cndmask_b32 v49, v49, v65, s[42:43]
    v_cndmask_b32 v50, v50, v66, s[44:45]
    v_cndmask_b32 v51, v51, v67, s[46:47]
    v_cndmask_b32 v52, v52, v68, s[48:49]
    v_cndmask_b32 v53, v53, v69, s[50:51]
    v_cndmask_b32 v54, v54, v70, s[52:53]
    v_cndmask_b32 v55, v55, v71, s[54:55]
    v_cndmask_b32 v56, v56, v72, s[56:57]
    v_cndmask_b32 v57, v57, v73, s[58:59]
    v_cndmask_b32 v58, v58, v74, s[60:61]
    v_cndmask_b32 v59, v59, v75, s[62:63]
    v_cndmask_b32 v60, v60, v76, s[64:65]
    v_cndmask_b32 v61, v61, v77, s[66:67]
    v_cndmask_b32 v62, v62, v78, s[68:69]
    v_cndmask_b32 v63, v63, v79, s[70:71]
    s_waitcnt lgkmcnt(1)
    v_mfma_f32_32x32x16_bf16 v[64:79], a[32:35], v[20:23], 0
    s_waitcnt lgkmcnt(0)
    v_mfma_f32_32x32x16_bf16 v[64:79], a[36:39], v[24:27], v[64:79]
    v_max3_f32 v30, v48, v49, v50
    v_max3_f32 v30, v30, v51, v52
    v_max3_f32 v30, v30, v53, v54
    v_max3_f32 v30, v30, v55, v56
    v_max3_f32 v30, v30, v57, v58
    v_max3_f32 v30, v30, v59, v60
    v_max3_f32 v30, v30, v61, v62
    v_max_f32 v30, v30, v63
    v_max3_f32 v30, v30, v80, v81
    v_max3_f32 v30, v30, v82, v83
    v_max3_f32 v30, v30, v84, v85
    v_max3_f32 v30, v30, v86, v87
    v_max3_f32 v30, v30, v88, v89
    v_max3_f32 v30, v30, v90, v91
    v_max3_f32 v30, v30, v92, v93
    v_max3_f32 v30, v30, v94, v95
    v_max3_f32 v30, v30, v96, v97
    v_max3_f32 v30, v30, v98, v99
    v_max3_f32 v30, v30, v100, v101
    v_max3_f32 v30, v30, v102, v103
    v_max3_f32 v30, v30, v104, v105
    v_max3_f32 v30, v30, v106, v107
    v_max3_f32 v30, v30, v108, v109
    v_max3_f32 v30, v30, v110, v111
    v_max3_f32 v30, v30, v64, v65
    v_max3_f32 v30, v30, v66, v67
    v_max3_f32 v30, v30, v68, v69
    v_max3_f32 v30, v30, v70, v71
    v_max3_f32 v30, v30, v72, v73
    v_max3_f32 v30, v30, v74, v75
    v_max3_f32 v30, v30, v76, v77
    v_max3_f32 v30, v30, v78, v79
    v_mov_b32 v31, v30
    s_nop 1
    v_permlane32_swap_b32 v31, v30
    v_max_f32 v30, v30, v31
    ds_write_b32 v44, v30
    s_waitcnt vmcnt(0)
    s_waitcnt lgkmcnt(0)
    s_barrier
    ds_read_b32 v31, v45
    ds_read_b128 a[40:43], v28 offset:24576
    ds_read_b128 a[44:47], v28 offset:25600
    ds_read_b128 a[48:51], v28 offset:40960
    ds_read_b128 a[52:55], v28 offset:41984
    ds_read_b128 a[56:59], v28 offset:26624
    ds_read_b128 a[60:63], v28 offset:27648
    ds_read_b128 a[64:67], v28 offset:28672
    ds_read_b128 a[68:71], v28 offset:29696
    ds_read_b128 a[72:75], v28 offset:30720
    ds_read_b128 a[76:79], v28 offset:31744
    s_waitcnt lgkmcnt(10)
    v_max_f32 v30, v30, v31
    v_sub_f32 v112, 0, v30
    v_sub_f32 v113, 0, v30
    v_sub_f32 v114, 0, v30
    v_sub_f32 v115, 0, v30
    v_sub_f32 v116, 0, v30
    v_sub_f32 v117, 0, v30
    v_sub_f32 v118, 0, v30
    v_sub_f32 v119, 0, v30
    v_sub_f32 v120, 0, v30
    v_sub_f32 v121, 0, v30
    v_sub_f32 v122, 0, v30
    v_sub_f32 v123, 0, v30
    v_sub_f32 v124, 0, v30
    v_sub_f32 v125, 0, v30
    v_sub_f32 v126, 0, v30
    v_sub_f32 v127, 0, v30
    s_nop 1
    v_mfma_f32_32x32x16_bf16 v[48:63], a[0:3], v[20:23], v[112:127]
    v_mfma_f32_32x32x16_bf16 v[48:63], a[4:7], v[24:27], v[48:63]
    v_mfma_f32_32x32x16_bf16 v[64:79], a[8:11], v[20:23], v[112:127]
    v_mfma_f32_32x32x16_bf16 v[64:79], a[12:15], v[24:27], v[64:79]
    v_mfma_f32_32x32x16_bf16 v[80:95], a[16:19], v[20:23], v[112:127]
    v_mfma_f32_32x32x16_bf16 v[80:95], a[20:23], v[24:27], v[80:95]
    v_mfma_f32_32x32x16_bf16 v[96:111], a[24:27], v[20:23], v[112:127]
    v_mfma_f32_32x32x16_bf16 v[96:111], a[28:31], v[24:27], v[96:111]
    s_nop 7
    v_cndmask_b32 v48, v48, v64, s[40:41]
    v_cndmask_b32 v49, v49, v65, s[42:43]
    v_cndmask_b32 v50, v50, v66, s[44:45]
    v_cndmask_b32 v51, v51, v67, s[46:47]
    v_cndmask_b32 v52, v52, v68, s[48:49]
    v_cndmask_b32 v53, v53, v69, s[50:51]
    v_cndmask_b32 v54, v54, v70, s[52:53]
    v_cndmask_b32 v55, v55, v71, s[54:55]
    v_cndmask_b32 v56, v56, v72, s[56:57]
    v_cndmask_b32 v57, v57, v73, s[58:59]
    v_cndmask_b32 v58, v58, v74, s[60:61]
    v_cndmask_b32 v59, v59, v75, s[62:63]
    v_cndmask_b32 v60, v60, v76, s[64:65]
    v_cndmask_b32 v61, v61, v77, s[66:67]
    v_cndmask_b32 v62, v62, v78, s[68:69]
    v_cndmask_b32 v63, v63, v79, s[70:71]
    v_mfma_f32_32x32x16_bf16 v[64:79], a[32:35], v[20:23], v[112:127]
    v_mfma_f32_32x32x16_bf16 v[64:79], a[36:39], v[24:27], v[64:79]
    v_exp_f32 v48, v48
    v_exp_f32 v49, v49
    v_exp_f32 v50, v50
    v_exp_f32 v51, v51
    v_exp_f32 v52, v52
    v_exp_f32 v53, v53
    v_exp_f32 v54, v54
    v_exp_f32 v55, v55
    v_exp_f32 v56, v56
    v_exp_f32 v57, v57
    v_exp_f32 v58, v58
    v_exp_f32 v59, v59
    v_exp_f32 v60, v60
    v_exp_f32 v61, v61
    v_exp_f32 v62, v62
    v_exp_f32 v63, v63
    v_cvt_pk_bf16_f32 v144, v48, v49
    v_cvt_pk_bf16_f32 v145, v50, v51
    v_cvt_pk_bf16_f32 v146, v52, v53
    v_cvt_pk_bf16_f32 v147, v54, v55
    v_cvt_pk_bf16_f32 v148, v56, v57
    v_cvt_pk_bf16_f32 v149, v58, v59
    v_cvt_pk_bf16_f32 v150, v60, v61
    v_cvt_pk_bf16_f32 v151, v62, v63
    s_mov_b64 exec, 0x7f
    buffer_load_dword v42, v40, s[84:87], 0 offen
    s_mov_b64 exec, -1
    v_and_b32 v152, v8, v144
    v_xor_b32 v144, v144, v152
    v_and_b32 v153, v9, v145
    v_xor_b32 v145, v145, v153
    v_and_b32 v154, v10, v146
    v_xor_b32 v146, v146, v154
    v_and_b32 v155, v11, v147
    v_xor_b32 v147, v147, v155
    v_and_b32 v156, v12, v148
    v_xor_b32 v148, v148, v156
    v_and_b32 v157, v13, v149
    v_xor_b32 v149, v149, v157
    v_and_b32 v158, v14, v150
    v_xor_b32 v150, v150, v158
    v_and_b32 v159, v15, v151
    v_xor_b32 v151, v151, v159
    s_waitcnt lgkmcnt(9)
    v_mfma_f32_32x32x16_bf16 v[128:143], a[40:43], v[144:147], 0
    s_waitcnt lgkmcnt(8)
    v_mfma_f32_32x32x16_bf16 v[128:143], a[44:47], v[148:151], v[128:143]
    s_waitcnt lgkmcnt(7)
    v_mfma_f32_32x32x16_bf16 v[128:143], a[48:51], v[152:155], v[128:143]
    s_waitcnt lgkmcnt(6)
    v_mfma_f32_32x32x16_bf16 v[128:143], a[52:55], v[156:159], v[128:143]
    v_exp_f32 v80, v80
    v_exp_f32 v81, v81
    v_exp_f32 v82, v82
    v_exp_f32 v83, v83
    v_exp_f32 v84, v84
    v_exp_f32 v85, v85
    v_exp_f32 v86, v86
    v_exp_f32 v87, v87
    v_exp_f32 v88, v88
    v_exp_f32 v89, v89
    v_exp_f32 v90, v90
    v_exp_f32 v91, v91
    v_exp_f32 v92, v92
    v_exp_f32 v93, v93
    v_exp_f32 v94, v94
    v_exp_f32 v95, v95
    v_cvt_pk_bf16_f32 v160, v80, v81
    v_cvt_pk_bf16_f32 v161, v82, v83
    v_cvt_pk_bf16_f32 v162, v84, v85
    v_cvt_pk_bf16_f32 v163, v86, v87
    v_cvt_pk_bf16_f32 v164, v88, v89
    v_cvt_pk_bf16_f32 v165, v90, v91
    v_cvt_pk_bf16_f32 v166, v92, v93
    v_cvt_pk_bf16_f32 v167, v94, v95
    s_mov_b64 exec, 0x3f80
    buffer_load_dword v42, v40, s[84:87], 0 offen
    s_mov_b64 exec, -1
    s_waitcnt lgkmcnt(5)
    v_mfma_f32_32x32x16_bf16 v[128:143], a[56:59], v[160:163], v[128:143]
    s_waitcnt lgkmcnt(4)
    v_mfma_f32_32x32x16_bf16 v[128:143], a[60:63], v[164:167], v[128:143]
    v_exp_f32 v96, v96
    v_exp_f32 v97, v97
    v_exp_f32 v98, v98
    v_exp_f32 v99, v99
    v_exp_f32 v100, v100
    v_exp_f32 v101, v101
    v_exp_f32 v102, v102
    v_exp_f32 v103, v103
    v_exp_f32 v104, v104
    v_exp_f32 v105, v105
    v_exp_f32 v106, v106
    v_exp_f32 v107, v107
    v_exp_f32 v108, v108
    v_exp_f32 v109, v109
    v_exp_f32 v110, v110
    v_exp_f32 v111, v111
    v_cvt_pk_bf16_f32 v144, v96, v97
    v_cvt_pk_bf16_f32 v145, v98, v99
    v_cvt_pk_bf16_f32 v146, v100, v101
    v_cvt_pk_bf16_f32 v147, v102, v103
    v_cvt_pk_bf16_f32 v148, v104, v105
    v_cvt_pk_bf16_f32 v149, v106, v107
    v_cvt_pk_bf16_f32 v150, v108, v109
    v_cvt_pk_bf16_f32 v151, v110, v111
    s_mov_b64 exec, 0x1fc000
    buffer_load_dword v42, v40, s[84:87], 0 offen
    s_mov_b64 exec, -1
    s_waitcnt lgkmcnt(3)
    v_mfma_f32_32x32x16_bf16 v[128:143], a[64:67], v[144:147], v[128:143]
    s_waitcnt lgkmcnt(2)
    v_mfma_f32_32x32x16_bf16 v[128:143], a[68:71], v[148:151], v[128:143]
    v_exp_f32 v64, v64
    v_exp_f32 v65, v65
    v_exp_f32 v66, v66
    v_exp_f32 v67, v67
    v_exp_f32 v68, v68
    v_exp_f32 v69, v69
    v_exp_f32 v70, v70
    v_exp_f32 v71, v71
    v_exp_f32 v72, v72
    v_exp_f32 v73, v73
    v_exp_f32 v74, v74
    v_exp_f32 v75, v75
    v_exp_f32 v76, v76
    v_exp_f32 v77, v77
    v_exp_f32 v78, v78
    v_exp_f32 v79, v79
    v_cvt_pk_bf16_f32 v152, v64, v65
    v_cvt_pk_bf16_f32 v153, v66, v67
    v_cvt_pk_bf16_f32 v154, v68, v69
    v_cvt_pk_bf16_f32 v155, v70, v71
    v_cvt_pk_bf16_f32 v156, v72, v73
    v_cvt_pk_bf16_f32 v157, v74, v75
    v_cvt_pk_bf16_f32 v158, v76, v77
    v_cvt_pk_bf16_f32 v159, v78, v79
    s_mov_b64 exec, 0xfe00000
    buffer_load_dword v42, v40, s[84:87], 0 offen
    s_mov_b64 exec, -1
    s_waitcnt lgkmcnt(1)
    v_mfma_f32_32x32x16_bf16 v[128:143], a[72:75], v[152:155], v[128:143]
    s_waitcnt lgkmcnt(0)
    v_mfma_f32_32x32x16_bf16 v[128:143], a[76:79], v[156:159], v[128:143]
    s_nop 11
    ds_write_b128 v44, v[136:139] offset:1024
    ds_write_b128 v44, v[140:143] offset:2048
    ds_write_b32 v44, v140 offset:3072
    s_waitcnt lgkmcnt(0)
    s_barrier
    ds_read_b128 v[144:147], v45 offset:1024
    ds_read_b128 v[148:151], v45 offset:2048
    ds_read_b32 v32, v45 offset:3072
    s_waitcnt lgkmcnt(0)
    v_add_f32 v32, v32, v140
    v_mov_b32 v33, v32
    s_nop 1
    v_permlane32_swap_b32 v33, v32
    v_rcp_f32 v33, v32
    v_add_f32 v128, v128, v144
    v_mul_f32 v128, v128, v33
    v_add_f32 v129, v129, v145
    v_mul_f32 v129, v129, v33
    v_add_f32 v130, v130, v146
    v_mul_f32 v130, v130, v33
    v_add_f32 v131, v131, v147
    v_mul_f32 v131, v131, v33
    v_add_f32 v132, v132, v148
    v_mul_f32 v132, v132, v33
    v_add_f32 v133, v133, v149
    v_mul_f32 v133, v133, v33
    v_add_f32 v134, v134, v150
    v_mul_f32 v134, v134, v33
    v_add_f32 v135, v135, v151
    v_mul_f32 v135, v135, v33
    v_cvt_pk_bf16_f32 v152, v128, v129
    v_cvt_pk_bf16_f32 v153, v130, v131
    v_cvt_pk_bf16_f32 v154, v132, v133
    v_cvt_pk_bf16_f32 v155, v134, v135
    s_lshl_b32 s37, s23, 2
    s_add_u32 s37, s37, s38
    s_lshl_b32 s37, s37, 15
    s_lshl_b32 s36, s24, 10
    s_add_u32 s37, s37, s36
    v_bfe_u32 v35, v1, 4, 1
    v_lshlrev_b32 v35, 14, v35
    v_and_b32 v36, 15, v1
    v_lshl_add_u32 v35, v36, 4, v35
    v_lshl_add_u32 v35, v5, 8, v35
    buffer_store_dwordx4 v[152:155], v35, s[16:19], s37 offen offset:0 sc0 sc1
    s_branch L_pk2a_done
L_pk2a_h1:
    s_waitcnt lgkmcnt(0)
    ds_read_b128 a[0:3], v28 offset:8192
    ds_read_b128 a[4:7], v28 offset:9216
    ds_read_b128 a[8:11], v28 offset:10240
    ds_read_b128 a[12:15], v28 offset:11264
    ds_read_b128 a[16:19], v28 offset:12288
    ds_read_b128 a[20:23], v28 offset:13312
    ds_read_b128 a[24:27], v28 offset:14336
    ds_read_b128 a[28:31], v28 offset:15360
    s_waitcnt lgkmcnt(7)
    v_mfma_f32_32x32x16_bf16 v[48:63], a[0:3], v[20:23], 0
    s_waitcnt lgkmcnt(6)
    v_mfma_f32_32x32x16_bf16 v[48:63], a[4:7], v[24:27], v[48:63]
    s_waitcnt lgkmcnt(5)
    v_mfma_f32_32x32x16_bf16 v[64:79], a[8:11], v[20:23], 0
    s_waitcnt lgkmcnt(4)
    v_mfma_f32_32x32x16_bf16 v[64:79], a[12:15], v[24:27], v[64:79]
    s_waitcnt lgkmcnt(3)
    v_mfma_f32_32x32x16_bf16 v[80:95], a[16:19], v[20:23], 0
    s_waitcnt lgkmcnt(2)
    v_mfma_f32_32x32x16_bf16 v[80:95], a[20:23], v[24:27], v[80:95]
    s_waitcnt lgkmcnt(1)
    v_mfma_f32_32x32x16_bf16 v[96:111], a[24:27], v[20:23], 0
    s_waitcnt lgkmcnt(0)
    v_mfma_f32_32x32x16_bf16 v[96:111], a[28:31], v[24:27], v[96:111]
    v_max3_f32 v30, v48, v49, v50
    v_max3_f32 v30, v30, v51, v52
    v_max3_f32 v30, v30, v53, v54
    v_max3_f32 v30, v30, v55, v56
    v_max3_f32 v30, v30, v57, v58
    v_max3_f32 v30, v30, v59, v60
    v_max3_f32 v30, v30, v61, v62
    v_max_f32 v30, v30, v63
    v_max3_f32 v30, v30, v64, v65
    v_max3_f32 v30, v30, v66, v67
    v_max3_f32 v30, v30, v68, v69
    v_max3_f32 v30, v30, v70, v71
    v_max3_f32 v30, v30, v72, v73
    v_max3_f32 v30, v30, v74, v75
    v_max3_f32 v30, v30, v76, v77
    v_max3_f32 v30, v30, v78, v79
    v_max3_f32 v30, v30, v80, v81
    v_max3_f32 v30, v30, v82, v83
    v_max3_f32 v30, v30, v84, v85
    v_max3_f32 v30, v30, v86, v87
    v_max3_f32 v30, v30, v88, v89
    v_max3_f32 v30, v30, v90, v91
    v_max3_f32 v30, v30, v92, v93
    v_max3_f32 v30, v30, v94, v95
    v_max3_f32 v30, v30, v96, v97
    v_max3_f32 v30, v30, v98, v99
    v_max3_f32 v30, v30, v100, v101
    v_max3_f32 v30, v30, v102, v103
    v_max3_f32 v30, v30, v104, v105
    v_max3_f32 v30, v30, v106, v107
    v_max3_f32 v30, v30, v108, v109
    v_max3_f32 v30, v30, v110, v111
    v_mov_b32 v31, v30
    s_nop 1
    v_permlane32_swap_b32 v31, v30
    v_max_f32 v30, v30, v31
    ds_write_b32 v44, v30
    s_waitcnt vmcnt(0)
    s_waitcnt lgkmcnt(0)
    s_barrier
    ds_read_b32 v31, v45
    ds_read_b128 a[40:43], v28 offset:32768
    ds_read_b128 a[44:47], v28 offset:33792
    ds_read_b128 a[48:51], v28 offset:34816
    ds_read_b128 a[52:55], v28 offset:35840
    ds_read_b128 a[56:59], v28 offset:36864
    ds_read_b128 a[60:63], v28 offset:37888
    ds_read_b128 a[64:67], v28 offset:38912
    ds_read_b128 a[68:71], v28 offset:39936
    s_waitcnt lgkmcnt(8)
    v_max_f32 v30, v30, v31
    v_sub_f32 v112, 0, v30
    v_sub_f32 v113, 0, v30
    v_sub_f32 v114, 0, v30
    v_sub_f32 v115, 0, v30
    v_sub_f32 v116, 0, v30
    v_sub_f32 v117, 0, v30
    v_sub_f32 v118, 0, v30
    v_sub_f32 v119, 0, v30
    v_sub_f32 v120, 0, v30
    v_sub_f32 v121, 0, v30
    v_sub_f32 v122, 0, v30
    v_sub_f32 v123, 0, v30
    v_sub_f32 v124, 0, v30
    v_sub_f32 v125, 0, v30
    v_sub_f32 v126, 0, v30
    v_sub_f32 v127, 0, v30
    s_nop 1
    v_mfma_f32_32x32x16_bf16 v[48:63], a[0:3], v[20:23], v[112:127]
    v_mfma_f32_32x32x16_bf16 v[48:63], a[4:7], v[24:27], v[48:63]
    v_mfma_f32_32x32x16_bf16 v[64:79], a[8:11], v[20:23], v[112:127]
    v_mfma_f32_32x32x16_bf16 v[64:79], a[12:15], v[24:27], v[64:79]
    v_mfma_f32_32x32x16_bf16 v[80:95], a[16:19], v[20:23], v[112:127]
    v_mfma_f32_32x32x16_bf16 v[80:95], a[20:23], v[24:27], v[80:95]
    v_mfma_f32_32x32x16_bf16 v[96:111], a[24:27], v[20:23], v[112:127]
    v_mfma_f32_32x32x16_bf16 v[96:111], a[28:31], v[24:27], v[96:111]
    s_nop 5
    v_exp_f32 v48, v48
    v_exp_f32 v49, v49
    v_exp_f32 v50, v50
    v_exp_f32 v51, v51
    v_exp_f32 v52, v52
    v_exp_f32 v53, v53
    v_exp_f32 v54, v54
    v_exp_f32 v55, v55
    v_exp_f32 v56, v56
    v_exp_f32 v57, v57
    v_exp_f32 v58, v58
    v_exp_f32 v59, v59
    v_exp_f32 v60, v60
    v_exp_f32 v61, v61
    v_exp_f32 v62, v62
    v_exp_f32 v63, v63
    v_cvt_pk_bf16_f32 v144, v48, v49
    v_cvt_pk_bf16_f32 v145, v50, v51
    v_cvt_pk_bf16_f32 v146, v52, v53
    v_cvt_pk_bf16_f32 v147, v54, v55
    v_cvt_pk_bf16_f32 v148, v56, v57
    v_cvt_pk_bf16_f32 v149, v58, v59
    v_cvt_pk_bf16_f32 v150, v60, v61
    v_cvt_pk_bf16_f32 v151, v62, v63
    s_mov_b64 exec, 0x7f
    buffer_load_dword v42, v40, s[84:87], 0 offen
    s_mov_b64 exec, -1
    s_waitcnt lgkmcnt(7)
    v_mfma_f32_32x32x16_bf16 v[128:143], a[40:43], v[144:147], 0
    s_waitcnt lgkmcnt(6)
    v_mfma_f32_32x32x16_bf16 v[128:143], a[44:47], v[148:151], v[128:143]
    v_exp_f32 v64, v64
    v_exp_f32 v65, v65
    v_exp_f32 v66, v66
    v_exp_f32 v67, v67
    v_exp_f32 v68, v68
    v_exp_f32 v69, v69
    v_exp_f32 v70, v70
    v_exp_f32 v71, v71
    v_exp_f32 v72, v72
    v_exp_f32 v73, v73
    v_exp_f32 v74, v74
    v_exp_f32 v75, v75
    v_exp_f32 v76, v76
    v_exp_f32 v77, v77
    v_exp_f32 v78, v78
    v_exp_f32 v79, v79
    v_cvt_pk_bf16_f32 v152, v64, v65
    v_cvt_pk_bf16_f32 v153, v66, v67
    v_cvt_pk_bf16_f32 v154, v68, v69
    v_cvt_pk_bf16_f32 v155, v70, v71
    v_cvt_pk_bf16_f32 v156, v72, v73
    v_cvt_pk_bf16_f32 v157, v74, v75
    v_cvt_pk_bf16_f32 v158, v76, v77
    v_cvt_pk_bf16_f32 v159, v78, v79
    s_mov_b64 exec, 0x3f80
    buffer_load_dword v42, v40, s[84:87], 0 offen
    s_mov_b64 exec, -1
    s_waitcnt lgkmcnt(5)
    v_mfma_f32_32x32x16_bf16 v[128:143], a[48:51], v[152:155], v[128:143]
    s_waitcnt lgkmcnt(4)
    v_mfma_f32_32x32x16_bf16 v[128:143], a[52:55], v[156:159], v[128:143]
    v_exp_f32 v80, v80
    v_exp_f32 v81, v81
    v_exp_f32 v82, v82
    v_exp_f32 v83, v83
    v_exp_f32 v84, v84
    v_exp_f32 v85, v85
    v_exp_f32 v86, v86
    v_exp_f32 v87, v87
    v_exp_f32 v88, v88
    v_exp_f32 v89, v89
    v_exp_f32 v90, v90
    v_exp_f32 v91, v91
    v_exp_f32 v92, v92
    v_exp_f32 v93, v93
    v_exp_f32 v94, v94
    v_exp_f32 v95, v95
    v_cvt_pk_bf16_f32 v160, v80, v81
    v_cvt_pk_bf16_f32 v161, v82, v83
    v_cvt_pk_bf16_f32 v162, v84, v85
    v_cvt_pk_bf16_f32 v163, v86, v87
    v_cvt_pk_bf16_f32 v164, v88, v89
    v_cvt_pk_bf16_f32 v165, v90, v91
    v_cvt_pk_bf16_f32 v166, v92, v93
    v_cvt_pk_bf16_f32 v167, v94, v95
    s_mov_b64 exec, 0x1fc000
    buffer_load_dword v42, v40, s[84:87], 0 offen
    s_mov_b64 exec, -1
    s_waitcnt lgkmcnt(3)
    v_mfma_f32_32x32x16_bf16 v[128:143], a[56:59], v[160:163], v[128:143]
    s_waitcnt lgkmcnt(2)
    v_mfma_f32_32x32x16_bf16 v[128:143], a[60:63], v[164:167], v[128:143]
    v_exp_f32 v96, v96
    v_exp_f32 v97, v97
    v_exp_f32 v98, v98
    v_exp_f32 v99, v99
    v_exp_f32 v100, v100
    v_exp_f32 v101, v101
    v_exp_f32 v102, v102
    v_exp_f32 v103, v103
    v_exp_f32 v104, v104
    v_exp_f32 v105, v105
    v_exp_f32 v106, v106
    v_exp_f32 v107, v107
    v_exp_f32 v108, v108
    v_exp_f32 v109, v109
    v_exp_f32 v110, v110
    v_exp_f32 v111, v111
    v_cvt_pk_bf16_f32 v144, v96, v97
    v_cvt_pk_bf16_f32 v145, v98, v99
    v_cvt_pk_bf16_f32 v146, v100, v101
    v_cvt_pk_bf16_f32 v147, v102, v103
    v_cvt_pk_bf16_f32 v148, v104, v105
    v_cvt_pk_bf16_f32 v149, v106, v107
    v_cvt_pk_bf16_f32 v150, v108, v109
    v_cvt_pk_bf16_f32 v151, v110, v111
    s_mov_b64 exec, 0xfe00000
    buffer_load_dword v42, v40, s[84:87], 0 offen
    s_mov_b64 exec, -1
    s_waitcnt lgkmcnt(1)
    v_mfma_f32_32x32x16_bf16 v[128:143], a[64:67], v[144:147], v[128:143]
    s_waitcnt lgkmcnt(0)
    v_mfma_f32_32x32x16_bf16 v[128:143], a[68:71], v[148:151], v[128:143]
    s_nop 11
    ds_write_b128 v44, v[128:131] offset:1024
    ds_write_b128 v44, v[132:135] offset:2048
    ds_write_b32 v44, v140 offset:3072
    s_waitcnt lgkmcnt(0)
    s_barrier
    ds_read_b128 v[144:147], v45 offset:1024
    ds_read_b128 v[148:151], v45 offset:2048
    ds_read_b32 v32, v45 offset:3072
    s_waitcnt lgkmcnt(0)
    v_add_f32 v32, v32, v140
    v_mov_b32 v33, v32
    s_nop 1
    v_permlane32_swap_b32 v33, v32
    v_rcp_f32 v33, v32
    v_add_f32 v136, v136, v144
    v_mul_f32 v136, v136, v33
    v_add_f32 v137, v137, v145
    v_mul_f32 v137, v137, v33
    v_add_f32 v138, v138, v146
    v_mul_f32 v138, v138, v33
    v_add_f32 v139, v139, v147
    v_mul_f32 v139, v139, v33
    v_add_f32 v140, v140, v148
    v_mul_f32 v140, v140, v33
    v_add_f32 v141, v141, v149
    v_mul_f32 v141, v141, v33
    v_add_f32 v142, v142, v150
    v_mul_f32 v142, v142, v33
    v_add_f32 v143, v143, v151
    v_mul_f32 v143, v143, v33
    v_cvt_pk_bf16_f32 v152, v136, v137
    v_cvt_pk_bf16_f32 v153, v138, v139
    v_cvt_pk_bf16_f32 v154, v140, v141
    v_cvt_pk_bf16_f32 v155, v142, v143
    v_cmp_eq_u32 vcc, 0, v5
    s_nop 1
    v_cndmask_b32 v154, 0, v154, vcc
    v_cndmask_b32 v155, 0, v155, vcc
    s_lshl_b32 s37, s23, 2
    s_add_u32 s37, s37, s38
    s_lshl_b32 s37, s37, 15
    s_lshl_b32 s36, s24, 10
    s_add_u32 s37, s37, s36
    v_bfe_u32 v35, v1, 4, 1
    v_lshlrev_b32 v35, 14, v35
    v_and_b32 v36, 15, v1
    v_lshl_add_u32 v35, v36, 4, v35
    v_lshl_add_u32 v35, v5, 8, v35
    buffer_store_dwordx4 v[152:155], v35, s[16:19], s37 offen offset:512 sc0 sc1
L_pk2a_done:
    s_nop 1
    s_lshl_b32 s34, s23, 7
    s_add_u32 s34, s34, 0x100c800
    s_waitcnt vmcnt(0) lgkmcnt(0)
    s_barrier
    v_mov_b32 v10, 0
    v_mov_b32 v11, 1
    v_cmp_eq_u32 vcc, 0, v0
    s_and_saveexec_b64 s[44:45], vcc
    s_cbranch_execz L_pub6
    buffer_atomic_add v11, v10, s[92:95], s34 offen sc1
L_pub6:
    s_mov_b64 exec, -1
    s_nop 1
    s_cmp_ge_u32 s2, 224
    s_cbranch_scc1 L_pk3a_idle
    s_load_dwordx2 s[20:21], s[0:1], 80
    s_load_dwordx2 s[8:9], s[0:1], 16
    s_load_dwordx2 s[12:13], s[0:1], 0
    s_load_dwordx2 s[48:49], s[0:1], 32
    v_and_b32 v1, 63, v0
    v_lshrrev_b32 v2, 6, v0
    s_nop 0
    v_readfirstlane_b32 s22, v2
    s_lshr_b32 s23, s2, 5
    s_and_b32 s24, s2, 31
    v_lshlrev_b32 v2, 4, v1
    v_lshrrev_b32 v3, 3, v1
    v_bfe_u32 v4, v1, 4, 2
    v_lshlrev_b32 v4, 1, v4
    v_and_b32 v5, 7, v1
    v_xor_b32 v4, v4, v5
    v_mul_u32_u24 v5, 896, v3
    v_lshl_add_u32 v5, v4, 4, v5
    s_lshl_b32 s25, s23, 7
    v_add_u32 v5, s25, v5
    s_waitcnt lgkmcnt(0)
    s_add_u32 s4, s20, 0x600000
    s_addc_u32 s5, s21, 0
    s_and_b32 s5, s5, 0xffff
    s_mov_b32 s6, 0x200000
    s_mov_b32 s7, 0x00020000
    s_and_b32 s9, s9, 0xffff
    s_mov_b32 s10, 0x62000
    s_mov_b32 s11, 0x00020000
    s_and_b32 s13, s13, 0xffff
    s_mov_b32 s14, 0x1c0000
    s_mov_b32 s15, 0x00020000
    s_mov_b32 s16, s20
    s_and_b32 s17, s21, 0xffff
    s_mov_b32 s18, 0x4000000
    s_mov_b32 s19, 0x00020000
    s_mul_i32 s30, s22, 7168
    s_lshl_b32 s32, s22, 10
    s_add_u32 m0, s32, 65536
    s_add_u32 s31, s30, 0
    buffer_load_dwordx4 v5, s[8:11], s31 offen sc1 lds
    s_add_u32 m0, s32, 73728
    s_add_u32 s31, s30, 57344
    buffer_load_dwordx4 v5, s[8:11], s31 offen sc1 lds
    s_add_u32 m0, s32, 81920
    s_add_u32 s31, s30, 114688
    buffer_load_dwordx4 v5, s[8:11], s31 offen sc1 lds
    s_add_u32 m0, s32, 90112
    s_add_u32 s31, s30, 172032
    buffer_load_dwordx4 v5, s[8:11], s31 offen sc1 lds
    s_add_u32 m0, s32, 98304
    s_add_u32 s31, s30, 229376
    buffer_load_dwordx4 v5, s[8:11], s31 offen sc1 lds
    s_add_u32 m0, s32, 106496
    s_add_u32 s31, s30, 286720
    buffer_load_dwordx4 v5, s[8:11], s31 offen sc1 lds
    s_add_u32 m0, s32, 114688
    s_add_u32 s31, s30, 344064
    buffer_load_dwordx4 v5, s[8:11], s31 offen sc1 lds
    s_lshl_b32 s35, s22, 10
    s_add_u32 m0, s35, 122880
    s_lshl_b32 s34, s24, 6
    s_lshl_b32 s35, s22, 3
    s_add_u32 s34, s34, s35
    s_mul_i32 s34, s34, 896
    buffer_load_dwordx4 v5, s[12:15], s34 offen sc1 lds
    s_lshr_b32 s34, s24, 1
    s_lshl_b32 s34, s34, 7
    s_add_u32 s34, s34, 0x100c800
    v_mov_b32 v10, 0
    s_cmp_lg_u32 s22, 0
    s_cbranch_scc1 L_aww7
    s_mov_b64 exec, 0x1
    s_mov_b32 s45, 0x40000
L_awp7:
    buffer_load_dword v168, v10, s[16:19], s34 offen sc0 sc1
    s_waitcnt vmcnt(0)
    v_cmp_gt_u32 vcc, 16, v168
    s_cbranch_vccz L_awd7
    s_sub_u32 s45, s45, 1
    s_cmp_lg_u32 s45, 0
    s_cbranch_scc1 L_awp7
L_awd7:
    s_mov_b64 exec, -1
L_aww7:
    s_nop 0
    s_barrier
    s_lshl_b32 s32, s22, 13
    s_lshl_b32 s29, s24, 16
    s_add_u32 s30, s29, s32
    s_add_u32 m0, s32, 0
    s_add_u32 s31, s30, 0
    buffer_load_dwordx4 v2, s[4:7], s31 offen sc1 lds
    s_add_u32 m0, s32, 1024
    s_add_u32 s31, s30, 1024
    buffer_load_dwordx4 v2, s[4:7], s31 offen sc1 lds
    s_barrier
    s_add_u32 m0, s32, 2048
    s_add_u32 s31, s30, 2048
    buffer_load_dwordx4 v2, s[4:7], s31 offen sc1 lds
    s_add_u32 m0, s32, 3072
    s_add_u32 s31, s30, 3072
    buffer_load_dwordx4 v2, s[4:7], s31 offen sc1 lds
    s_add_u32 m0, s32, 4096
    s_add_u32 s31, s30, 4096
    buffer_load_dwordx4 v2, s[4:7], s31 offen sc1 lds
    s_add_u32 m0, s32, 5120
    s_add_u32 s31, s30, 5120
    buffer_load_dwordx4 v2, s[4:7], s31 offen sc1 lds
    s_add_u32 m0, s32, 6144
    s_add_u32 s31, s30, 6144
    buffer_load_dwordx4 v2, s[4:7], s31 offen sc1 lds
    s_add_u32 m0, s32, 7168
    s_add_u32 s31, s30, 7168
    buffer_load_dwordx4 v2, s[4:7], s31 offen sc1 lds
    s_and_b32 s33, s22, 1
    s_lshr_b32 s34, s22, 1
    s_lshl_b32 s35, s33, 15
    v_add_u32 v6, s35, v2
    v_lshrrev_b32 v7, 4, v1
    v_bfe_u32 v8, v1, 2, 2
    v_and_b32 v9, 3, v1
    v_lshrrev_b32 v10, 1, v7
    v_and_b32 v11, 1, v7
    v_lshlrev_b32 v12, 4, v10
    v_lshl_add_u32 v12, v11, 2, v12
    v_add_u32 v12, v12, v8
    v_lshlrev_b32 v12, 7, v12
    v_lshl_add_u32 v12, v9, 3, v12
    v_lshrrev_b32 v13, 1, v8
    v_lshl_add_u32 v13, v11, 1, v13
    v_xor_b32 v14, s34, v13
    v_lshl_add_u32 v16, v14, 5, v12
    v_add_u32 v16, 65536, v16
    v_add_u32 v13, 2, v13
    v_and_b32 v13, 3, v13
    v_xor_b32 v14, s34, v13
    v_lshl_add_u32 v17, v14, 5, v12
    v_add_u32 v17, 65536, v17
    v_lshl_add_u32 v14, v7, 2, v8
    v_bfe_u32 v15, v14, 1, 2
    v_lshlrev_b32 v14, 7, v14
    v_lshl_add_u32 v14, v9, 3, v14
    s_lshl_b32 s38, s33, 12
    s_add_u32 s38, s38, 122880
    v_add_u32 v14, s38, v14
    v_xor_b32 v20, s34, v15
    v_lshl_add_u32 v18, v20, 5, v14
    s_waitcnt vmcnt(0)
    s_barrier
    ds_read_b128 v[48:51], v6 offset:0
    ds_read_b128 v[52:55], v6 offset:16384
    ds_read_b64_tr_b16 v[72:73], v16 offset:0
    ds_read_b64_tr_b16 v[74:75], v16 offset:1024
    ds_read_b128 v[56:59], v6 offset:1024
    ds_read_b128 v[60:63], v6 offset:17408
    ds_read_b64_tr_b16 v[76:77], v17 offset:3584
    ds_read_b64_tr_b16 v[78:79], v17 offset:4608
    ds_read_b128 v[64:67], v6 offset:2048
    ds_read_b128 v[68:71], v6 offset:18432
    ds_read_b64_tr_b16 v[80:81], v16 offset:7168
    ds_read_b64_tr_b16 v[82:83], v16 offset:8192
    s_waitcnt lgkmcnt(8)
    v_mfma_f32_16x16x32_bf16 v[32:35], v[48:51], v[72:75], 0
    v_mfma_f32_16x16x32_bf16 v[36:39], v[52:55], v[72:75], 0
    ds_read_b128 v[48:51], v6 offset:3072
    ds_read_b128 v[52:55], v6 offset:19456
    ds_read_b64_tr_b16 v[72:73], v17 offset:10752
    ds_read_b64_tr_b16 v[74:75], v17 offset:11776
    s_waitcnt lgkmcnt(8)
    v_mfma_f32_16x16x32_bf16 v[32:35], v[56:59], v[76:79], v[32:35]
    v_mfma_f32_16x16x32_bf16 v[36:39], v[60:63], v[76:79], v[36:39]
    ds_read_b128 v[56:59], v6 offset:4096
    ds_read_b128 v[60:63], v6 offset:20480
    ds_read_b64_tr_b16 v[76:77], v16 offset:14336
    ds_read_b64_tr_b16 v[78:79], v16 offset:15360
    s_waitcnt lgkmcnt(8)
    v_mfma_f32_16x16x32_bf16 v[32:35], v[64:67], v[80:83], v[32:35]
    v_mfma_f32_16x16x32_bf16 v[36:39], v[68:71], v[80:83], v[36:39]
    ds_read_b128 v[64:67], v6 offset:5120
    ds_read_b128 v[68:71], v6 offset:21504
    ds_read_b64_tr_b16 v[80:81], v17 offset:17920
    ds_read_b64_tr_b16 v[82:83], v17 offset:18944
    s_waitcnt lgkmcnt(8)
    v_mfma_f32_16x16x32_bf16 v[32:35], v[48:51], v[72:75], v[32:35]
    v_mfma_f32_16x16x32_bf16 v[36:39], v[52:55], v[72:75], v[36:39]
    ds_read_b128 v[48:51], v6 offset:6144
    ds_read_b128 v[52:55], v6 offset:22528
    ds_read_b64_tr_b16 v[72:73], v16 offset:21504
    ds_read_b64_tr_b16 v[74:75], v16 offset:22528
    s_waitcnt lgkmcnt(8)
    v_mfma_f32_16x16x32_bf16 v[32:35], v[56:59], v[76:79], v[32:35]
    v_mfma_f32_16x16x32_bf16 v[36:39], v[60:63], v[76:79], v[36:39]
    ds_read_b128 v[56:59], v6 offset:7168
    ds_read_b128 v[60:63], v6 offset:23552
    ds_read_b64_tr_b16 v[76:77], v17 offset:25088
    ds_read_b64_tr_b16 v[78:79], v17 offset:26112
    s_waitcnt lgkmcnt(8)
    v_mfma_f32_16x16x32_bf16 v[32:35], v[64:67], v[80:83], v[32:35]
    v_mfma_f32_16x16x32_bf16 v[36:39], v[68:71], v[80:83], v[36:39]
    ds_read_b128 v[64:67], v6 offset:8192
    ds_read_b128 v[68:71], v6 offset:24576
    ds_read_b64_tr_b16 v[80:81], v16 offset:28672
    ds_read_b64_tr_b16 v[82:83], v16 offset:29696
    s_waitcnt lgkmcnt(8)
    v_mfma_f32_16x16x32_bf16 v[32:35], v[48:51], v[72:75], v[32:35]
    v_mfma_f32_16x16x32_bf16 v[36:39], v[52:55], v[72:75], v[36:39]
    ds_read_b128 v[48:51], v6 offset:9216
    ds_read_b128 v[52:55], v6 offset:25600
    ds_read_b64_tr_b16 v[72:73], v17 offset:32256
    ds_read_b64_tr_b16 v[74:75], v17 offset:33280
    s_waitcnt lgkmcnt(8)
    v_mfma_f32_16x16x32_bf16 v[32:35], v[56:59], v[76:79], v[32:35]
    v_mfma_f32_16x16x32_bf16 v[36:39], v[60:63], v[76:79], v[36:39]
    ds_read_b128 v[56:59], v6 offset:10240
    ds_read_b128 v[60:63], v6 offset:26624
    ds_read_b64_tr_b16 v[76:77], v16 offset:35840
    ds_read_b64_tr_b16 v[78:79], v16 offset:36864
    s_waitcnt lgkmcnt(8)
    v_mfma_f32_16x16x32_bf16 v[32:35], v[64:67], v[80:83], v[32:35]
    v_mfma_f32_16x16x32_bf16 v[36:39], v[68:71], v[80:83], v[36:39]
    ds_read_b128 v[64:67], v6 offset:11264
    ds_read_b128 v[68:71], v6 offset:27648
    ds_read_b64_tr_b16 v[80:81], v17 offset:39424
    ds_read_b64_tr_b16 v[82:83], v17 offset:40448
    s_waitcnt lgkmcnt(8)
    v_mfma_f32_16x16x32_bf16 v[32:35], v[48:51], v[72:75], v[32:35]
    v_mfma_f32_16x16x32_bf16 v[36:39], v[52:55], v[72:75], v[36:39]
    ds_read_b128 v[48:51], v6 offset:12288
    ds_read_b128 v[52:55], v6 offset:28672
    ds_read_b64_tr_b16 v[72:73], v16 offset:43008
    ds_read_b64_tr_b16 v[74:75], v16 offset:44032
    s_waitcnt lgkmcnt(8)
    v_mfma_f32_16x16x32_bf16 v[32:35], v[56:59], v[76:79], v[32:35]
    v_mfma_f32_16x16x32_bf16 v[36:39], v[60:63], v[76:79], v[36:39]
    ds_read_b128 v[56:59], v6 offset:13312
    ds_read_b128 v[60:63], v6 offset:29696
    ds_read_b64_tr_b16 v[76:77], v17 offset:46592
    ds_read_b64_tr_b16 v[78:79], v17 offset:47616
    s_waitcnt lgkmcnt(8)
    v_mfma_f32_16x16x32_bf16 v[32:35], v[64:67], v[80:83], v[32:35]
    v_mfma_f32_16x16x32_bf16 v[36:39], v[68:71], v[80:83], v[36:39]
    ds_read_b128 v[64:67], v6 offset:14336
    ds_read_b128 v[68:71], v6 offset:30720
    ds_read_b64_tr_b16 v[80:81], v16 offset:50176
    ds_read_b64_tr_b16 v[82:83], v16 offset:51200
    s_waitcnt lgkmcnt(8)
    v_mfma_f32_16x16x32_bf16 v[32:35], v[48:51], v[72:75], v[32:35]
    v_mfma_f32_16x16x32_bf16 v[36:39], v[52:55], v[72:75], v[36:39]
    ds_read_b128 v[48:51], v6 offset:15360
    ds_read_b128 v[52:55], v6 offset:31744
    ds_read_b64_tr_b16 v[72:73], v17 offset:53760
    ds_read_b64_tr_b16 v[74:75], v17 offset:54784
    ds_read_b64_tr_b16 v[96:97], v18 offset:0
    ds_read_b64_tr_b16 v[98:99], v18 offset:2048
    s_waitcnt lgkmcnt(10)
    v_mfma_f32_16x16x32_bf16 v[32:35], v[56:59], v[76:79], v[32:35]
    v_mfma_f32_16x16x32_bf16 v[36:39], v[60:63], v[76:79], v[36:39]
    s_waitcnt lgkmcnt(6)
    v_mfma_f32_16x16x32_bf16 v[32:35], v[64:67], v[80:83], v[32:35]
    v_mfma_f32_16x16x32_bf16 v[36:39], v[68:71], v[80:83], v[36:39]
    s_waitcnt lgkmcnt(2)
    v_mfma_f32_16x16x32_bf16 v[32:35], v[48:51], v[72:75], v[32:35]
    v_mfma_f32_16x16x32_bf16 v[36:39], v[52:55], v[72:75], v[36:39]
    s_waitcnt lgkmcnt(1)
    v_lshlrev_b32 v104, 16, v96
    v_and_b32 v105, 0xffff0000, v96
    s_nop 3
    v_add_f32 v32, v32, v104
    v_add_f32 v33, v33, v105
    v_cvt_pk_bf16_f32 v112, v32, v33
    v_lshlrev_b32 v104, 16, v97
    v_and_b32 v105, 0xffff0000, v97
    v_add_f32 v34, v34, v104
    v_add_f32 v35, v35, v105
    v_cvt_pk_bf16_f32 v113, v34, v35
    s_waitcnt lgkmcnt(0)
    v_lshlrev_b32 v104, 16, v98
    v_and_b32 v105, 0xffff0000, v98
    v_add_f32 v36, v36, v104
    v_add_f32 v37, v37, v105
    v_cvt_pk_bf16_f32 v114, v36, v37
    v_lshlrev_b32 v104, 16, v99
    v_and_b32 v105, 0xffff0000, v99
    v_add_f32 v38, v38, v104
    v_add_f32 v39, v39, v105
    v_cvt_pk_bf16_f32 v115, v38, v39
    s_lshl_b32 s39, s24, 1
    s_add_u32 s39, s39, s33
    s_mul_i32 s39, s39, 28672
    s_lshl_b32 s40, s23, 3
    s_lshl_b32 s41, s34, 1
    s_add_u32 s40, s40, s41
    s_lshl_b32 s40, s40, 9
    s_add_u32 s39, s39, s40
    s_add_u32 s39, s39, 0xa00000
    v_bfe_u32 v21, v1, 3, 1
    v_lshlrev_b32 v21, 9, v21
    v_lshl_add_u32 v21, v7, 7, v21
    v_and_b32 v22, 7, v1
    v_lshl_add_u32 v21, v22, 4, v21
    buffer_store_dwordx4 v[112:115], v21, s[16:19], s39 offen sc0 sc1
    v_and_b32 v22, 15, v1
    v_mul_u32_u24 v23, 136, v22
    v_lshl_add_u32 v23, v7, 3, v23
    s_mul_i32 s41, s34, 2176
    s_lshl_b32 s42, s33, 6
    s_add_u32 s41, s41, s42
    s_add_u32 s41, s41, 131072
    v_add_u32 v23, s41, v23
    ds_write_b64 v23, v[112:113] offset:0
    ds_write_b64 v23, v[114:115] offset:32
    v_lshl_add_u32 v24, v7, 2, v8
    v_mul_u32_u24 v24, 136, v24
    v_lshl_add_u32 v24, v9, 3, v24
    v_add_u32 v24, s41, v24
    ds_read_b64_tr_b16 v[120:121], v24 offset:0
    ds_read_b64_tr_b16 v[122:123], v24 offset:32
    s_lshl_b32 s42, s24, 2
    s_lshl_b32 s43, s33, 1
    s_add_u32 s42, s42, s43
    s_mul_i32 s43, s42, 14336
    s_lshl_b32 s44, s23, 4
    s_lshl_b32 s45, s34, 2
    s_add_u32 s44, s44, s45
    s_lshl_b32 s44, s44, 7
    s_add_u32 s43, s43, s44
    s_add_u32 s43, s43, 0x800000
    v_lshlrev_b32 v25, 7, v7
    v_lshl_add_u32 v25, v22, 3, v25
    v_mov_b32 v26, 0x3f803f80
    v_mov_b32 v28, 0
    v_mov_b32 v29, 0
    v_mov_b32 v30, 0
    v_mov_b32 v31, 0
    s_add_u32 s44, s43, 0
    s_waitcnt lgkmcnt(1)
    buffer_store_dwordx2 v[120:121], v25, s[16:19], s44 offen sc0 sc1
    v_dot2_f32_bf16 v28, v120, v26, v28
    v_dot2_f32_bf16 v29, v120, v120, v29
    v_dot2_f32_bf16 v28, v121, v26, v28
    v_dot2_f32_bf16 v29, v121, v121, v29
    s_add_u32 s44, s43, 14336
    s_waitcnt lgkmcnt(0)
    buffer_store_dwordx2 v[122:123], v25, s[16:19], s44 offen sc0 sc1
    v_dot2_f32_bf16 v30, v122, v26, v30
    v_dot2_f32_bf16 v31, v122, v122, v31
    v_dot2_f32_bf16 v30, v123, v26, v30
    v_dot2_f32_bf16 v31, v123, v123, v31
    v_cmp_gt_u32 vcc, 16, v1
    v_lshlrev_b32 v27, 2, v1
    s_lshl_b32 s44, s42, 7
    s_add_u32 s44, s44, 0x1000000
    v_mov_b32 v104, v28
    s_nop 1
    v_permlane16_swap_b32 v104, v28
    v_add_f32 v28, v28, v104
    v_mov_b32 v104, v28
    s_nop 1
    v_permlane32_swap_b32 v104, v28
    v_add_f32 v28, v28, v104
    v_mov_b32 v105, v29
    s_nop 1
    v_permlane16_swap_b32 v105, v29
    v_add_f32 v29, v29, v105
    v_mov_b32 v105, v29
    s_nop 1
    v_permlane32_swap_b32 v105, v29
    v_add_f32 v29, v29, v105
    v_cndmask_b32 v106, v29, v28, vcc
    v_mov_b32 v104, v30
    s_nop 1
    v_permlane16_swap_b32 v104, v30
    v_add_f32 v30, v30, v104
    v_mov_b32 v104, v30
    s_nop 1
    v_permlane32_swap_b32 v104, v30
    v_add_f32 v30, v30, v104
    v_mov_b32 v105, v31
    s_nop 1
    v_permlane16_swap_b32 v105, v31
    v_add_f32 v31, v31, v105
    v_mov_b32 v105, v31
    s_nop 1
    v_permlane32_swap_b32 v105, v31
    v_add_f32 v31, v31, v105
    v_cndmask_b32 v107, v31, v30, vcc
    s_mov_b64 exec, 0xffffffff
    buffer_atomic_add_f32 v106, v27, s[16:19], s44 offen
    buffer_atomic_add_f32 v107, v27, s[16:19], s44 offen offset:128
    s_mov_b64 exec, -1
    s_and_b32 s34, s2, 7
    s_lshl_b32 s34, s34, 7
    s_add_u32 s34, s34, 0x100d800
    s_waitcnt vmcnt(0) lgkmcnt(0)
    s_barrier
    v_mov_b32 v10, 0
    v_mov_b32 v11, 1
    v_cmp_eq_u32 vcc, 0, v0
    s_and_saveexec_b64 s[44:45], vcc
    s_cbranch_execz L_pub8
    buffer_atomic_add v11, v10, s[16:19], s34 offen sc1
L_pub8:
    s_mov_b64 exec, -1
L_pk3a_skip:
    s_nop 1
    s_cmp_ge_u32 s2, 224
    s_cbranch_scc1 L_pg1a_skip
    s_load_dwordx2 s[20:21], s[0:1], 80
    s_load_dwordx2 s[4:5], s[0:1], 32
    s_load_dwordx2 s[12:13], s[0:1], 40
    s_load_dwordx2 s[92:93], s[0:1], 48
    v_and_b32 v1, 63, v0
    v_lshrrev_b32 v2, 6, v0
    s_nop 0
    v_readfirstlane_b32 s22, v2
    s_and_b32 s25, s2, 7
    s_lshr_b32 s26, s2, 3
    s_and_b32 s24, s25, 1
    s_lshl_b32 s24, s24, 2
    s_and_b32 s27, s26, 3
    s_add_u32 s24, s24, s27
    s_lshr_b32 s23, s25, 1
    s_mul_i32 s23, s23, 7
    s_lshr_b32 s27, s26, 2
    s_add_u32 s23, s23, s27
    s_and_b32 s47, s22, 3
    s_lshr_b32 s48, s22, 2
    v_lshrrev_b32 v3, 3, v1
    v_bfe_u32 v4, v1, 4, 2
    v_lshlrev_b32 v4, 1, v4
    v_and_b32 v5, 7, v1
    v_xor_b32 v4, v4, v5
    v_mul_u32_u24 v5, 3584, v3
    v_lshl_add_u32 v5, v4, 4, v5
    s_mul_i32 s27, s47, 1835008
    s_mul_i32 s28, s48, 57344
    s_add_u32 s27, s27, s28
    s_lshl_b32 s28, s23, 7
    s_add_u32 s27, s27, s28
    v_add_u32 v5, s27, v5
    v_lshrrev_b32 v7, 4, v1
    v_and_b32 v8, 7, v1
    v_lshlrev_b32 v8, 4, v8
    v_lshl_add_u32 v8, v7, 7, v8
    v_bfe_u32 v9, v1, 3, 1
    v_lshl_add_u32 v6, v9, 9, v8
    s_cmp_eq_u32 s48, 0
    s_cselect_b64 s[50:51], -1, 0
    v_cndmask_b32 v9, v8, v6, s[50:51]
    s_waitcnt lgkmcnt(0)
    s_and_b32 s5, s5, 0xffff
    s_mov_b32 s6, 0x700000
    s_mov_b32 s7, 0x00020000
    s_mov_b32 s8, s20
    s_and_b32 s9, s21, 0xffff
    s_mov_b32 s10, 0x4000000
    s_mov_b32 s11, 0x00020000
    s_and_b32 s13, s13, 0xffff
    s_mov_b32 s14, 0xe00
    s_mov_b32 s15, 0x00020000
    s_mul_i32 s29, s47, 458752
    s_mul_i32 s30, s24, 3584
    s_add_u32 s29, s29, s30
    s_add_u32 s29, s29, 0xa00000
    s_lshl_b32 s30, s48, 11
    s_add_u32 s29, s29, s30
    s_mul_i32 s31, s47, 36864
    s_lshl_b32 s30, s48, 11
    s_add_u32 s49, s31, s30
    v_add_u32 v4, 27648, v5
    s_add_u32 m0, s49, 0
    s_mov_b32 s32, 0
    buffer_load_dwordx4 v5, s[4:7], s32 offen sc1 lds
    buffer_load_dwordx4 v4, s[4:7], s32 offen offset:1024 sc1 lds
    s_add_u32 m0, s49, 4096
    s_mov_b32 s32, 114688
    buffer_load_dwordx4 v5, s[4:7], s32 offen sc1 lds
    buffer_load_dwordx4 v4, s[4:7], s32 offen offset:1024 sc1 lds
    s_add_u32 m0, s49, 8192
    s_mov_b32 s32, 229376
    buffer_load_dwordx4 v5, s[4:7], s32 offen sc1 lds
    buffer_load_dwordx4 v4, s[4:7], s32 offen offset:1024 sc1 lds
    s_add_u32 m0, s49, 12288
    s_mov_b32 s32, 344064
    buffer_load_dwordx4 v5, s[4:7], s32 offen sc1 lds
    buffer_load_dwordx4 v4, s[4:7], s32 offen offset:1024 sc1 lds
    s_add_u32 m0, s49, 16384
    s_mov_b32 s32, 458752
    buffer_load_dwordx4 v5, s[4:7], s32 offen sc1 lds
    buffer_load_dwordx4 v4, s[4:7], s32 offen offset:1024 sc1 lds
    s_add_u32 m0, s49, 20480
    s_mov_b32 s32, 573440
    buffer_load_dwordx4 v5, s[4:7], s32 offen sc1 lds
    buffer_load_dwordx4 v4, s[4:7], s32 offen offset:1024 sc1 lds
    s_add_u32 m0, s49, 24576
    s_mov_b32 s32, 688128
    buffer_load_dwordx4 v5, s[4:7], s32 offen sc1 lds
    buffer_load_dwordx4 v4, s[4:7], s32 offen offset:1024 sc1 lds
    s_add_u32 m0, s49, 28672
    s_mov_b32 s32, 802816
    buffer_load_dwordx4 v5, s[4:7], s32 offen sc1 lds
    buffer_load_dwordx4 v4, s[4:7], s32 offen offset:1024 sc1 lds
    s_add_u32 m0, s49, 32768
    s_mov_b32 s32, 917504
    buffer_load_dwordx4 v5, s[4:7], s32 offen sc1 lds
    buffer_load_dwordx4 v4, s[4:7], s32 offen offset:1024 sc1 lds
    s_lshr_b32 s36, s47, 1
    s_lshl_b32 s37, s23, 7
    s_lshl_b32 s38, s36, 6
    s_add_u32 s37, s37, s38
    v_lshlrev_b32 v33, 3, v7
    buffer_load_dwordx2 v[100:101], v33, s[12:15], s37 offen sc1
    buffer_load_dwordx2 v[102:103], v33, s[12:15], s37 offen offset:32 sc1
    s_mov_b32 s34, 0x100d800
    v_lshlrev_b32 v10, 7, v1
    s_cmp_lg_u32 s22, 0
    s_cbranch_scc1 L_aww9
    s_mov_b64 exec, 0xff
    s_mov_b32 s45, 0x40000
L_awp9:
    buffer_load_dword v168, v10, s[8:11], s34 offen sc0 sc1
    s_waitcnt vmcnt(0)
    v_cmp_gt_u32 vcc, 28, v168
    s_cbranch_vccz L_awd9
    s_sub_u32 s45, s45, 1
    s_cmp_lg_u32 s45, 0
    s_cbranch_scc1 L_awp9
L_awd9:
    s_mov_b64 exec, -1
L_aww9:
    s_nop 0
    s_barrier
    v_lshrrev_b32 v10, 2, v1
    v_lshlrev_b32 v10, 7, v10
    v_and_b32 v11, 3, v1
    v_lshl_add_u32 v10, v11, 4, v10
    s_lshl_b32 s34, s22, 11
    s_add_u32 s34, s34, 0x1000000
    buffer_load_dwordx4 v[16:19], v10, s[8:11], s34 offen sc1
    buffer_load_dwordx4 v[20:23], v10, s[8:11], s34 offen offset:64 sc1
    s_add_u32 s33, s29, 0
    buffer_load_dwordx4 v[112:115], v6, s[8:11], s33 offen sc1
    buffer_load_dwordx4 v[116:119], v9, s[8:11], s33 offen offset:1024 sc1
    s_barrier
    s_add_u32 s33, s29, 28672
    buffer_load_dwordx4 v[120:123], v6, s[8:11], s33 offen sc1
    buffer_load_dwordx4 v[124:127], v9, s[8:11], s33 offen offset:1024 sc1
    s_add_u32 s33, s29, 57344
    buffer_load_dwordx4 v[128:131], v6, s[8:11], s33 offen sc1
    buffer_load_dwordx4 v[132:135], v9, s[8:11], s33 offen offset:1024 sc1
    s_add_u32 s33, s29, 86016
    buffer_load_dwordx4 v[136:139], v6, s[8:11], s33 offen sc1
    buffer_load_dwordx4 v[140:143], v9, s[8:11], s33 offen offset:1024 sc1
    s_add_u32 s33, s29, 114688
    buffer_load_dwordx4 v[144:147], v6, s[8:11], s33 offen sc1
    buffer_load_dwordx4 v[148:151], v9, s[8:11], s33 offen offset:1024 sc1
    s_add_u32 s33, s29, 143360
    buffer_load_dwordx4 v[152:155], v6, s[8:11], s33 offen sc1
    buffer_load_dwordx4 v[156:159], v9, s[8:11], s33 offen offset:1024 sc1
    s_add_u32 s33, s29, 172032
    buffer_load_dwordx4 v[160:163], v6, s[8:11], s33 offen sc1
    buffer_load_dwordx4 v[164:167], v9, s[8:11], s33 offen offset:1024 sc1
    v_bfe_u32 v12, v1, 2, 2
    v_and_b32 v13, 3, v1
    v_and_b32 v14, 1, v7
    v_lshlrev_b32 v15, 2, v7
    v_add_u32 v15, v15, v12
    v_lshlrev_b32 v15, 7, v15
    v_lshl_add_u32 v15, v13, 3, v15
    v_add_u32 v15, s31, v15
    v_lshrrev_b32 v32, 1, v12
    v_lshl_add_u32 v32, v14, 1, v32
    v_xor_b32 v33, 0, v32
    v_lshl_add_u32 v36, v33, 5, v15
    v_xor_b32 v33, 1, v32
    v_lshl_add_u32 v37, v33, 5, v15
    v_xor_b32 v33, 2, v32
    v_lshl_add_u32 v38, v33, 5, v15
    v_xor_b32 v33, 3, v32
    v_lshl_add_u32 v39, v33, 5, v15
    s_waitcnt vmcnt(15)
    v_mul_f32 v16, 0x3b124925, v16
    s_waitcnt vmcnt(14)
    v_mul_f32 v20, 0x3b124925, v20
    v_fma_f32 v20, -v16, v16, v20
    v_max_f32 v20, 0, v20
    v_add_f32 v34, 0x3727c5ac, v20
    v_rcp_f32 v34, v34
    s_nop 0
    v_mul_f32 v35, v20, v34
    v_add_f32 v35, 0x3727c5ac, v35
    v_rcp_f32 v35, v35
    s_nop 0
    v_mul_f32 v34, v34, v35
    v_sqrt_f32 v20, v34
    s_nop 0
    v_mul_f32 v16, -v16, v20
    v_mul_f32 v17, 0x3b124925, v17
    v_mul_f32 v21, 0x3b124925, v21
    v_fma_f32 v21, -v17, v17, v21
    v_max_f32 v21, 0, v21
    v_add_f32 v34, 0x3727c5ac, v21
    v_rcp_f32 v34, v34
    s_nop 0
    v_mul_f32 v35, v21, v34
    v_add_f32 v35, 0x3727c5ac, v35
    v_rcp_f32 v35, v35
    s_nop 0
    v_mul_f32 v34, v34, v35
    v_sqrt_f32 v21, v34
    s_nop 0
    v_mul_f32 v17, -v17, v21
    v_mul_f32 v18, 0x3b124925, v18
    v_mul_f32 v22, 0x3b124925, v22
    v_fma_f32 v22, -v18, v18, v22
    v_max_f32 v22, 0, v22
    v_add_f32 v34, 0x3727c5ac, v22
    v_rcp_f32 v34, v34
    s_nop 0
    v_mul_f32 v35, v22, v34
    v_add_f32 v35, 0x3727c5ac, v35
    v_rcp_f32 v35, v35
    s_nop 0
    v_mul_f32 v34, v34, v35
    v_sqrt_f32 v22, v34
    s_nop 0
    v_mul_f32 v18, -v18, v22
    v_mul_f32 v19, 0x3b124925, v19
    v_mul_f32 v23, 0x3b124925, v23
    v_fma_f32 v23, -v19, v19, v23
    v_max_f32 v23, 0, v23
    v_add_f32 v34, 0x3727c5ac, v23
    v_rcp_f32 v34, v34
    s_nop 0
    v_mul_f32 v35, v23, v34
    v_add_f32 v35, 0x3727c5ac, v35
    v_rcp_f32 v35, v35
    s_nop 0
    v_mul_f32 v34, v34, v35
    v_sqrt_f32 v23, v34
    s_nop 0
    v_mul_f32 v19, -v19, v23
    v_lshlrev_b32 v34, 4, v1
    s_lshl_b32 s34, s22, 10
    s_add_u32 s34, s34, 147456
    v_add_u32 v34, s34, v34
    ds_write_b128 v34, v[20:23]
    ds_write_b128 v34, v[16:19] offset:8192
    v_lshlrev_b32 v35, 4, v7
    s_lshl_b32 s34, s47, 11
    s_add_u32 s34, s34, 147456
    v_add_u32 v35, s34, v35
    s_waitcnt vmcnt(12)
    s_waitcnt lgkmcnt(0)
    s_barrier
    ds_read_b64_tr_b16 a[0:1], v36 offset:0
    ds_read_b64_tr_b16 a[2:3], v36 offset:2048
    ds_read_b64_tr_b16 a[4:5], v37 offset:0
    ds_read_b64_tr_b16 a[6:7], v37 offset:2048
    ds_read_b64_tr_b16 a[8:9], v38 offset:0
    ds_read_b64_tr_b16 a[10:11], v38 offset:2048
    ds_read_b64_tr_b16 a[12:13], v39 offset:0
    ds_read_b64_tr_b16 a[14:15], v39 offset:2048
    ds_read_b128 v[56:59], v35 offset:0
    ds_read_b128 v[64:67], v35 offset:8192
    ds_read_b128 v[60:63], v35 offset:64
    ds_read_b128 v[68:71], v35 offset:8256
    ds_read_b128 v[72:75], v35 offset:128
    ds_read_b128 v[80:83], v35 offset:8320
    ds_read_b128 v[76:79], v35 offset:192
    s_waitcnt lgkmcnt(13)
    ds_read_b128 v[84:87], v35 offset:8384
    v_lshlrev_b32 v88, 16, v112
    v_and_b32 v89, 0xffff0000, v112
    v_lshlrev_b32 v90, 16, v113
    v_and_b32 v91, 0xffff0000, v113
    s_waitcnt lgkmcnt(6)
    v_fma_f32 v88, v88, v56, v64
    v_fma_f32 v89, v89, v57, v65
    v_fma_f32 v90, v90, v58, v66
    v_fma_f32 v91, v91, v59, v67
    v_cvt_pk_bf16_f32 v40, v88, v89
    v_cvt_pk_bf16_f32 v41, v90, v91
    v_lshlrev_b32 v92, 16, v114
    v_and_b32 v93, 0xffff0000, v114
    v_lshlrev_b32 v94, 16, v115
    v_and_b32 v95, 0xffff0000, v115
    s_waitcnt lgkmcnt(4)
    v_fma_f32 v92, v92, v60, v68
    v_fma_f32 v93, v93, v61, v69
    v_fma_f32 v94, v94, v62, v70
    v_fma_f32 v95, v95, v63, v71
    v_cvt_pk_bf16_f32 v42, v92, v93
    v_cvt_pk_bf16_f32 v43, v94, v95
    v_lshlrev_b32 v88, 16, v116
    v_and_b32 v89, 0xffff0000, v116
    v_lshlrev_b32 v90, 16, v117
    v_and_b32 v91, 0xffff0000, v117
    v_fma_f32 v88, v88, v56, v64
    v_fma_f32 v89, v89, v57, v65
    v_fma_f32 v90, v90, v58, v66
    v_fma_f32 v91, v91, v59, v67
    v_cvt_pk_bf16_f32 v44, v88, v89
    v_cvt_pk_bf16_f32 v45, v90, v91
    v_lshlrev_b32 v92, 16, v118
    v_and_b32 v93, 0xffff0000, v118
    v_lshlrev_b32 v94, 16, v119
    v_and_b32 v95, 0xffff0000, v119
    v_fma_f32 v92, v92, v60, v68
    v_fma_f32 v93, v93, v61, v69
    v_fma_f32 v94, v94, v62, v70
    v_fma_f32 v95, v95, v63, v71
    v_cvt_pk_bf16_f32 v46, v92, v93
    v_cvt_pk_bf16_f32 v47, v94, v95
    v_mfma_f32_16x16x32_bf16 a[32:35], a[0:3], v[40:43], 0
    s_waitcnt vmcnt(8)
    s_barrier
    ds_read_b64_tr_b16 a[16:17], v36 offset:4096
    ds_read_b64_tr_b16 a[18:19], v36 offset:6144
    ds_read_b64_tr_b16 a[20:21], v37 offset:4096
    ds_read_b64_tr_b16 a[22:23], v37 offset:6144
    ds_read_b64_tr_b16 a[24:25], v38 offset:4096
    v_mfma_f32_16x16x32_bf16 a[40:43], a[4:7], v[40:43], 0
    ds_read_b64_tr_b16 a[26:27], v38 offset:6144
    ds_read_b64_tr_b16 a[28:29], v39 offset:4096
    ds_read_b64_tr_b16 a[30:31], v39 offset:6144
    v_lshlrev_b32 v88, 16, v120
    v_and_b32 v89, 0xffff0000, v120
    v_lshlrev_b32 v90, 16, v121
    v_and_b32 v91, 0xffff0000, v121
    v_mfma_f32_16x16x32_bf16 a[48:51], a[8:11], v[40:43], 0
    s_waitcnt lgkmcnt(10)
    v_fma_f32 v88, v88, v72, v80
    v_fma_f32 v89, v89, v73, v81
    v_fma_f32 v90, v90, v74, v82
    v_fma_f32 v91, v91, v75, v83
    v_cvt_pk_bf16_f32 v48, v88, v89
    v_cvt_pk_bf16_f32 v49, v90, v91
    v_lshlrev_b32 v92, 16, v122
    v_mfma_f32_16x16x32_bf16 a[56:59], a[12:15], v[40:43], 0
    v_and_b32 v93, 0xffff0000, v122
    v_lshlrev_b32 v94, 16, v123
    v_and_b32 v95, 0xffff0000, v123
    s_waitcnt lgkmcnt(8)
    v_fma_f32 v92, v92, v76, v84
    v_fma_f32 v93, v93, v77, v85
    v_fma_f32 v94, v94, v78, v86
    v_fma_f32 v95, v95, v79, v87
    v_mfma_f32_16x16x32_bf16 a[36:39], a[0:3], v[44:47], 0
    v_cvt_pk_bf16_f32 v50, v92, v93
    v_cvt_pk_bf16_f32 v51, v94, v95
    v_lshlrev_b32 v88, 16, v124
    v_and_b32 v89, 0xffff0000, v124
    s_add_u32 s33, s29, 200704
    buffer_load_dwordx4 v[168:171], v6, s[8:11], s33 offen sc1
    v_lshlrev_b32 v90, 16, v125
    v_and_b32 v91, 0xffff0000, v125
    v_mfma_f32_16x16x32_bf16 a[44:47], a[4:7], v[44:47], 0
    v_fma_f32 v88, v88, v72, v80
    v_fma_f32 v89, v89, v73, v81
    v_fma_f32 v90, v90, v74, v82
    v_fma_f32 v91, v91, v75, v83
    v_cvt_pk_bf16_f32 v52, v88, v89
    v_cvt_pk_bf16_f32 v53, v90, v91
    v_lshlrev_b32 v92, 16, v126
    v_mfma_f32_16x16x32_bf16 a[52:55], a[8:11], v[44:47], 0
    v_and_b32 v93, 0xffff0000, v126
    v_lshlrev_b32 v94, 16, v127
    v_and_b32 v95, 0xffff0000, v127
    v_fma_f32 v92, v92, v76, v84
    v_fma_f32 v93, v93, v77, v85
    v_fma_f32 v94, v94, v78, v86
    v_fma_f32 v95, v95, v79, v87
    v_mfma_f32_16x16x32_bf16 a[60:63], a[12:15], v[44:47], 0
    v_cvt_pk_bf16_f32 v54, v92, v93
    v_cvt_pk_bf16_f32 v55, v94, v95
    ds_read_b128 v[56:59], v35 offset:256
    ds_read_b128 v[64:67], v35 offset:8448
    ds_read_b128 v[60:63], v35 offset:320
    ds_read_b128 v[68:71], v35 offset:8512
    buffer_load_dwordx4 v[172:175], v9, s[8:11], s33 offen offset:1024 sc1
    s_waitcnt lgkmcnt(10)
    v_mfma_f32_16x16x32_bf16 a[32:35], a[16:19], v[48:51], a[32:35]
    ds_read_b64_tr_b16 a[0:1], v36 offset:8192
    ds_read_b64_tr_b16 a[2:3], v36 offset:10240
    ds_read_b64_tr_b16 a[4:5], v37 offset:8192
    ds_read_b64_tr_b16 a[6:7], v37 offset:10240
    ds_read_b64_tr_b16 a[8:9], v38 offset:8192
    s_waitcnt lgkmcnt(13)
    ds_read_b64_tr_b16 a[10:11], v38 offset:10240
    v_mfma_f32_16x16x32_bf16 a[40:43], a[20:23], v[48:51], a[40:43]
    ds_read_b64_tr_b16 a[12:13], v39 offset:8192
    s_waitcnt lgkmcnt(13)
    ds_read_b64_tr_b16 a[14:15], v39 offset:10240
    v_lshlrev_b32 v88, 16, v128
    v_and_b32 v89, 0xffff0000, v128
    v_lshlrev_b32 v90, 16, v129
    v_and_b32 v91, 0xffff0000, v129
    s_waitcnt lgkmcnt(10)
    v_fma_f32 v88, v88, v56, v64
    v_mfma_f32_16x16x32_bf16 a[48:51], a[24:27], v[48:51], a[48:51]
    v_fma_f32 v89, v89, v57, v65
    v_fma_f32 v90, v90, v58, v66
    v_fma_f32 v91, v91, v59, v67
    v_cvt_pk_bf16_f32 v40, v88, v89
    v_cvt_pk_bf16_f32 v41, v90, v91
    v_lshlrev_b32 v92, 16, v130
    v_and_b32 v93, 0xffff0000, v130
    v_mfma_f32_16x16x32_bf16 a[56:59], a[28:31], v[48:51], a[56:59]
    v_lshlrev_b32 v94, 16, v131
    v_and_b32 v95, 0xffff0000, v131
    s_waitcnt lgkmcnt(8)
    v_fma_f32 v92, v92, v60, v68
    v_fma_f32 v93, v93, v61, v69
    v_fma_f32 v94, v94, v62, v70
    v_fma_f32 v95, v95, v63, v71
    v_cvt_pk_bf16_f32 v42, v92, v93
    v_mfma_f32_16x16x32_bf16 a[36:39], a[16:19], v[52:55], a[36:39]
    v_cvt_pk_bf16_f32 v43, v94, v95
    v_lshlrev_b32 v88, 16, v132
    v_and_b32 v89, 0xffff0000, v132
    s_add_u32 s33, s29, 229376
    buffer_load_dwordx4 v[112:115], v6, s[8:11], s33 offen sc1
    v_lshlrev_b32 v90, 16, v133
    v_and_b32 v91, 0xffff0000, v133
    v_mfma_f32_16x16x32_bf16 a[44:47], a[20:23], v[52:55], a[44:47]
    v_fma_f32 v88, v88, v56, v64
    v_fma_f32 v89, v89, v57, v65
    v_fma_f32 v90, v90, v58, v66
    v_fma_f32 v91, v91, v59, v67
    v_cvt_pk_bf16_f32 v44, v88, v89
    v_cvt_pk_bf16_f32 v45, v90, v91
    v_lshlrev_b32 v92, 16, v134
    v_mfma_f32_16x16x32_bf16 a[52:55], a[24:27], v[52:55], a[52:55]
    v_and_b32 v93, 0xffff0000, v134
    v_lshlrev_b32 v94, 16, v135
    v_and_b32 v95, 0xffff0000, v135
    v_fma_f32 v92, v92, v60, v68
    v_fma_f32 v93, v93, v61, v69
    v_fma_f32 v94, v94, v62, v70
    v_fma_f32 v95, v95, v63, v71
    v_mfma_f32_16x16x32_bf16 a[60:63], a[28:31], v[52:55], a[60:63]
    v_cvt_pk_bf16_f32 v46, v92, v93
    v_cvt_pk_bf16_f32 v47, v94, v95
    ds_read_b128 v[72:75], v35 offset:384
    ds_read_b128 v[80:83], v35 offset:8576
    ds_read_b128 v[76:79], v35 offset:448
    ds_read_b128 v[84:87], v35 offset:8640
    buffer_load_dwordx4 v[116:119], v9, s[8:11], s33 offen offset:1024 sc1
    s_waitcnt lgkmcnt(10)
    v_mfma_f32_16x16x32_bf16 a[32:35], a[0:3], v[40:43], a[32:35]
    s_waitcnt vmcnt(8)
    s_barrier
    ds_read_b64_tr_b16 a[16:17], v36 offset:12288
    ds_read_b64_tr_b16 a[18:19], v36 offset:14336
    ds_read_b64_tr_b16 a[20:21], v37 offset:12288
    ds_read_b64_tr_b16 a[22:23], v37 offset:14336
    ds_read_b64_tr_b16 a[24:25], v38 offset:12288
    s_waitcnt lgkmcnt(13)
    ds_read_b64_tr_b16 a[26:27], v38 offset:14336
    v_mfma_f32_16x16x32_bf16 a[40:43], a[4:7], v[40:43], a[40:43]
    ds_read_b64_tr_b16 a[28:29], v39 offset:12288
    s_waitcnt lgkmcnt(13)
    ds_read_b64_tr_b16 a[30:31], v39 offset:14336
    v_lshlrev_b32 v88, 16, v136
    v_and_b32 v89, 0xffff0000, v136
    v_lshlrev_b32 v90, 16, v137
    v_and_b32 v91, 0xffff0000, v137
    s_waitcnt lgkmcnt(10)
    v_fma_f32 v88, v88, v72, v80
    v_mfma_f32_16x16x32_bf16 a[48:51], a[8:11], v[40:43], a[48:51]
    v_fma_f32 v89, v89, v73, v81
    v_fma_f32 v90, v90, v74, v82
    v_fma_f32 v91, v91, v75, v83
    v_cvt_pk_bf16_f32 v48, v88, v89
    v_cvt_pk_bf16_f32 v49, v90, v91
    v_lshlrev_b32 v92, 16, v138
    s_add_u32 m0, s49, 0
    s_mov_b32 s32, 1032192
    buffer_load_dwordx4 v5, s[4:7], s32 offen sc1 lds
    v_mfma_f32_16x16x32_bf16 a[56:59], a[12:15], v[40:43], a[56:59]
    v_and_b32 v93, 0xffff0000, v138
    v_lshlrev_b32 v94, 16, v139
    v_and_b32 v95, 0xffff0000, v139
    s_waitcnt lgkmcnt(8)
    v_fma_f32 v92, v92, v76, v84
    v_fma_f32 v93, v93, v77, v85
    v_fma_f32 v94, v94, v78, v86
    v_fma_f32 v95, v95, v79, v87
    v_mfma_f32_16x16x32_bf16 a[36:39], a[0:3], v[44:47], a[36:39]
    v_cvt_pk_bf16_f32 v50, v92, v93
    v_cvt_pk_bf16_f32 v51, v94, v95
    v_lshlrev_b32 v88, 16, v140
    v_and_b32 v89, 0xffff0000, v140
    buffer_load_dwordx4 v4, s[4:7], s32 offen offset:1024 sc1 lds
    v_lshlrev_b32 v90, 16, v141
    v_and_b32 v91, 0xffff0000, v141
    v_mfma_f32_16x16x32_bf16 a[44:47], a[4:7], v[44:47], a[44:47]
    v_fma_f32 v88, v88, v72, v80
    v_fma_f32 v89, v89, v73, v81
    v_fma_f32 v90, v90, v74, v82
    v_fma_f32 v91, v91, v75, v83
    v_cvt_pk_bf16_f32 v52, v88, v89
    v_cvt_pk_bf16_f32 v53, v90, v91
    v_lshlrev_b32 v92, 16, v142
    v_mfma_f32_16x16x32_bf16 a[52:55], a[8:11], v[44:47], a[52:55]
    v_and_b32 v93, 0xffff0000, v142
    v_lshlrev_b32 v94, 16, v143
    s_add_u32 s33, s29, 258048
    buffer_load_dwordx4 v[120:123], v6, s[8:11], s33 offen sc1
    v_and_b32 v95, 0xffff0000, v143
    v_fma_f32 v92, v92, v76, v84
    v_fma_f32 v93, v93, v77, v85
    v_fma_f32 v94, v94, v78, v86
    v_mfma_f32_16x16x32_bf16 a[60:63], a[12:15], v[44:47], a[60:63]
    v_fma_f32 v95, v95, v79, v87
    v_cvt_pk_bf16_f32 v54, v92, v93
    v_cvt_pk_bf16_f32 v55, v94, v95
    ds_read_b128 v[56:59], v35 offset:512
    ds_read_b128 v[64:67], v35 offset:8704
    ds_read_b128 v[60:63], v35 offset:576
    ds_read_b128 v[68:71], v35 offset:8768
    buffer_load_dwordx4 v[124:127], v9, s[8:11], s33 offen offset:1024 sc1
    s_waitcnt lgkmcnt(10)
    v_mfma_f32_16x16x32_bf16 a[32:35], a[16:19], v[48:51], a[32:35]
    ds_read_b64_tr_b16 a[0:1], v36 offset:16384
    ds_read_b64_tr_b16 a[2:3], v36 offset:18432
    ds_read_b64_tr_b16 a[4:5], v37 offset:16384
    ds_read_b64_tr_b16 a[6:7], v37 offset:18432
    ds_read_b64_tr_b16 a[8:9], v38 offset:16384
    s_waitcnt lgkmcnt(13)
    ds_read_b64_tr_b16 a[10:11], v38 offset:18432
    ds_read_b64_tr_b16 a[12:13], v39 offset:16384
    v_mfma_f32_16x16x32_bf16 a[40:43], a[20:23], v[48:51], a[40:43]
    s_waitcnt lgkmcnt(13)
    ds_read_b64_tr_b16 a[14:15], v39 offset:18432
    v_lshlrev_b32 v88, 16, v144
    v_and_b32 v89, 0xffff0000, v144
    v_lshlrev_b32 v90, 16, v145
    v_and_b32 v91, 0xffff0000, v145
    s_waitcnt lgkmcnt(10)
    v_fma_f32 v88, v88, v56, v64
    v_fma_f32 v89, v89, v57, v65
    v_mfma_f32_16x16x32_bf16 a[48:51], a[24:27], v[48:51], a[48:51]
    v_fma_f32 v90, v90, v58, v66
    v_fma_f32 v91, v91, v59, v67
    v_cvt_pk_bf16_f32 v40, v88, v89
    v_cvt_pk_bf16_f32 v41, v90, v91
    v_lshlrev_b32 v92, 16, v146
    s_add_u32 m0, s49, 4096
    s_mov_b32 s32, 1146880
    buffer_load_dwordx4 v5, s[4:7], s32 offen sc1 lds
    v_and_b32 v93, 0xffff0000, v146
    v_mfma_f32_16x16x32_bf16 a[56:59], a[28:31], v[48:51], a[56:59]
    v_lshlrev_b32 v94, 16, v147
    v_and_b32 v95, 0xffff0000, v147
    s_waitcnt lgkmcnt(8)
    v_fma_f32 v92, v92, v60, v68
    v_fma_f32 v93, v93, v61, v69
    v_fma_f32 v94, v94, v62, v70
    v_fma_f32 v95, v95, v63, v71
    v_cvt_pk_bf16_f32 v42, v92, v93
    v_mfma_f32_16x16x32_bf16 a[36:39], a[16:19], v[52:55], a[36:39]
    v_cvt_pk_bf16_f32 v43, v94, v95
    v_lshlrev_b32 v88, 16, v148
    v_and_b32 v89, 0xffff0000, v148
    buffer_load_dwordx4 v4, s[4:7], s32 offen offset:1024 sc1 lds
    v_lshlrev_b32 v90, 16, v149
    v_and_b32 v91, 0xffff0000, v149
    v_fma_f32 v88, v88, v56, v64
    v_mfma_f32_16x16x32_bf16 a[44:47], a[20:23], v[52:55], a[44:47]
    v_fma_f32 v89, v89, v57, v65
    v_fma_f32 v90, v90, v58, v66
    v_fma_f32 v91, v91, v59, v67
    v_cvt_pk_bf16_f32 v44, v88, v89
    v_cvt_pk_bf16_f32 v45, v90, v91
    v_lshlrev_b32 v92, 16, v150
    v_and_b32 v93, 0xffff0000, v150
    v_mfma_f32_16x16x32_bf16 a[52:55], a[24:27], v[52:55], a[52:55]
    v_lshlrev_b32 v94, 16, v151
    s_add_u32 s33, s29, 286720
    buffer_load_dwordx4 v[128:131], v6, s[8:11], s33 offen sc1
    v_and_b32 v95, 0xffff0000, v151
    v_fma_f32 v92, v92, v60, v68
    v_fma_f32 v93, v93, v61, v69
    v_fma_f32 v94, v94, v62, v70
    v_fma_f32 v95, v95, v63, v71
    v_mfma_f32_16x16x32_bf16 a[60:63], a[28:31], v[52:55], a[60:63]
    v_cvt_pk_bf16_f32 v46, v92, v93
    v_cvt_pk_bf16_f32 v47, v94, v95
    ds_read_b128 v[72:75], v35 offset:640
    ds_read_b128 v[80:83], v35 offset:8832
    ds_read_b128 v[76:79], v35 offset:704
    ds_read_b128 v[84:87], v35 offset:8896
    buffer_load_dwordx4 v[132:135], v9, s[8:11], s33 offen offset:1024 sc1
    s_waitcnt lgkmcnt(10)
    v_mfma_f32_16x16x32_bf16 a[32:35], a[0:3], v[40:43], a[32:35]
    s_waitcnt vmcnt(12)
    s_barrier
    ds_read_b64_tr_b16 a[16:17], v36 offset:20480
    ds_read_b64_tr_b16 a[18:19], v36 offset:22528
    ds_read_b64_tr_b16 a[20:21], v37 offset:20480
    ds_read_b64_tr_b16 a[22:23], v37 offset:22528
    ds_read_b64_tr_b16 a[24:25], v38 offset:20480
    s_waitcnt lgkmcnt(13)
    ds_read_b64_tr_b16 a[26:27], v38 offset:22528
    v_mfma_f32_16x16x32_bf16 a[40:43], a[4:7], v[40:43], a[40:43]
    ds_read_b64_tr_b16 a[28:29], v39 offset:20480
    s_waitcnt lgkmcnt(13)
    ds_read_b64_tr_b16 a[30:31], v39 offset:22528
    v_lshlrev_b32 v88, 16, v152
    v_and_b32 v89, 0xffff0000, v152
    v_lshlrev_b32 v90, 16, v153
    v_and_b32 v91, 0xffff0000, v153
    s_waitcnt lgkmcnt(10)
    v_fma_f32 v88, v88, v72, v80
    v_mfma_f32_16x16x32_bf16 a[48:51], a[8:11], v[40:43], a[48:51]
    v_fma_f32 v89, v89, v73, v81
    v_fma_f32 v90, v90, v74, v82
    v_fma_f32 v91, v91, v75, v83
    v_cvt_pk_bf16_f32 v48, v88, v89
    v_cvt_pk_bf16_f32 v49, v90, v91
    v_lshlrev_b32 v92, 16, v154
    s_add_u32 m0, s49, 8192
    s_mov_b32 s32, 1261568
    buffer_load_dwordx4 v5, s[4:7], s32 offen sc1 lds
    v_mfma_f32_16x16x32_bf16 a[56:59], a[12:15], v[40:43], a[56:59]
    v_and_b32 v93, 0xffff0000, v154
    v_lshlrev_b32 v94, 16, v155
    v_and_b32 v95, 0xffff0000, v155
    s_waitcnt lgkmcnt(8)
    v_fma_f32 v92, v92, v76, v84
    v_fma_f32 v93, v93, v77, v85
    v_fma_f32 v94, v94, v78, v86
    v_fma_f32 v95, v95, v79, v87
    v_mfma_f32_16x16x32_bf16 a[36:39], a[0:3], v[44:47], a[36:39]
    v_cvt_pk_bf16_f32 v50, v92, v93
    v_cvt_pk_bf16_f32 v51, v94, v95
    v_lshlrev_b32 v88, 16, v156
    v_and_b32 v89, 0xffff0000, v156
    buffer_load_dwordx4 v4, s[4:7], s32 offen offset:1024 sc1 lds
    v_lshlrev_b32 v90, 16, v157
    v_and_b32 v91, 0xffff0000, v157
    v_mfma_f32_16x16x32_bf16 a[44:47], a[4:7], v[44:47], a[44:47]
    v_fma_f32 v88, v88, v72, v80
    v_fma_f32 v89, v89, v73, v81
    v_fma_f32 v90, v90, v74, v82
    v_fma_f32 v91, v91, v75, v83
    v_cvt_pk_bf16_f32 v52, v88, v89
    v_cvt_pk_bf16_f32 v53, v90, v91
    v_lshlrev_b32 v92, 16, v158
    v_mfma_f32_16x16x32_bf16 a[52:55], a[8:11], v[44:47], a[52:55]
    v_and_b32 v93, 0xffff0000, v158
    v_lshlrev_b32 v94, 16, v159
    s_add_u32 s33, s29, 315392
    buffer_load_dwordx4 v[136:139], v6, s[8:11], s33 offen sc1
    v_and_b32 v95, 0xffff0000, v159
    v_fma_f32 v92, v92, v76, v84
    v_fma_f32 v93, v93, v77, v85
    v_fma_f32 v94, v94, v78, v86
    v_mfma_f32_16x16x32_bf16 a[60:63], a[12:15], v[44:47], a[60:63]
    v_fma_f32 v95, v95, v79, v87
    v_cvt_pk_bf16_f32 v54, v92, v93
    v_cvt_pk_bf16_f32 v55, v94, v95
    ds_read_b128 v[56:59], v35 offset:768
    ds_read_b128 v[64:67], v35 offset:8960
    ds_read_b128 v[60:63], v35 offset:832
    ds_read_b128 v[68:71], v35 offset:9024
    buffer_load_dwordx4 v[140:143], v9, s[8:11], s33 offen offset:1024 sc1
    s_waitcnt lgkmcnt(10)
    v_mfma_f32_16x16x32_bf16 a[32:35], a[16:19], v[48:51], a[32:35]
    ds_read_b64_tr_b16 a[0:1], v36 offset:24576
    ds_read_b64_tr_b16 a[2:3], v36 offset:26624
    ds_read_b64_tr_b16 a[4:5], v37 offset:24576
    ds_read_b64_tr_b16 a[6:7], v37 offset:26624
    ds_read_b64_tr_b16 a[8:9], v38 offset:24576
    s_waitcnt lgkmcnt(13)
    ds_read_b64_tr_b16 a[10:11], v38 offset:26624
    ds_read_b64_tr_b16 a[12:13], v39 offset:24576
    v_mfma_f32_16x16x32_bf16 a[40:43], a[20:23], v[48:51], a[40:43]
    s_waitcnt lgkmcnt(13)
    ds_read_b64_tr_b16 a[14:15], v39 offset:26624
    v_lshlrev_b32 v88, 16, v160
    v_and_b32 v89, 0xffff0000, v160
    v_lshlrev_b32 v90, 16, v161
    v_and_b32 v91, 0xffff0000, v161
    s_waitcnt lgkmcnt(10)
    v_fma_f32 v88, v88, v56, v64
    v_fma_f32 v89, v89, v57, v65
    v_mfma_f32_16x16x32_bf16 a[48:51], a[24:27], v[48:51], a[48:51]
    v_fma_f32 v90, v90, v58, v66
    v_fma_f32 v91, v91, v59, v67
    v_cvt_pk_bf16_f32 v40, v88, v89
    v_cvt_pk_bf16_f32 v41, v90, v91
    v_lshlrev_b32 v92, 16, v162
    s_add_u32 m0, s49, 12288
    s_mov_b32 s32, 1376256
    buffer_load_dwordx4 v5, s[4:7], s32 offen sc1 lds
    v_and_b32 v93, 0xffff0000, v162
    v_mfma_f32_16x16x32_bf16 a[56:59], a[28:31], v[48:51], a[56:59]
    v_lshlrev_b32 v94, 16, v163
    v_and_b32 v95, 0xffff0000, v163
    s_waitcnt lgkmcnt(8)
    v_fma_f32 v92, v92, v60, v68
    v_fma_f32 v93, v93, v61, v69
    v_fma_f32 v94, v94, v62, v70
    v_fma_f32 v95, v95, v63, v71
    v_cvt_pk_bf16_f32 v42, v92, v93
    v_mfma_f32_16x16x32_bf16 a[36:39], a[16:19], v[52:55], a[36:39]
    v_cvt_pk_bf16_f32 v43, v94, v95
    v_lshlrev_b32 v88, 16, v164
    v_and_b32 v89, 0xffff0000, v164
    buffer_load_dwordx4 v4, s[4:7], s32 offen offset:1024 sc1 lds
    v_lshlrev_b32 v90, 16, v165
    v_and_b32 v91, 0xffff0000, v165
    v_fma_f32 v88, v88, v56, v64
    v_mfma_f32_16x16x32_bf16 a[44:47], a[20:23], v[52:55], a[44:47]
    v_fma_f32 v89, v89, v57, v65
    v_fma_f32 v90, v90, v58, v66
    v_fma_f32 v91, v91, v59, v67
    v_cvt_pk_bf16_f32 v44, v88, v89
    v_cvt_pk_bf16_f32 v45, v90, v91
    v_lshlrev_b32 v92, 16, v166
    v_and_b32 v93, 0xffff0000, v166
    v_mfma_f32_16x16x32_bf16 a[52:55], a[24:27], v[52:55], a[52:55]
    v_lshlrev_b32 v94, 16, v167
    s_add_u32 s33, s29, 344064
    buffer_load_dwordx4 v[144:147], v6, s[8:11], s33 offen sc1
    v_and_b32 v95, 0xffff0000, v167
    v_fma_f32 v92, v92, v60, v68
    v_fma_f32 v93, v93, v61, v69
    v_fma_f32 v94, v94, v62, v70
    v_fma_f32 v95, v95, v63, v71
    v_mfma_f32_16x16x32_bf16 a[60:63], a[28:31], v[52:55], a[60:63]
    v_cvt_pk_bf16_f32 v46, v92, v93
    v_cvt_pk_bf16_f32 v47, v94, v95
    ds_read_b128 v[72:75], v35 offset:896
    ds_read_b128 v[80:83], v35 offset:9088
    ds_read_b128 v[76:79], v35 offset:960
    ds_read_b128 v[84:87], v35 offset:9152
    buffer_load_dwordx4 v[148:151], v9, s[8:11], s33 offen offset:1024 sc1
    s_waitcnt lgkmcnt(10)
    v_mfma_f32_16x16x32_bf16 a[32:35], a[0:3], v[40:43], a[32:35]
    s_waitcnt vmcnt(16)
    s_barrier
    ds_read_b64_tr_b16 a[16:17], v36 offset:28672
    ds_read_b64_tr_b16 a[18:19], v36 offset:30720
    ds_read_b64_tr_b16 a[20:21], v37 offset:28672
    ds_read_b64_tr_b16 a[22:23], v37 offset:30720
    ds_read_b64_tr_b16 a[24:25], v38 offset:28672
    s_waitcnt lgkmcnt(13)
    ds_read_b64_tr_b16 a[26:27], v38 offset:30720
    v_mfma_f32_16x16x32_bf16 a[40:43], a[4:7], v[40:43], a[40:43]
    ds_read_b64_tr_b16 a[28:29], v39 offset:28672
    s_waitcnt lgkmcnt(13)
    ds_read_b64_tr_b16 a[30:31], v39 offset:30720
    v_lshlrev_b32 v88, 16, v168
    v_and_b32 v89, 0xffff0000, v168
    v_lshlrev_b32 v90, 16, v169
    v_and_b32 v91, 0xffff0000, v169
    s_waitcnt lgkmcnt(10)
    v_fma_f32 v88, v88, v72, v80
    v_mfma_f32_16x16x32_bf16 a[48:51], a[8:11], v[40:43], a[48:51]
    v_fma_f32 v89, v89, v73, v81
    v_fma_f32 v90, v90, v74, v82
    v_fma_f32 v91, v91, v75, v83
    v_cvt_pk_bf16_f32 v48, v88, v89
    v_cvt_pk_bf16_f32 v49, v90, v91
    v_lshlrev_b32 v92, 16, v170
    s_add_u32 m0, s49, 16384
    s_mov_b32 s32, 1490944
    buffer_load_dwordx4 v5, s[4:7], s32 offen sc1 lds
    v_mfma_f32_16x16x32_bf16 a[56:59], a[12:15], v[40:43], a[56:59]
    v_and_b32 v93, 0xffff0000, v170
    v_lshlrev_b32 v94, 16, v171
    v_and_b32 v95, 0xffff0000, v171
    s_waitcnt lgkmcnt(8)
    v_fma_f32 v92, v92, v76, v84
    v_fma_f32 v93, v93, v77, v85
    v_fma_f32 v94, v94, v78, v86
    v_fma_f32 v95, v95, v79, v87
    v_mfma_f32_16x16x32_bf16 a[36:39], a[0:3], v[44:47], a[36:39]
    v_cvt_pk_bf16_f32 v50, v92, v93
    v_cvt_pk_bf16_f32 v51, v94, v95
    v_lshlrev_b32 v88, 16, v172
    v_and_b32 v89, 0xffff0000, v172
    buffer_load_dwordx4 v4, s[4:7], s32 offen offset:1024 sc1 lds
    v_lshlrev_b32 v90, 16, v173
    v_and_b32 v91, 0xffff0000, v173
    v_mfma_f32_16x16x32_bf16 a[44:47], a[4:7], v[44:47], a[44:47]
    v_fma_f32 v88, v88, v72, v80
    v_fma_f32 v89, v89, v73, v81
    v_fma_f32 v90, v90, v74, v82
    v_fma_f32 v91, v91, v75, v83
    v_cvt_pk_bf16_f32 v52, v88, v89
    v_cvt_pk_bf16_f32 v53, v90, v91
    v_lshlrev_b32 v92, 16, v174
    v_mfma_f32_16x16x32_bf16 a[52:55], a[8:11], v[44:47], a[52:55]
    v_and_b32 v93, 0xffff0000, v174
    v_lshlrev_b32 v94, 16, v175
    s_add_u32 s33, s29, 372736
    buffer_load_dwordx4 v[152:155], v6, s[8:11], s33 offen sc1
    v_and_b32 v95, 0xffff0000, v175
    v_fma_f32 v92, v92, v76, v84
    v_fma_f32 v93, v93, v77, v85
    v_fma_f32 v94, v94, v78, v86
    v_mfma_f32_16x16x32_bf16 a[60:63], a[12:15], v[44:47], a[60:63]
    v_fma_f32 v95, v95, v79, v87
    v_cvt_pk_bf16_f32 v54, v92, v93
    v_cvt_pk_bf16_f32 v55, v94, v95
    ds_read_b128 v[56:59], v35 offset:1024
    ds_read_b128 v[64:67], v35 offset:9216
    ds_read_b128 v[60:63], v35 offset:1088
    ds_read_b128 v[68:71], v35 offset:9280
    buffer_load_dwordx4 v[156:159], v9, s[8:11], s33 offen offset:1024 sc1
    s_waitcnt lgkmcnt(10)
    v_mfma_f32_16x16x32_bf16 a[32:35], a[16:19], v[48:51], a[32:35]
    ds_read_b64_tr_b16 a[0:1], v36 offset:32768
    ds_read_b64_tr_b16 a[2:3], v36 offset:34816
    ds_read_b64_tr_b16 a[4:5], v37 offset:32768
    ds_read_b64_tr_b16 a[6:7], v37 offset:34816
    ds_read_b64_tr_b16 a[8:9], v38 offset:32768
    s_waitcnt lgkmcnt(13)
    ds_read_b64_tr_b16 a[10:11], v38 offset:34816
    ds_read_b64_tr_b16 a[12:13], v39 offset:32768
    v_mfma_f32_16x16x32_bf16 a[40:43], a[20:23], v[48:51], a[40:43]
    s_waitcnt lgkmcnt(13)
    ds_read_b64_tr_b16 a[14:15], v39 offset:34816
    v_lshlrev_b32 v88, 16, v112
    v_and_b32 v89, 0xffff0000, v112
    v_lshlrev_b32 v90, 16, v113
    v_and_b32 v91, 0xffff0000, v113
    s_waitcnt lgkmcnt(10)
    v_fma_f32 v88, v88, v56, v64
    v_fma_f32 v89, v89, v57, v65
    v_mfma_f32_16x16x32_bf16 a[48:51], a[24:27], v[48:51], a[48:51]
    v_fma_f32 v90, v90, v58, v66
    v_fma_f32 v91, v91, v59, v67
    v_cvt_pk_bf16_f32 v40, v88, v89
    v_cvt_pk_bf16_f32 v41, v90, v91
    v_lshlrev_b32 v92, 16, v114
    s_add_u32 m0, s49, 20480
    s_mov_b32 s32, 1605632
    buffer_load_dwordx4 v5, s[4:7], s32 offen sc1 lds
    v_and_b32 v93, 0xffff0000, v114
    v_mfma_f32_16x16x32_bf16 a[56:59], a[28:31], v[48:51], a[56:59]
    v_lshlrev_b32 v94, 16, v115
    v_and_b32 v95, 0xffff0000, v115
    s_waitcnt lgkmcnt(8)
    v_fma_f32 v92, v92, v60, v68
    v_fma_f32 v93, v93, v61, v69
    v_fma_f32 v94, v94, v62, v70
    v_fma_f32 v95, v95, v63, v71
    v_cvt_pk_bf16_f32 v42, v92, v93
    v_mfma_f32_16x16x32_bf16 a[36:39], a[16:19], v[52:55], a[36:39]
    v_cvt_pk_bf16_f32 v43, v94, v95
    v_lshlrev_b32 v88, 16, v116
    v_and_b32 v89, 0xffff0000, v116
    buffer_load_dwordx4 v4, s[4:7], s32 offen offset:1024 sc1 lds
    v_lshlrev_b32 v90, 16, v117
    v_and_b32 v91, 0xffff0000, v117
    v_fma_f32 v88, v88, v56, v64
    v_mfma_f32_16x16x32_bf16 a[44:47], a[20:23], v[52:55], a[44:47]
    v_fma_f32 v89, v89, v57, v65
    v_fma_f32 v90, v90, v58, v66
    v_fma_f32 v91, v91, v59, v67
    v_cvt_pk_bf16_f32 v44, v88, v89
    v_cvt_pk_bf16_f32 v45, v90, v91
    v_lshlrev_b32 v92, 16, v118
    v_and_b32 v93, 0xffff0000, v118
    v_mfma_f32_16x16x32_bf16 a[52:55], a[24:27], v[52:55], a[52:55]
    v_lshlrev_b32 v94, 16, v119
    s_add_u32 s33, s29, 401408
    buffer_load_dwordx4 v[160:163], v6, s[8:11], s33 offen sc1
    v_and_b32 v95, 0xffff0000, v119
    v_fma_f32 v92, v92, v60, v68
    v_fma_f32 v93, v93, v61, v69
    v_fma_f32 v94, v94, v62, v70
    v_fma_f32 v95, v95, v63, v71
    v_mfma_f32_16x16x32_bf16 a[60:63], a[28:31], v[52:55], a[60:63]
    v_cvt_pk_bf16_f32 v46, v92, v93
    v_cvt_pk_bf16_f32 v47, v94, v95
    ds_read_b128 v[72:75], v35 offset:1152
    ds_read_b128 v[80:83], v35 offset:9344
    ds_read_b128 v[76:79], v35 offset:1216
    ds_read_b128 v[84:87], v35 offset:9408
    buffer_load_dwordx4 v[164:167], v9, s[8:11], s33 offen offset:1024 sc1
    s_waitcnt lgkmcnt(10)
    v_mfma_f32_16x16x32_bf16 a[32:35], a[0:3], v[40:43], a[32:35]
    s_waitcnt vmcnt(16)
    s_barrier
    ds_read_b64_tr_b16 a[16:17], v36 offset:0
    ds_read_b64_tr_b16 a[18:19], v36 offset:2048
    ds_read_b64_tr_b16 a[20:21], v37 offset:0
    ds_read_b64_tr_b16 a[22:23], v37 offset:2048
    ds_read_b64_tr_b16 a[24:25], v38 offset:0
    s_waitcnt lgkmcnt(13)
    ds_read_b64_tr_b16 a[26:27], v38 offset:2048
    v_mfma_f32_16x16x32_bf16 a[40:43], a[4:7], v[40:43], a[40:43]
    ds_read_b64_tr_b16 a[28:29], v39 offset:0
    s_waitcnt lgkmcnt(13)
    ds_read_b64_tr_b16 a[30:31], v39 offset:2048
    v_lshlrev_b32 v88, 16, v120
    v_and_b32 v89, 0xffff0000, v120
    v_lshlrev_b32 v90, 16, v121
    v_and_b32 v91, 0xffff0000, v121
    s_waitcnt lgkmcnt(10)
    v_fma_f32 v88, v88, v72, v80
    v_mfma_f32_16x16x32_bf16 a[48:51], a[8:11], v[40:43], a[48:51]
    v_fma_f32 v89, v89, v73, v81
    v_fma_f32 v90, v90, v74, v82
    v_fma_f32 v91, v91, v75, v83
    v_cvt_pk_bf16_f32 v48, v88, v89
    v_cvt_pk_bf16_f32 v49, v90, v91
    v_lshlrev_b32 v92, 16, v122
    s_add_u32 m0, s49, 24576
    s_mov_b32 s32, 1720320
    buffer_load_dwordx4 v5, s[4:7], s32 offen sc1 lds
    v_mfma_f32_16x16x32_bf16 a[56:59], a[12:15], v[40:43], a[56:59]
    v_and_b32 v93, 0xffff0000, v122
    v_lshlrev_b32 v94, 16, v123
    v_and_b32 v95, 0xffff0000, v123
    s_waitcnt lgkmcnt(8)
    v_fma_f32 v92, v92, v76, v84
    v_fma_f32 v93, v93, v77, v85
    v_fma_f32 v94, v94, v78, v86
    v_fma_f32 v95, v95, v79, v87
    v_mfma_f32_16x16x32_bf16 a[36:39], a[0:3], v[44:47], a[36:39]
    v_cvt_pk_bf16_f32 v50, v92, v93
    v_cvt_pk_bf16_f32 v51, v94, v95
    v_lshlrev_b32 v88, 16, v124
    v_and_b32 v89, 0xffff0000, v124
    buffer_load_dwordx4 v4, s[4:7], s32 offen offset:1024 sc1 lds
    v_lshlrev_b32 v90, 16, v125
    v_and_b32 v91, 0xffff0000, v125
    v_mfma_f32_16x16x32_bf16 a[44:47], a[4:7], v[44:47], a[44:47]
    v_fma_f32 v88, v88, v72, v80
    v_fma_f32 v89, v89, v73, v81
    v_fma_f32 v90, v90, v74, v82
    v_fma_f32 v91, v91, v75, v83
    v_cvt_pk_bf16_f32 v52, v88, v89
    v_cvt_pk_bf16_f32 v53, v90, v91
    v_lshlrev_b32 v92, 16, v126
    v_mfma_f32_16x16x32_bf16 a[52:55], a[8:11], v[44:47], a[52:55]
    v_and_b32 v93, 0xffff0000, v126
    v_lshlrev_b32 v94, 16, v127
    s_add_u32 s33, s29, 430080
    buffer_load_dwordx4 v[168:171], v6, s[8:11], s33 offen sc1
    v_and_b32 v95, 0xffff0000, v127
    v_fma_f32 v92, v92, v76, v84
    v_fma_f32 v93, v93, v77, v85
    v_fma_f32 v94, v94, v78, v86
    v_mfma_f32_16x16x32_bf16 a[60:63], a[12:15], v[44:47], a[60:63]
    v_fma_f32 v95, v95, v79, v87
    v_cvt_pk_bf16_f32 v54, v92, v93
    v_cvt_pk_bf16_f32 v55, v94, v95
    ds_read_b128 v[56:59], v35 offset:1280
    ds_read_b128 v[64:67], v35 offset:9472
    ds_read_b128 v[60:63], v35 offset:1344
    ds_read_b128 v[68:71], v35 offset:9536
    buffer_load_dwordx4 v[172:175], v9, s[8:11], s33 offen offset:1024 sc1
    s_waitcnt lgkmcnt(10)
    v_mfma_f32_16x16x32_bf16 a[32:35], a[16:19], v[48:51], a[32:35]
    ds_read_b64_tr_b16 a[0:1], v36 offset:4096
    ds_read_b64_tr_b16 a[2:3], v36 offset:6144
    ds_read_b64_tr_b16 a[4:5], v37 offset:4096
    ds_read_b64_tr_b16 a[6:7], v37 offset:6144
    ds_read_b64_tr_b16 a[8:9], v38 offset:4096
    s_waitcnt lgkmcnt(13)
    ds_read_b64_tr_b16 a[10:11], v38 offset:6144
    v_mfma_f32_16x16x32_bf16 a[40:43], a[20:23], v[48:51], a[40:43]
    ds_read_b64_tr_b16 a[12:13], v39 offset:4096
    s_waitcnt lgkmcnt(13)
    ds_read_b64_tr_b16 a[14:15], v39 offset:6144
    v_lshlrev_b32 v88, 16, v128
    v_and_b32 v89, 0xffff0000, v128
    v_lshlrev_b32 v90, 16, v129
    v_and_b32 v91, 0xffff0000, v129
    s_waitcnt lgkmcnt(10)
    v_fma_f32 v88, v88, v56, v64
    v_mfma_f32_16x16x32_bf16 a[48:51], a[24:27], v[48:51], a[48:51]
    v_fma_f32 v89, v89, v57, v65
    v_fma_f32 v90, v90, v58, v66
    v_fma_f32 v91, v91, v59, v67
    v_cvt_pk_bf16_f32 v40, v88, v89
    v_cvt_pk_bf16_f32 v41, v90, v91
    v_lshlrev_b32 v92, 16, v130
    v_mfma_f32_16x16x32_bf16 a[56:59], a[28:31], v[48:51], a[56:59]
    v_and_b32 v93, 0xffff0000, v130
    v_lshlrev_b32 v94, 16, v131
    v_and_b32 v95, 0xffff0000, v131
    s_waitcnt lgkmcnt(8)
    v_fma_f32 v92, v92, v60, v68
    v_fma_f32 v93, v93, v61, v69
    v_fma_f32 v94, v94, v62, v70
    v_fma_f32 v95, v95, v63, v71
    v_mfma_f32_16x16x32_bf16 a[36:39], a[16:19], v[52:55], a[36:39]
    v_cvt_pk_bf16_f32 v42, v92, v93
    v_cvt_pk_bf16_f32 v43, v94, v95
    v_lshlrev_b32 v88, 16, v132
    v_and_b32 v89, 0xffff0000, v132
    v_lshlrev_b32 v90, 16, v133
    v_and_b32 v91, 0xffff0000, v133
    v_mfma_f32_16x16x32_bf16 a[44:47], a[20:23], v[52:55], a[44:47]
    v_fma_f32 v88, v88, v56, v64
    v_fma_f32 v89, v89, v57, v65
    v_fma_f32 v90, v90, v58, v66
    v_fma_f32 v91, v91, v59, v67
    v_cvt_pk_bf16_f32 v44, v88, v89
    v_cvt_pk_bf16_f32 v45, v90, v91
    v_lshlrev_b32 v92, 16, v134
    v_mfma_f32_16x16x32_bf16 a[52:55], a[24:27], v[52:55], a[52:55]
    v_and_b32 v93, 0xffff0000, v134
    v_lshlrev_b32 v94, 16, v135
    v_and_b32 v95, 0xffff0000, v135
    v_fma_f32 v92, v92, v60, v68
    v_fma_f32 v93, v93, v61, v69
    v_fma_f32 v94, v94, v62, v70
    v_mfma_f32_16x16x32_bf16 a[60:63], a[28:31], v[52:55], a[60:63]
    v_fma_f32 v95, v95, v63, v71
    v_cvt_pk_bf16_f32 v46, v92, v93
    v_cvt_pk_bf16_f32 v47, v94, v95
    ds_read_b128 v[72:75], v35 offset:1408
    ds_read_b128 v[80:83], v35 offset:9600
    ds_read_b128 v[76:79], v35 offset:1472
    ds_read_b128 v[84:87], v35 offset:9664
    s_waitcnt lgkmcnt(10)
    v_mfma_f32_16x16x32_bf16 a[32:35], a[0:3], v[40:43], a[32:35]
    s_waitcnt vmcnt(12)
    s_barrier
    ds_read_b64_tr_b16 a[16:17], v36 offset:8192
    ds_read_b64_tr_b16 a[18:19], v36 offset:10240
    ds_read_b64_tr_b16 a[20:21], v37 offset:8192
    ds_read_b64_tr_b16 a[22:23], v37 offset:10240
    ds_read_b64_tr_b16 a[24:25], v38 offset:8192
    s_waitcnt lgkmcnt(13)
    v_mfma_f32_16x16x32_bf16 a[40:43], a[4:7], v[40:43], a[40:43]
    ds_read_b64_tr_b16 a[26:27], v38 offset:10240
    ds_read_b64_tr_b16 a[28:29], v39 offset:8192
    s_waitcnt lgkmcnt(13)
    ds_read_b64_tr_b16 a[30:31], v39 offset:10240
    v_lshlrev_b32 v88, 16, v136
    v_and_b32 v89, 0xffff0000, v136
    v_lshlrev_b32 v90, 16, v137
    v_and_b32 v91, 0xffff0000, v137
    v_mfma_f32_16x16x32_bf16 a[48:51], a[8:11], v[40:43], a[48:51]
    s_waitcnt lgkmcnt(10)
    v_fma_f32 v88, v88, v72, v80
    v_fma_f32 v89, v89, v73, v81
    v_fma_f32 v90, v90, v74, v82
    v_fma_f32 v91, v91, v75, v83
    v_cvt_pk_bf16_f32 v48, v88, v89
    v_cvt_pk_bf16_f32 v49, v90, v91
    v_lshlrev_b32 v92, 16, v138
    v_mfma_f32_16x16x32_bf16 a[56:59], a[12:15], v[40:43], a[56:59]
    v_and_b32 v93, 0xffff0000, v138
    v_lshlrev_b32 v94, 16, v139
    v_and_b32 v95, 0xffff0000, v139
    s_waitcnt lgkmcnt(8)
    v_fma_f32 v92, v92, v76, v84
    v_fma_f32 v93, v93, v77, v85
    v_fma_f32 v94, v94, v78, v86
    v_fma_f32 v95, v95, v79, v87
    v_mfma_f32_16x16x32_bf16 a[36:39], a[0:3], v[44:47], a[36:39]
    v_cvt_pk_bf16_f32 v50, v92, v93
    v_cvt_pk_bf16_f32 v51, v94, v95
    v_lshlrev_b32 v88, 16, v140
    v_and_b32 v89, 0xffff0000, v140
    s_lshr_b32 s44, s2, 3
    s_bfe_u32 s45, s2, 0x20001
    s_lshl_b32 s44, s44, 6
    s_lshl_b32 s46, s22, 3
    s_add_u32 s44, s44, s46
    v_and_b32 v98, 7, v1
    v_add_u32 v98, s44, v98
    v_lshlrev_b32 v98, 12, v98
    v_lshl_add_u32 v98, v3, 7, v98
    s_lshl_b32 s45, s45, 10
    v_add_u32 v98, s45, v98
    s_and_b32 s93, s93, 0xffff
    s_mov_b32 s94, 0x700000
    s_mov_b32 s95, 0x00020000
    v_lshlrev_b32 v90, 16, v141
    v_and_b32 v91, 0xffff0000, v141
    v_mfma_f32_16x16x32_bf16 a[44:47], a[4:7], v[44:47], a[44:47]
    v_fma_f32 v88, v88, v72, v80
    v_fma_f32 v89, v89, v73, v81
    v_fma_f32 v90, v90, v74, v82
    v_fma_f32 v91, v91, v75, v83
    v_cvt_pk_bf16_f32 v52, v88, v89
    v_cvt_pk_bf16_f32 v53, v90, v91
    v_lshlrev_b32 v92, 16, v142
    v_mfma_f32_16x16x32_bf16 a[52:55], a[8:11], v[44:47], a[52:55]
    v_and_b32 v93, 0xffff0000, v142
    v_lshlrev_b32 v94, 16, v143
    v_and_b32 v95, 0xffff0000, v143
    v_fma_f32 v92, v92, v76, v84
    v_fma_f32 v93, v93, v77, v85
    v_fma_f32 v94, v94, v78, v86
    v_fma_f32 v95, v95, v79, v87
    v_mfma_f32_16x16x32_bf16 a[60:63], a[12:15], v[44:47], a[60:63]
    v_cvt_pk_bf16_f32 v54, v92, v93
    v_cvt_pk_bf16_f32 v55, v94, v95
    ds_read_b128 v[56:59], v35 offset:1536
    ds_read_b128 v[64:67], v35 offset:9728
    ds_read_b128 v[60:63], v35 offset:1600
    ds_read_b128 v[68:71], v35 offset:9792
    buffer_load_dword v99, v98, s[92:95], 0 offen
    s_waitcnt lgkmcnt(10)
    v_mfma_f32_16x16x32_bf16 a[32:35], a[16:19], v[48:51], a[32:35]
    ds_read_b64_tr_b16 a[0:1], v36 offset:12288
    ds_read_b64_tr_b16 a[2:3], v36 offset:14336
    ds_read_b64_tr_b16 a[4:5], v37 offset:12288
    ds_read_b64_tr_b16 a[6:7], v37 offset:14336
    ds_read_b64_tr_b16 a[8:9], v38 offset:12288
    s_waitcnt lgkmcnt(13)
    ds_read_b64_tr_b16 a[10:11], v38 offset:14336
    v_mfma_f32_16x16x32_bf16 a[40:43], a[20:23], v[48:51], a[40:43]
    ds_read_b64_tr_b16 a[12:13], v39 offset:12288
    s_waitcnt lgkmcnt(13)
    ds_read_b64_tr_b16 a[14:15], v39 offset:14336
    v_lshlrev_b32 v88, 16, v144
    v_and_b32 v89, 0xffff0000, v144
    v_lshlrev_b32 v90, 16, v145
    v_and_b32 v91, 0xffff0000, v145
    s_waitcnt lgkmcnt(10)
    v_fma_f32 v88, v88, v56, v64
    v_mfma_f32_16x16x32_bf16 a[48:51], a[24:27], v[48:51], a[48:51]
    v_fma_f32 v89, v89, v57, v65
    v_fma_f32 v90, v90, v58, v66
    v_fma_f32 v91, v91, v59, v67
    v_cvt_pk_bf16_f32 v40, v88, v89
    v_cvt_pk_bf16_f32 v41, v90, v91
    v_lshlrev_b32 v92, 16, v146
    v_mfma_f32_16x16x32_bf16 a[56:59], a[28:31], v[48:51], a[56:59]
    v_and_b32 v93, 0xffff0000, v146
    v_lshlrev_b32 v94, 16, v147
    v_and_b32 v95, 0xffff0000, v147
    s_waitcnt lgkmcnt(8)
    v_fma_f32 v92, v92, v60, v68
    v_fma_f32 v93, v93, v61, v69
    v_fma_f32 v94, v94, v62, v70
    v_fma_f32 v95, v95, v63, v71
    v_mfma_f32_16x16x32_bf16 a[36:39], a[16:19], v[52:55], a[36:39]
    v_cvt_pk_bf16_f32 v42, v92, v93
    v_cvt_pk_bf16_f32 v43, v94, v95
    v_lshlrev_b32 v88, 16, v148
    v_and_b32 v89, 0xffff0000, v148
    v_lshlrev_b32 v90, 16, v149
    v_and_b32 v91, 0xffff0000, v149
    v_mfma_f32_16x16x32_bf16 a[44:47], a[20:23], v[52:55], a[44:47]
    v_fma_f32 v88, v88, v56, v64
    v_fma_f32 v89, v89, v57, v65
    v_fma_f32 v90, v90, v58, v66
    v_fma_f32 v91, v91, v59, v67
    v_cvt_pk_bf16_f32 v44, v88, v89
    v_cvt_pk_bf16_f32 v45, v90, v91
    v_lshlrev_b32 v92, 16, v150
    v_mfma_f32_16x16x32_bf16 a[52:55], a[24:27], v[52:55], a[52:55]
    v_and_b32 v93, 0xffff0000, v150
    v_lshlrev_b32 v94, 16, v151
    v_and_b32 v95, 0xffff0000, v151
    v_fma_f32 v92, v92, v60, v68
    v_fma_f32 v93, v93, v61, v69
    v_fma_f32 v94, v94, v62, v70
    v_mfma_f32_16x16x32_bf16 a[60:63], a[28:31], v[52:55], a[60:63]
    v_fma_f32 v95, v95, v63, v71
    v_cvt_pk_bf16_f32 v46, v92, v93
    v_cvt_pk_bf16_f32 v47, v94, v95
    ds_read_b128 v[72:75], v35 offset:1664
    ds_read_b128 v[80:83], v35 offset:9856
    ds_read_b128 v[76:79], v35 offset:1728
    ds_read_b128 v[84:87], v35 offset:9920
    s_waitcnt lgkmcnt(10)
    v_mfma_f32_16x16x32_bf16 a[32:35], a[0:3], v[40:43], a[32:35]
    s_waitcnt vmcnt(5)
    s_barrier
    ds_read_b64_tr_b16 a[16:17], v36 offset:16384
    ds_read_b64_tr_b16 a[18:19], v36 offset:18432
    ds_read_b64_tr_b16 a[20:21], v37 offset:16384
    ds_read_b64_tr_b16 a[22:23], v37 offset:18432
    ds_read_b64_tr_b16 a[24:25], v38 offset:16384
    s_waitcnt lgkmcnt(13)
    v_mfma_f32_16x16x32_bf16 a[40:43], a[4:7], v[40:43], a[40:43]
    ds_read_b64_tr_b16 a[26:27], v38 offset:18432
    ds_read_b64_tr_b16 a[28:29], v39 offset:16384
    s_waitcnt lgkmcnt(13)
    ds_read_b64_tr_b16 a[30:31], v39 offset:18432
    v_lshlrev_b32 v88, 16, v152
    v_and_b32 v89, 0xffff0000, v152
    v_lshlrev_b32 v90, 16, v153
    v_and_b32 v91, 0xffff0000, v153
    v_mfma_f32_16x16x32_bf16 a[48:51], a[8:11], v[40:43], a[48:51]
    s_waitcnt lgkmcnt(10)
    v_fma_f32 v88, v88, v72, v80
    v_fma_f32 v89, v89, v73, v81
    v_fma_f32 v90, v90, v74, v82
    v_fma_f32 v91, v91, v75, v83
    v_cvt_pk_bf16_f32 v48, v88, v89
    v_cvt_pk_bf16_f32 v49, v90, v91
    v_mfma_f32_16x16x32_bf16 a[56:59], a[12:15], v[40:43], a[56:59]
    v_lshlrev_b32 v92, 16, v154
    v_and_b32 v93, 0xffff0000, v154
    v_lshlrev_b32 v94, 16, v155
    v_and_b32 v95, 0xffff0000, v155
    s_waitcnt lgkmcnt(8)
    v_fma_f32 v92, v92, v76, v84
    v_fma_f32 v93, v93, v77, v85
    v_fma_f32 v94, v94, v78, v86
    v_mfma_f32_16x16x32_bf16 a[36:39], a[0:3], v[44:47], a[36:39]
    v_fma_f32 v95, v95, v79, v87
    v_cvt_pk_bf16_f32 v50, v92, v93
    v_cvt_pk_bf16_f32 v51, v94, v95
    v_lshlrev_b32 v88, 16, v156
    v_and_b32 v89, 0xffff0000, v156
    v_lshlrev_b32 v90, 16, v157
    v_and_b32 v91, 0xffff0000, v157
    v_mfma_f32_16x16x32_bf16 a[44:47], a[4:7], v[44:47], a[44:47]
    v_fma_f32 v88, v88, v72, v80
    v_fma_f32 v89, v89, v73, v81
    v_fma_f32 v90, v90, v74, v82
    v_fma_f32 v91, v91, v75, v83
    v_cvt_pk_bf16_f32 v52, v88, v89
    v_cvt_pk_bf16_f32 v53, v90, v91
    v_mfma_f32_16x16x32_bf16 a[52:55], a[8:11], v[44:47], a[52:55]
    v_lshlrev_b32 v92, 16, v158
    v_and_b32 v93, 0xffff0000, v158
    v_lshlrev_b32 v94, 16, v159
    v_and_b32 v95, 0xffff0000, v159
    v_fma_f32 v92, v92, v76, v84
    v_fma_f32 v93, v93, v77, v85
    v_fma_f32 v94, v94, v78, v86
    v_mfma_f32_16x16x32_bf16 a[60:63], a[12:15], v[44:47], a[60:63]
    v_fma_f32 v95, v95, v79, v87
    v_cvt_pk_bf16_f32 v54, v92, v93
    v_cvt_pk_bf16_f32 v55, v94, v95
    ds_read_b128 v[56:59], v35 offset:1792
    ds_read_b128 v[64:67], v35 offset:9984
    ds_read_b128 v[60:63], v35 offset:1856
    ds_read_b128 v[68:71], v35 offset:10048
    s_waitcnt lgkmcnt(10)
    v_mfma_f32_16x16x32_bf16 a[32:35], a[16:19], v[48:51], a[32:35]
    ds_read_b64_tr_b16 a[0:1], v36 offset:20480
    ds_read_b64_tr_b16 a[2:3], v36 offset:22528
    ds_read_b64_tr_b16 a[4:5], v37 offset:20480
    ds_read_b64_tr_b16 a[6:7], v37 offset:22528
    ds_read_b64_tr_b16 a[8:9], v38 offset:20480
    s_waitcnt lgkmcnt(13)
    ds_read_b64_tr_b16 a[10:11], v38 offset:22528
    v_mfma_f32_16x16x32_bf16 a[40:43], a[20:23], v[48:51], a[40:43]
    ds_read_b64_tr_b16 a[12:13], v39 offset:20480
    s_waitcnt lgkmcnt(13)
    ds_read_b64_tr_b16 a[14:15], v39 offset:22528
    v_lshlrev_b32 v88, 16, v160
    v_and_b32 v89, 0xffff0000, v160
    v_lshlrev_b32 v90, 16, v161
    v_and_b32 v91, 0xffff0000, v161
    s_waitcnt lgkmcnt(10)
    v_fma_f32 v88, v88, v56, v64
    v_mfma_f32_16x16x32_bf16 a[48:51], a[24:27], v[48:51], a[48:51]
    v_fma_f32 v89, v89, v57, v65
    v_fma_f32 v90, v90, v58, v66
    v_fma_f32 v91, v91, v59, v67
    v_cvt_pk_bf16_f32 v40, v88, v89
    v_cvt_pk_bf16_f32 v41, v90, v91
    v_lshlrev_b32 v92, 16, v162
    v_mfma_f32_16x16x32_bf16 a[56:59], a[28:31], v[48:51], a[56:59]
    v_and_b32 v93, 0xffff0000, v162
    v_lshlrev_b32 v94, 16, v163
    v_and_b32 v95, 0xffff0000, v163
    s_waitcnt lgkmcnt(8)
    v_fma_f32 v92, v92, v60, v68
    v_fma_f32 v93, v93, v61, v69
    v_fma_f32 v94, v94, v62, v70
    v_fma_f32 v95, v95, v63, v71
    v_mfma_f32_16x16x32_bf16 a[36:39], a[16:19], v[52:55], a[36:39]
    v_cvt_pk_bf16_f32 v42, v92, v93
    v_cvt_pk_bf16_f32 v43, v94, v95
    v_lshlrev_b32 v88, 16, v164
    v_and_b32 v89, 0xffff0000, v164
    v_lshlrev_b32 v90, 16, v165
    v_and_b32 v91, 0xffff0000, v165
    v_mfma_f32_16x16x32_bf16 a[44:47], a[20:23], v[52:55], a[44:47]
    v_fma_f32 v88, v88, v56, v64
    v_fma_f32 v89, v89, v57, v65
    v_fma_f32 v90, v90, v58, v66
    v_fma_f32 v91, v91, v59, v67
    v_cvt_pk_bf16_f32 v44, v88, v89
    v_cvt_pk_bf16_f32 v45, v90, v91
    v_lshlrev_b32 v92, 16, v166
    v_mfma_f32_16x16x32_bf16 a[52:55], a[24:27], v[52:55], a[52:55]
    v_and_b32 v93, 0xffff0000, v166
    v_lshlrev_b32 v94, 16, v167
    v_and_b32 v95, 0xffff0000, v167
    v_fma_f32 v92, v92, v60, v68
    v_fma_f32 v93, v93, v61, v69
    v_fma_f32 v94, v94, v62, v70
    v_mfma_f32_16x16x32_bf16 a[60:63], a[28:31], v[52:55], a[60:63]
    v_fma_f32 v95, v95, v63, v71
    v_cvt_pk_bf16_f32 v46, v92, v93
    v_cvt_pk_bf16_f32 v47, v94, v95
    ds_read_b128 v[72:75], v35 offset:1920
    ds_read_b128 v[80:83], v35 offset:10112
    ds_read_b128 v[76:79], v35 offset:1984
    ds_read_b128 v[84:87], v35 offset:10176
    s_waitcnt lgkmcnt(10)
    v_mfma_f32_16x16x32_bf16 a[32:35], a[0:3], v[40:43], a[32:35]
    s_waitcnt vmcnt(1)
    s_barrier
    ds_read_b64_tr_b16 a[16:17], v36 offset:24576
    ds_read_b64_tr_b16 a[18:19], v36 offset:26624
    ds_read_b64_tr_b16 a[20:21], v37 offset:24576
    ds_read_b64_tr_b16 a[22:23], v37 offset:26624
    ds_read_b64_tr_b16 a[24:25], v38 offset:24576
    s_waitcnt lgkmcnt(13)
    v_mfma_f32_16x16x32_bf16 a[40:43], a[4:7], v[40:43], a[40:43]
    ds_read_b64_tr_b16 a[26:27], v38 offset:26624
    ds_read_b64_tr_b16 a[28:29], v39 offset:24576
    s_waitcnt lgkmcnt(13)
    ds_read_b64_tr_b16 a[30:31], v39 offset:26624
    v_lshlrev_b32 v88, 16, v168
    v_and_b32 v89, 0xffff0000, v168
    v_lshlrev_b32 v90, 16, v169
    v_mfma_f32_16x16x32_bf16 a[48:51], a[8:11], v[40:43], a[48:51]
    v_and_b32 v91, 0xffff0000, v169
    s_waitcnt lgkmcnt(10)
    v_fma_f32 v88, v88, v72, v80
    v_fma_f32 v89, v89, v73, v81
    v_fma_f32 v90, v90, v74, v82
    v_fma_f32 v91, v91, v75, v83
    v_cvt_pk_bf16_f32 v48, v88, v89
    v_mfma_f32_16x16x32_bf16 a[56:59], a[12:15], v[40:43], a[56:59]
    v_cvt_pk_bf16_f32 v49, v90, v91
    v_lshlrev_b32 v92, 16, v170
    v_and_b32 v93, 0xffff0000, v170
    v_lshlrev_b32 v94, 16, v171
    v_and_b32 v95, 0xffff0000, v171
    s_waitcnt lgkmcnt(8)
    v_fma_f32 v92, v92, v76, v84
    v_mfma_f32_16x16x32_bf16 a[36:39], a[0:3], v[44:47], a[36:39]
    v_fma_f32 v93, v93, v77, v85
    v_fma_f32 v94, v94, v78, v86
    v_fma_f32 v95, v95, v79, v87
    v_cvt_pk_bf16_f32 v50, v92, v93
    v_cvt_pk_bf16_f32 v51, v94, v95
    v_lshlrev_b32 v88, 16, v172
    v_mfma_f32_16x16x32_bf16 a[44:47], a[4:7], v[44:47], a[44:47]
    v_and_b32 v89, 0xffff0000, v172
    v_lshlrev_b32 v90, 16, v173
    v_and_b32 v91, 0xffff0000, v173
    v_fma_f32 v88, v88, v72, v80
    v_fma_f32 v89, v89, v73, v81
    v_fma_f32 v90, v90, v74, v82
    v_mfma_f32_16x16x32_bf16 a[52:55], a[8:11], v[44:47], a[52:55]
    v_fma_f32 v91, v91, v75, v83
    v_cvt_pk_bf16_f32 v52, v88, v89
    v_cvt_pk_bf16_f32 v53, v90, v91
    v_lshlrev_b32 v92, 16, v174
    v_and_b32 v93, 0xffff0000, v174
    v_lshlrev_b32 v94, 16, v175
    v_mfma_f32_16x16x32_bf16 a[60:63], a[12:15], v[44:47], a[60:63]
    v_and_b32 v95, 0xffff0000, v175
    v_fma_f32 v92, v92, v76, v84
    v_fma_f32 v93, v93, v77, v85
    v_fma_f32 v94, v94, v78, v86
    v_fma_f32 v95, v95, v79, v87
    v_cvt_pk_bf16_f32 v54, v92, v93
    v_cvt_pk_bf16_f32 v55, v94, v95
    s_waitcnt lgkmcnt(6)
    v_mfma_f32_16x16x32_bf16 a[32:35], a[16:19], v[48:51], a[32:35]
    s_waitcnt lgkmcnt(4)
    v_mfma_f32_16x16x32_bf16 a[40:43], a[20:23], v[48:51], a[40:43]
    s_waitcnt lgkmcnt(2)
    v_mfma_f32_16x16x32_bf16 a[48:51], a[24:27], v[48:51], a[48:51]
    s_waitcnt lgkmcnt(0)
    v_mfma_f32_16x16x32_bf16 a[56:59], a[28:31], v[48:51], a[56:59]
    v_mfma_f32_16x16x32_bf16 a[36:39], a[16:19], v[52:55], a[36:39]
    v_mfma_f32_16x16x32_bf16 a[44:47], a[20:23], v[52:55], a[44:47]
    v_mfma_f32_16x16x32_bf16 a[52:55], a[24:27], v[52:55], a[52:55]
    v_mfma_f32_16x16x32_bf16 a[60:63], a[28:31], v[52:55], a[60:63]
    v_lshlrev_b32 v34, 4, v1
    s_lshl_b32 s35, s48, 13
    s_add_u32 s34, s31, s35
    s_add_u32 s34, s34, 0
    v_add_u32 v33, s34, v34
    ds_write_b128 v33, a[32:35] offset:0
    ds_write_b128 v33, a[36:39] offset:2048
    ds_write_b128 v33, a[40:43] offset:1024
    ds_write_b128 v33, a[44:47] offset:3072
    ds_write_b128 v33, a[48:51] offset:4096
    ds_write_b128 v33, a[52:55] offset:6144
    ds_write_b128 v33, a[56:59] offset:5120
    ds_write_b128 v33, a[60:63] offset:7168
    s_waitcnt lgkmcnt(0)
    s_barrier
    s_lshl_b32 s34, s47, 11
    s_add_u32 s34, s34, s35
    s_add_u32 s34, s34, 0
    v_add_u32 v33, s34, v34
    v_add_u32 v35, 73728, v33
    ds_read_b128 v[40:43], v33 offset:0
    ds_read_b128 v[48:51], v33 offset:36864
    ds_read_b128 v[56:59], v35 offset:0
    ds_read_b128 v[64:67], v35 offset:36864
    ds_read_b128 v[44:47], v33 offset:1024
    ds_read_b128 v[52:55], v33 offset:37888
    ds_read_b128 v[60:63], v35 offset:1024
    ds_read_b128 v[68:71], v35 offset:37888
    s_waitcnt lgkmcnt(6)
    v_add_f32 v40, v40, v48
    s_waitcnt lgkmcnt(4)
    v_add_f32 v56, v56, v64
    v_add_f32 v41, v41, v49
    v_add_f32 v57, v57, v65
    v_add_f32 v42, v42, v50
    v_add_f32 v58, v58, v66
    v_add_f32 v43, v43, v51
    v_add_f32 v59, v59, v67
    v_add_f32 v40, v40, v56
    v_add_f32 v41, v41, v57
    v_add_f32 v42, v42, v58
    v_add_f32 v43, v43, v59
    s_waitcnt lgkmcnt(2)
    v_add_f32 v44, v44, v52
    s_waitcnt lgkmcnt(0)
    v_add_f32 v60, v60, v68
    v_add_f32 v45, v45, v53
    v_add_f32 v61, v61, v69
    v_add_f32 v46, v46, v54
    v_add_f32 v62, v62, v70
    v_add_f32 v47, v47, v55
    v_add_f32 v63, v63, v71
    v_add_f32 v44, v44, v60
    v_add_f32 v45, v45, v61
    v_add_f32 v46, v46, v62
    v_add_f32 v47, v47, v63
    v_lshlrev_b32 v76, 16, v100
    v_and_b32 v77, 0xffff0000, v100
    v_lshlrev_b32 v78, 16, v101
    v_and_b32 v79, 0xffff0000, v101
    v_lshlrev_b32 v80, 16, v102
    v_and_b32 v81, 0xffff0000, v102
    v_lshlrev_b32 v82, 16, v103
    v_and_b32 v83, 0xffff0000, v103
    s_mov_b32 s39, 0xc0135761
    s_mov_b32 s40, 0xbdd2d3e8
    v_mov_b32 v84, s39
    v_add_f32 v40, v40, v76
    v_mul_f32 v85, v40, v40
    v_fma_f32 v85, v85, s40, v84
    v_mul_f32 v85, v85, v40
    v_exp_f32 v85, v85
    s_nop 0
    v_add_f32 v85, 1.0, v85
    v_rcp_f32 v85, v85
    s_nop 0
    v_mul_f32 v40, v40, v85
    v_add_f32 v41, v41, v77
    v_mul_f32 v86, v41, v41
    v_fma_f32 v86, v86, s40, v84
    v_mul_f32 v86, v86, v41
    v_exp_f32 v86, v86
    s_nop 0
    v_add_f32 v86, 1.0, v86
    v_rcp_f32 v86, v86
    s_nop 0
    v_mul_f32 v41, v41, v86
    v_add_f32 v42, v42, v78
    v_mul_f32 v85, v42, v42
    v_fma_f32 v85, v85, s40, v84
    v_mul_f32 v85, v85, v42
    v_exp_f32 v85, v85
    s_nop 0
    v_add_f32 v85, 1.0, v85
    v_rcp_f32 v85, v85
    s_nop 0
    v_mul_f32 v42, v42, v85
    v_add_f32 v43, v43, v79
    v_mul_f32 v86, v43, v43
    v_fma_f32 v86, v86, s40, v84
    v_mul_f32 v86, v86, v43
    v_exp_f32 v86, v86
    s_nop 0
    v_add_f32 v86, 1.0, v86
    v_rcp_f32 v86, v86
    s_nop 0
    v_mul_f32 v43, v43, v86
    v_add_f32 v44, v44, v80
    v_mul_f32 v85, v44, v44
    v_fma_f32 v85, v85, s40, v84
    v_mul_f32 v85, v85, v44
    v_exp_f32 v85, v85
    s_nop 0
    v_add_f32 v85, 1.0, v85
    v_rcp_f32 v85, v85
    s_nop 0
    v_mul_f32 v44, v44, v85
    v_add_f32 v45, v45, v81
    v_mul_f32 v86, v45, v45
    v_fma_f32 v86, v86, s40, v84
    v_mul_f32 v86, v86, v45
    v_exp_f32 v86, v86
    s_nop 0
    v_add_f32 v86, 1.0, v86
    v_rcp_f32 v86, v86
    s_nop 0
    v_mul_f32 v45, v45, v86
    v_add_f32 v46, v46, v82
    v_mul_f32 v85, v46, v46
    v_fma_f32 v85, v85, s40, v84
    v_mul_f32 v85, v85, v46
    v_exp_f32 v85, v85
    s_nop 0
    v_add_f32 v85, 1.0, v85
    v_rcp_f32 v85, v85
    s_nop 0
    v_mul_f32 v46, v46, v85
    v_add_f32 v47, v47, v83
    v_mul_f32 v86, v47, v47
    v_fma_f32 v86, v86, s40, v84
    v_mul_f32 v86, v86, v47
    v_exp_f32 v86, v86
    s_nop 0
    v_add_f32 v86, 1.0, v86
    v_rcp_f32 v86, v86
    s_nop 0
    v_mul_f32 v47, v47, v86
    v_cvt_pk_bf16_f32 v88, v40, v41
    v_cvt_pk_bf16_f32 v89, v42, v43
    v_cvt_pk_bf16_f32 v90, v44, v45
    v_cvt_pk_bf16_f32 v91, v46, v47
    s_mul_i32 s41, s24, 56
    s_lshl_b32 s42, s23, 1
    s_add_u32 s41, s41, s42
    s_add_u32 s41, s41, s36
    s_mul_i32 s41, s41, 3584
    s_add_u32 s41, s41, 0xc00000
    s_and_b32 s42, s47, 1
    s_lshl_b32 s43, s48, 1
    s_add_u32 s42, s42, s43
    s_lshl_b32 s43, s42, 10
    s_add_u32 s41, s41, s43
    s_cmp_eq_u32 s42, 3
    s_cselect_b32 s44, 0x00ff00ff, -1
    s_mov_b32 s45, s44
    s_mov_b64 exec, s[44:45]
    buffer_store_dwordx4 v[88:91], v6, s[8:11], s41 offen sc0 sc1
    s_mov_b64 exec, -1
    s_lshl_b32 s34, s24, 7
    s_add_u32 s34, s34, 0x100c000
    s_waitcnt vmcnt(0) lgkmcnt(0)
    s_barrier
    v_mov_b32 v10, 0
    v_mov_b32 v11, 1
    v_cmp_eq_u32 vcc, 0, v0
    s_and_saveexec_b64 s[44:45], vcc
    s_cbranch_execz L_pub10
    buffer_atomic_add v11, v10, s[8:11], s34 offen sc1
L_pub10:
    s_mov_b64 exec, -1
L_pg1a_skip:
    s_branch L_pg1a_go
L_pk3a_idle:
    s_nop 1
    s_load_dwordx2 s[48:49], s[0:1], 32
    s_load_dwordx2 s[52:53], s[0:1], 48
    v_and_b32 v1, 63, v0
    v_lshrrev_b32 v2, 6, v0
    s_nop 0
    v_readfirstlane_b32 s22, v2
    s_lshr_b32 s34, s2, 3
    s_sub_u32 s34, s34, 28
    s_lshl_b32 s34, s34, 3
    s_add_u32 s34, s34, s22
    s_bfe_u32 s36, s2, 0x20001
    s_waitcnt lgkmcnt(0)
    s_and_b32 s49, s49, 0xffff
    s_mov_b32 s50, 0x700000
    s_mov_b32 s51, 0x00020000
    s_and_b32 s53, s53, 0xffff
    s_mov_b32 s54, 0x700000
    s_mov_b32 s55, 0x00020000
    s_mul_i32 s35, s34, 448
    s_mul_i32 s37, s36, 896
    s_add_u32 s38, s35, 0
    v_add_u32 v10, s38, v1
    s_mov_b32 s39, 149797
    v_mul_lo_u32 v11, v10, s39
    v_lshrrev_b32 v11, 20, v11
    v_mul_u32_u24 v12, 7, v11
    v_sub_u32 v12, v10, v12
    v_mul_u32_u24 v11, 3584, v11
    v_lshl_add_u32 v11, v12, 7, v11
    buffer_load_dword v13, v11, s[48:51], s37 offen
    s_add_u32 s38, s35, 64
    v_add_u32 v10, s38, v1
    s_mov_b32 s39, 149797
    v_mul_lo_u32 v11, v10, s39
    v_lshrrev_b32 v11, 20, v11
    v_mul_u32_u24 v12, 7, v11
    v_sub_u32 v12, v10, v12
    v_mul_u32_u24 v11, 3584, v11
    v_lshl_add_u32 v11, v12, 7, v11
    buffer_load_dword v13, v11, s[48:51], s37 offen
    s_add_u32 s38, s35, 128
    v_add_u32 v10, s38, v1
    s_mov_b32 s39, 149797
    v_mul_lo_u32 v11, v10, s39
    v_lshrrev_b32 v11, 20, v11
    v_mul_u32_u24 v12, 7, v11
    v_sub_u32 v12, v10, v12
    v_mul_u32_u24 v11, 3584, v11
    v_lshl_add_u32 v11, v12, 7, v11
    buffer_load_dword v13, v11, s[48:51], s37 offen
    s_add_u32 s38, s35, 192
    v_add_u32 v10, s38, v1
    s_mov_b32 s39, 149797
    v_mul_lo_u32 v11, v10, s39
    v_lshrrev_b32 v11, 20, v11
    v_mul_u32_u24 v12, 7, v11
    v_sub_u32 v12, v10, v12
    v_mul_u32_u24 v11, 3584, v11
    v_lshl_add_u32 v11, v12, 7, v11
    buffer_load_dword v13, v11, s[48:51], s37 offen
    s_add_u32 s38, s35, 256
    v_add_u32 v10, s38, v1
    s_mov_b32 s39, 149797
    v_mul_lo_u32 v11, v10, s39
    v_lshrrev_b32 v11, 20, v11
    v_mul_u32_u24 v12, 7, v11
    v_sub_u32 v12, v10, v12
    v_mul_u32_u24 v11, 3584, v11
    v_lshl_add_u32 v11, v12, 7, v11
    buffer_load_dword v13, v11, s[48:51], s37 offen
    s_add_u32 s38, s35, 320
    v_add_u32 v10, s38, v1
    s_mov_b32 s39, 149797
    v_mul_lo_u32 v11, v10, s39
    v_lshrrev_b32 v11, 20, v11
    v_mul_u32_u24 v12, 7, v11
    v_sub_u32 v12, v10, v12
    v_mul_u32_u24 v11, 3584, v11
    v_lshl_add_u32 v11, v12, 7, v11
    buffer_load_dword v13, v11, s[48:51], s37 offen
    s_add_u32 s38, s35, 384
    v_add_u32 v10, s38, v1
    s_mov_b32 s39, 149797
    v_mul_lo_u32 v11, v10, s39
    v_lshrrev_b32 v11, 20, v11
    v_mul_u32_u24 v12, 7, v11
    v_sub_u32 v12, v10, v12
    v_mul_u32_u24 v11, 3584, v11
    v_lshl_add_u32 v11, v12, 7, v11
    buffer_load_dword v13, v11, s[48:51], s37 offen
    s_sub_u32 s35, s2, 224
    s_lshl_b32 s35, s35, 3
    s_add_u32 s35, s35, s22
    s_mul_i32 s35, s35, 28672
    v_lshlrev_b32 v10, 7, v1
    s_add_u32 s38, s35, 0
    buffer_load_dword v13, v10, s[52:55], s38 offen
    s_add_u32 s38, s35, 8192
    buffer_load_dword v13, v10, s[52:55], s38 offen
    s_add_u32 s38, s35, 16384
    buffer_load_dword v13, v10, s[52:55], s38 offen
    s_add_u32 s38, s35, 24576
    s_mov_b64 exec, 0xffffffff
    buffer_load_dword v13, v10, s[52:55], s38 offen
    s_mov_b64 exec, -1
L_pg1a_go:
    s_nop 1
    s_load_dwordx2 s[20:21], s[0:1], 80
    s_load_dwordx2 s[4:5], s[0:1], 48
    s_load_dwordx2 s[12:13], s[0:1], 56
    v_and_b32 v1, 63, v0
    v_lshrrev_b32 v2, 6, v0
    s_nop 0
    v_readfirstlane_b32 s22, v2
    s_and_b32 s25, s2, 7
    s_lshr_b32 s26, s2, 3
    s_and_b32 s24, s25, 1
    s_lshl_b32 s24, s24, 2
    s_and_b32 s27, s26, 3
    s_add_u32 s24, s24, s27
    s_lshr_b32 s23, s25, 1
    s_mul_i32 s23, s23, 8
    s_lshr_b32 s27, s26, 2
    s_add_u32 s23, s23, s27
    s_and_b32 s47, s22, 3
    s_lshr_b32 s48, s22, 2
    v_lshrrev_b32 v3, 3, v1
    v_bfe_u32 v4, v1, 4, 2
    v_lshlrev_b32 v4, 1, v4
    v_and_b32 v5, 7, v1
    v_xor_b32 v4, v4, v5
    v_mul_u32_u24 v5, 4096, v3
    v_lshl_add_u32 v5, v4, 4, v5
    s_mul_i32 s27, s47, 1835008
    s_mul_i32 s28, s48, 65536
    s_add_u32 s27, s27, s28
    s_lshl_b32 s28, s23, 7
    s_add_u32 s27, s27, s28
    v_add_u32 v5, s27, v5
    v_lshrrev_b32 v7, 4, v1
    v_and_b32 v8, 7, v1
    v_lshlrev_b32 v8, 4, v8
    v_lshl_add_u32 v8, v7, 7, v8
    v_bfe_u32 v9, v1, 3, 1
    v_lshl_add_u32 v6, v9, 9, v8
    s_cmp_eq_u32 s48, 0
    s_cselect_b64 s[50:51], -1, 0
    v_cndmask_b32 v9, v8, v6, s[50:51]
    s_waitcnt lgkmcnt(0)
    s_and_b32 s5, s5, 0xffff
    s_mov_b32 s6, 0x700000
    s_mov_b32 s7, 0x00020000
    s_mov_b32 s8, s20
    s_and_b32 s9, s21, 0xffff
    s_mov_b32 s10, 0x4000000
    s_mov_b32 s11, 0x00020000
    s_and_b32 s13, s13, 0xffff
    s_mov_b32 s14, 0x1000
    s_mov_b32 s15, 0x00020000
    s_add_u32 s16, s20, 0xe00000
    s_addc_u32 s17, s21, 0
    s_and_b32 s17, s17, 0xffff
    s_mov_b32 s18, 0x1c0000
    s_mov_b32 s19, 0x00020000
    s_mul_i32 s29, s24, 56
    s_mul_i32 s30, s47, 14
    s_add_u32 s29, s29, s30
    s_mul_i32 s29, s29, 3584
    s_add_u32 s29, s29, 0xc00000
    s_lshl_b32 s30, s48, 11
    s_add_u32 s29, s29, s30
    s_mul_i32 s31, s47, 36864
    s_lshl_b32 s30, s48, 11
    s_add_u32 s49, s31, s30
    v_add_u32 v4, 31744, v5
    s_add_u32 m0, s49, 0
    s_mov_b32 s32, 0
    buffer_load_dwordx4 v5, s[4:7], s32 offen sc1 lds
    buffer_load_dwordx4 v4, s[4:7], s32 offen offset:1024 sc1 lds
    s_add_u32 m0, s49, 4096
    s_mov_b32 s32, 131072
    buffer_load_dwordx4 v5, s[4:7], s32 offen sc1 lds
    buffer_load_dwordx4 v4, s[4:7], s32 offen offset:1024 sc1 lds
    s_add_u32 m0, s49, 8192
    s_mov_b32 s32, 262144
    buffer_load_dwordx4 v5, s[4:7], s32 offen sc1 lds
    buffer_load_dwordx4 v4, s[4:7], s32 offen offset:1024 sc1 lds
    s_add_u32 m0, s49, 12288
    s_mov_b32 s32, 393216
    buffer_load_dwordx4 v5, s[4:7], s32 offen sc1 lds
    buffer_load_dwordx4 v4, s[4:7], s32 offen offset:1024 sc1 lds
    s_add_u32 m0, s49, 16384
    s_mov_b32 s32, 524288
    buffer_load_dwordx4 v5, s[4:7], s32 offen sc1 lds
    buffer_load_dwordx4 v4, s[4:7], s32 offen offset:1024 sc1 lds
    s_add_u32 m0, s49, 20480
    s_mov_b32 s32, 655360
    buffer_load_dwordx4 v5, s[4:7], s32 offen sc1 lds
    buffer_load_dwordx4 v4, s[4:7], s32 offen offset:1024 sc1 lds
    s_add_u32 m0, s49, 24576
    s_mov_b32 s32, 786432
    buffer_load_dwordx4 v5, s[4:7], s32 offen sc1 lds
    buffer_load_dwordx4 v4, s[4:7], s32 offen offset:1024 sc1 lds
    s_add_u32 m0, s49, 28672
    s_mov_b32 s32, 917504
    buffer_load_dwordx4 v5, s[4:7], s32 offen sc1 lds
    buffer_load_dwordx4 v4, s[4:7], s32 offen offset:1024 sc1 lds
    s_add_u32 m0, s49, 32768
    s_mov_b32 s32, 1048576
    buffer_load_dwordx4 v5, s[4:7], s32 offen sc1 lds
    buffer_load_dwordx4 v4, s[4:7], s32 offen offset:1024 sc1 lds
    s_lshl_b32 s34, s24, 7
    s_add_u32 s34, s34, 0x100c000
    v_mov_b32 v10, 0
    s_cmp_lg_u32 s22, 0
    s_cbranch_scc1 L_aww11
    s_mov_b64 exec, 0x1
    s_mov_b32 s45, 0x40000
L_awp11:
    buffer_load_dword v168, v10, s[8:11], s34 offen sc0 sc1
    s_waitcnt vmcnt(0)
    v_cmp_gt_u32 vcc, 28, v168
    s_cbranch_vccz L_awd11
    s_sub_u32 s45, s45, 1
    s_cmp_lg_u32 s45, 0
    s_cbranch_scc1 L_awp11
L_awd11:
    s_mov_b64 exec, -1
L_aww11:
    s_nop 0
    s_barrier
    s_add_u32 s33, s29, 0
    buffer_load_dwordx4 v[112:115], v6, s[8:11], s33 offen sc1
    buffer_load_dwordx4 v[116:119], v9, s[8:11], s33 offen offset:1024 sc1
    s_barrier
    s_add_u32 s33, s29, 3584
    buffer_load_dwordx4 v[120:123], v6, s[8:11], s33 offen sc1
    buffer_load_dwordx4 v[124:127], v9, s[8:11], s33 offen offset:1024 sc1
    s_add_u32 s33, s29, 7168
    buffer_load_dwordx4 v[128:131], v6, s[8:11], s33 offen sc1
    buffer_load_dwordx4 v[132:135], v9, s[8:11], s33 offen offset:1024 sc1
    s_add_u32 s33, s29, 10752
    buffer_load_dwordx4 v[136:139], v6, s[8:11], s33 offen sc1
    buffer_load_dwordx4 v[140:143], v9, s[8:11], s33 offen offset:1024 sc1
    s_add_u32 s33, s29, 14336
    buffer_load_dwordx4 v[144:147], v6, s[8:11], s33 offen sc1
    buffer_load_dwordx4 v[148:151], v9, s[8:11], s33 offen offset:1024 sc1
    s_add_u32 s33, s29, 17920
    buffer_load_dwordx4 v[152:155], v6, s[8:11], s33 offen sc1
    buffer_load_dwordx4 v[156:159], v9, s[8:11], s33 offen offset:1024 sc1
    s_add_u32 s33, s29, 21504
    buffer_load_dwordx4 v[160:163], v6, s[8:11], s33 offen sc1
    buffer_load_dwordx4 v[164:167], v9, s[8:11], s33 offen offset:1024 sc1
    s_lshl_b32 s36, s23, 2
    s_add_u32 s36, s36, s47
    s_mul_i32 s37, s36, 14336
    s_mul_i32 s38, s24, 1792
    s_add_u32 s37, s37, s38
    s_lshl_b32 s38, s48, 10
    s_add_u32 s37, s37, s38
    s_add_u32 s37, s37, 0x800000
    v_and_b32 v33, 15, v1
    v_lshlrev_b32 v35, 3, v33
    v_lshl_add_u32 v35, v7, 7, v35
    buffer_load_dwordx2 v[100:101], v35, s[8:11], s37 offen offset:0 sc1
    buffer_load_dwordx2 v[102:103], v35, s[8:11], s37 offen offset:512 sc1
    s_lshl_b32 s38, s36, 5
    v_lshlrev_b32 v36, 1, v33
    buffer_load_ushort v104, v36, s[12:15], s38 offen sc1
    v_bfe_u32 v12, v1, 2, 2
    v_and_b32 v13, 3, v1
    v_and_b32 v14, 1, v7
    v_lshlrev_b32 v15, 2, v7
    v_add_u32 v15, v15, v12
    v_lshlrev_b32 v15, 7, v15
    v_lshl_add_u32 v15, v13, 3, v15
    v_add_u32 v15, s31, v15
    v_lshrrev_b32 v32, 1, v12
    v_lshl_add_u32 v32, v14, 1, v32
    v_xor_b32 v33, 0, v32
    v_lshl_add_u32 v36, v33, 5, v15
    v_xor_b32 v33, 1, v32
    v_lshl_add_u32 v37, v33, 5, v15
    v_xor_b32 v33, 2, v32
    v_lshl_add_u32 v38, v33, 5, v15
    v_xor_b32 v33, 3, v32
    v_lshl_add_u32 v39, v33, 5, v15
    s_waitcnt vmcnt(15)
    s_barrier
    ds_read_b64_tr_b16 a[0:1], v36 offset:0
    ds_read_b64_tr_b16 a[2:3], v36 offset:2048
    ds_read_b64_tr_b16 a[4:5], v37 offset:0
    ds_read_b64_tr_b16 a[6:7], v37 offset:2048
    ds_read_b64_tr_b16 a[8:9], v38 offset:0
    ds_read_b64_tr_b16 a[10:11], v38 offset:2048
    ds_read_b64_tr_b16 a[12:13], v39 offset:0
    ds_read_b64_tr_b16 a[14:15], v39 offset:2048
    s_waitcnt lgkmcnt(6)
    v_mfma_f32_16x16x32_bf16 a[32:35], v[112:115], a[0:3], 0
    s_waitcnt vmcnt(11)
    s_barrier
    s_waitcnt lgkmcnt(4)
    v_mfma_f32_16x16x32_bf16 a[40:43], v[112:115], a[4:7], 0
    ds_read_b64_tr_b16 a[16:17], v36 offset:4096
    s_waitcnt lgkmcnt(3)
    v_mfma_f32_16x16x32_bf16 a[48:51], v[112:115], a[8:11], 0
    ds_read_b64_tr_b16 a[18:19], v36 offset:6144
    ds_read_b64_tr_b16 a[20:21], v37 offset:4096
    s_waitcnt lgkmcnt(3)
    v_mfma_f32_16x16x32_bf16 a[56:59], v[112:115], a[12:15], 0
    ds_read_b64_tr_b16 a[22:23], v37 offset:6144
    v_mfma_f32_16x16x32_bf16 a[36:39], v[116:119], a[0:3], 0
    ds_read_b64_tr_b16 a[24:25], v38 offset:4096
    v_mfma_f32_16x16x32_bf16 a[44:47], v[116:119], a[4:7], 0
    ds_read_b64_tr_b16 a[26:27], v38 offset:6144
    ds_read_b64_tr_b16 a[28:29], v39 offset:4096
    v_mfma_f32_16x16x32_bf16 a[52:55], v[116:119], a[8:11], 0
    ds_read_b64_tr_b16 a[30:31], v39 offset:6144
    v_mfma_f32_16x16x32_bf16 a[60:63], v[116:119], a[12:15], 0
    s_add_u32 s33, s29, 25088
    buffer_load_dwordx4 v[168:171], v6, s[8:11], s33 offen sc1
    buffer_load_dwordx4 v[172:175], v9, s[8:11], s33 offen offset:1024 sc1
    s_waitcnt lgkmcnt(6)
    v_mfma_f32_16x16x32_bf16 a[32:35], v[120:123], a[16:19], a[32:35]
    ds_read_b64_tr_b16 a[0:1], v36 offset:8192
    s_waitcnt lgkmcnt(5)
    v_mfma_f32_16x16x32_bf16 a[40:43], v[120:123], a[20:23], a[40:43]
    ds_read_b64_tr_b16 a[2:3], v36 offset:10240
    s_waitcnt lgkmcnt(4)
    v_mfma_f32_16x16x32_bf16 a[48:51], v[120:123], a[24:27], a[48:51]
    ds_read_b64_tr_b16 a[4:5], v37 offset:8192
    s_waitcnt lgkmcnt(3)
    v_mfma_f32_16x16x32_bf16 a[56:59], v[120:123], a[28:31], a[56:59]
    ds_read_b64_tr_b16 a[6:7], v37 offset:10240
    ds_read_b64_tr_b16 a[8:9], v38 offset:8192
    v_mfma_f32_16x16x32_bf16 a[36:39], v[124:127], a[16:19], a[36:39]
    ds_read_b64_tr_b16 a[10:11], v38 offset:10240
    v_mfma_f32_16x16x32_bf16 a[44:47], v[124:127], a[20:23], a[44:47]
    ds_read_b64_tr_b16 a[12:13], v39 offset:8192
    v_mfma_f32_16x16x32_bf16 a[52:55], v[124:127], a[24:27], a[52:55]
    ds_read_b64_tr_b16 a[14:15], v39 offset:10240
    v_mfma_f32_16x16x32_bf16 a[60:63], v[124:127], a[28:31], a[60:63]
    s_add_u32 s33, s29, 28672
    buffer_load_dwordx4 v[112:115], v6, s[8:11], s33 offen sc1
    buffer_load_dwordx4 v[116:119], v9, s[8:11], s33 offen offset:1024 sc1
    s_waitcnt lgkmcnt(6)
    v_mfma_f32_16x16x32_bf16 a[32:35], v[128:131], a[0:3], a[32:35]
    s_waitcnt vmcnt(11)
    s_barrier
    s_waitcnt lgkmcnt(4)
    v_mfma_f32_16x16x32_bf16 a[40:43], v[128:131], a[4:7], a[40:43]
    ds_read_b64_tr_b16 a[16:17], v36 offset:12288
    ds_read_b64_tr_b16 a[18:19], v36 offset:14336
    s_waitcnt lgkmcnt(4)
    v_mfma_f32_16x16x32_bf16 a[48:51], v[128:131], a[8:11], a[48:51]
    ds_read_b64_tr_b16 a[20:21], v37 offset:12288
    s_waitcnt lgkmcnt(3)
    v_mfma_f32_16x16x32_bf16 a[56:59], v[128:131], a[12:15], a[56:59]
    ds_read_b64_tr_b16 a[22:23], v37 offset:14336
    ds_read_b64_tr_b16 a[24:25], v38 offset:12288
    v_mfma_f32_16x16x32_bf16 a[36:39], v[132:135], a[0:3], a[36:39]
    ds_read_b64_tr_b16 a[26:27], v38 offset:14336
    ds_read_b64_tr_b16 a[28:29], v39 offset:12288
    v_mfma_f32_16x16x32_bf16 a[44:47], v[132:135], a[4:7], a[44:47]
    ds_read_b64_tr_b16 a[30:31], v39 offset:14336
    v_mfma_f32_16x16x32_bf16 a[52:55], v[132:135], a[8:11], a[52:55]
    s_add_u32 m0, s49, 0
    s_mov_b32 s32, 1179648
    buffer_load_dwordx4 v5, s[4:7], s32 offen sc1 lds
    buffer_load_dwordx4 v4, s[4:7], s32 offen offset:1024 sc1 lds
    v_mfma_f32_16x16x32_bf16 a[60:63], v[132:135], a[12:15], a[60:63]
    s_add_u32 s33, s29, 32256
    buffer_load_dwordx4 v[120:123], v6, s[8:11], s33 offen sc1
    buffer_load_dwordx4 v[124:127], v9, s[8:11], s33 offen offset:1024 sc1
    s_waitcnt lgkmcnt(6)
    v_mfma_f32_16x16x32_bf16 a[32:35], v[136:139], a[16:19], a[32:35]
    ds_read_b64_tr_b16 a[0:1], v36 offset:16384
    s_waitcnt lgkmcnt(5)
    v_mfma_f32_16x16x32_bf16 a[40:43], v[136:139], a[20:23], a[40:43]
    ds_read_b64_tr_b16 a[2:3], v36 offset:18432
    ds_read_b64_tr_b16 a[4:5], v37 offset:16384
    s_waitcnt lgkmcnt(5)
    v_mfma_f32_16x16x32_bf16 a[48:51], v[136:139], a[24:27], a[48:51]
    ds_read_b64_tr_b16 a[6:7], v37 offset:18432
    s_waitcnt lgkmcnt(4)
    v_mfma_f32_16x16x32_bf16 a[56:59], v[136:139], a[28:31], a[56:59]
    ds_read_b64_tr_b16 a[8:9], v38 offset:16384
    ds_read_b64_tr_b16 a[10:11], v38 offset:18432
    v_mfma_f32_16x16x32_bf16 a[36:39], v[140:143], a[16:19], a[36:39]
    ds_read_b64_tr_b16 a[12:13], v39 offset:16384
    v_mfma_f32_16x16x32_bf16 a[44:47], v[140:143], a[20:23], a[44:47]
    ds_read_b64_tr_b16 a[14:15], v39 offset:18432
    s_add_u32 m0, s49, 4096
    s_mov_b32 s32, 1310720
    buffer_load_dwordx4 v5, s[4:7], s32 offen sc1 lds
    v_mfma_f32_16x16x32_bf16 a[52:55], v[140:143], a[24:27], a[52:55]
    buffer_load_dwordx4 v4, s[4:7], s32 offen offset:1024 sc1 lds
    v_mfma_f32_16x16x32_bf16 a[60:63], v[140:143], a[28:31], a[60:63]
    s_add_u32 s33, s29, 35840
    buffer_load_dwordx4 v[128:131], v6, s[8:11], s33 offen sc1
    buffer_load_dwordx4 v[132:135], v9, s[8:11], s33 offen offset:1024 sc1
    s_waitcnt lgkmcnt(6)
    v_mfma_f32_16x16x32_bf16 a[32:35], v[144:147], a[0:3], a[32:35]
    s_waitcnt vmcnt(15)
    s_barrier
    s_waitcnt lgkmcnt(4)
    v_mfma_f32_16x16x32_bf16 a[40:43], v[144:147], a[4:7], a[40:43]
    ds_read_b64_tr_b16 a[16:17], v36 offset:20480
    ds_read_b64_tr_b16 a[18:19], v36 offset:22528
    s_waitcnt lgkmcnt(4)
    v_mfma_f32_16x16x32_bf16 a[48:51], v[144:147], a[8:11], a[48:51]
    ds_read_b64_tr_b16 a[20:21], v37 offset:20480
    s_waitcnt lgkmcnt(3)
    v_mfma_f32_16x16x32_bf16 a[56:59], v[144:147], a[12:15], a[56:59]
    ds_read_b64_tr_b16 a[22:23], v37 offset:22528
    ds_read_b64_tr_b16 a[24:25], v38 offset:20480
    v_mfma_f32_16x16x32_bf16 a[36:39], v[148:151], a[0:3], a[36:39]
    ds_read_b64_tr_b16 a[26:27], v38 offset:22528
    ds_read_b64_tr_b16 a[28:29], v39 offset:20480
    v_mfma_f32_16x16x32_bf16 a[44:47], v[148:151], a[4:7], a[44:47]
    ds_read_b64_tr_b16 a[30:31], v39 offset:22528
    v_mfma_f32_16x16x32_bf16 a[52:55], v[148:151], a[8:11], a[52:55]
    s_add_u32 m0, s49, 8192
    s_mov_b32 s32, 1441792
    buffer_load_dwordx4 v5, s[4:7], s32 offen sc1 lds
    buffer_load_dwordx4 v4, s[4:7], s32 offen offset:1024 sc1 lds
    v_mfma_f32_16x16x32_bf16 a[60:63], v[148:151], a[12:15], a[60:63]
    s_add_u32 s33, s29, 39424
    buffer_load_dwordx4 v[136:139], v6, s[8:11], s33 offen sc1
    buffer_load_dwordx4 v[140:143], v9, s[8:11], s33 offen offset:1024 sc1
    s_waitcnt lgkmcnt(6)
    v_mfma_f32_16x16x32_bf16 a[32:35], v[152:155], a[16:19], a[32:35]
    ds_read_b64_tr_b16 a[0:1], v36 offset:24576
    s_waitcnt lgkmcnt(5)
    v_mfma_f32_16x16x32_bf16 a[40:43], v[152:155], a[20:23], a[40:43]
    ds_read_b64_tr_b16 a[2:3], v36 offset:26624
    ds_read_b64_tr_b16 a[4:5], v37 offset:24576
    s_waitcnt lgkmcnt(5)
    v_mfma_f32_16x16x32_bf16 a[48:51], v[152:155], a[24:27], a[48:51]
    ds_read_b64_tr_b16 a[6:7], v37 offset:26624
    s_waitcnt lgkmcnt(4)
    v_mfma_f32_16x16x32_bf16 a[56:59], v[152:155], a[28:31], a[56:59]
    ds_read_b64_tr_b16 a[8:9], v38 offset:24576
    ds_read_b64_tr_b16 a[10:11], v38 offset:26624
    v_mfma_f32_16x16x32_bf16 a[36:39], v[156:159], a[16:19], a[36:39]
    ds_read_b64_tr_b16 a[12:13], v39 offset:24576
    v_mfma_f32_16x16x32_bf16 a[44:47], v[156:159], a[20:23], a[44:47]
    ds_read_b64_tr_b16 a[14:15], v39 offset:26624
    s_add_u32 m0, s49, 12288
    s_mov_b32 s32, 1572864
    buffer_load_dwordx4 v5, s[4:7], s32 offen sc1 lds
    v_mfma_f32_16x16x32_bf16 a[52:55], v[156:159], a[24:27], a[52:55]
    buffer_load_dwordx4 v4, s[4:7], s32 offen offset:1024 sc1 lds
    v_mfma_f32_16x16x32_bf16 a[60:63], v[156:159], a[28:31], a[60:63]
    s_add_u32 s33, s29, 43008
    buffer_load_dwordx4 v[144:147], v6, s[8:11], s33 offen sc1
    buffer_load_dwordx4 v[148:151], v9, s[8:11], s33 offen offset:1024 sc1
    s_waitcnt lgkmcnt(6)
    v_mfma_f32_16x16x32_bf16 a[32:35], v[160:163], a[0:3], a[32:35]
    s_waitcnt vmcnt(16)
    s_barrier
    s_waitcnt lgkmcnt(4)
    v_mfma_f32_16x16x32_bf16 a[40:43], v[160:163], a[4:7], a[40:43]
    ds_read_b64_tr_b16 a[16:17], v36 offset:28672
    ds_read_b64_tr_b16 a[18:19], v36 offset:30720
    s_waitcnt lgkmcnt(4)
    v_mfma_f32_16x16x32_bf16 a[48:51], v[160:163], a[8:11], a[48:51]
    ds_read_b64_tr_b16 a[20:21], v37 offset:28672
    s_waitcnt lgkmcnt(3)
    v_mfma_f32_16x16x32_bf16 a[56:59], v[160:163], a[12:15], a[56:59]
    ds_read_b64_tr_b16 a[22:23], v37 offset:30720
    ds_read_b64_tr_b16 a[24:25], v38 offset:28672
    v_mfma_f32_16x16x32_bf16 a[36:39], v[164:167], a[0:3], a[36:39]
    ds_read_b64_tr_b16 a[26:27], v38 offset:30720
    ds_read_b64_tr_b16 a[28:29], v39 offset:28672
    v_mfma_f32_16x16x32_bf16 a[44:47], v[164:167], a[4:7], a[44:47]
    ds_read_b64_tr_b16 a[30:31], v39 offset:30720
    v_mfma_f32_16x16x32_bf16 a[52:55], v[164:167], a[8:11], a[52:55]
    s_add_u32 m0, s49, 16384
    s_mov_b32 s32, 1703936
    buffer_load_dwordx4 v5, s[4:7], s32 offen sc1 lds
    buffer_load_dwordx4 v4, s[4:7], s32 offen offset:1024 sc1 lds
    v_mfma_f32_16x16x32_bf16 a[60:63], v[164:167], a[12:15], a[60:63]
    s_add_u32 s33, s29, 46592
    buffer_load_dwordx4 v[152:155], v6, s[8:11], s33 offen sc1
    buffer_load_dwordx4 v[156:159], v9, s[8:11], s33 offen offset:1024 sc1
    s_waitcnt lgkmcnt(6)
    v_mfma_f32_16x16x32_bf16 a[32:35], v[168:171], a[16:19], a[32:35]
    ds_read_b64_tr_b16 a[0:1], v36 offset:32768
    s_waitcnt lgkmcnt(5)
    v_mfma_f32_16x16x32_bf16 a[40:43], v[168:171], a[20:23], a[40:43]
    ds_read_b64_tr_b16 a[2:3], v36 offset:34816
    s_waitcnt lgkmcnt(4)
    v_mfma_f32_16x16x32_bf16 a[48:51], v[168:171], a[24:27], a[48:51]
    ds_read_b64_tr_b16 a[4:5], v37 offset:32768
    s_waitcnt lgkmcnt(3)
    v_mfma_f32_16x16x32_bf16 a[56:59], v[168:171], a[28:31], a[56:59]
    ds_read_b64_tr_b16 a[6:7], v37 offset:34816
    v_mfma_f32_16x16x32_bf16 a[36:39], v[172:175], a[16:19], a[36:39]
    ds_read_b64_tr_b16 a[8:9], v38 offset:32768
    v_mfma_f32_16x16x32_bf16 a[44:47], v[172:175], a[20:23], a[44:47]
    ds_read_b64_tr_b16 a[10:11], v38 offset:34816
    v_mfma_f32_16x16x32_bf16 a[52:55], v[172:175], a[24:27], a[52:55]
    ds_read_b64_tr_b16 a[12:13], v39 offset:32768
    v_mfma_f32_16x16x32_bf16 a[60:63], v[172:175], a[28:31], a[60:63]
    ds_read_b64_tr_b16 a[14:15], v39 offset:34816
    s_waitcnt lgkmcnt(6)
    v_mfma_f32_16x16x32_bf16 a[32:35], v[112:115], a[0:3], a[32:35]
    s_waitcnt vmcnt(12)
    s_barrier
    s_waitcnt lgkmcnt(4)
    v_mfma_f32_16x16x32_bf16 a[40:43], v[112:115], a[4:7], a[40:43]
    ds_read_b64_tr_b16 a[16:17], v36 offset:0
    s_waitcnt lgkmcnt(3)
    v_mfma_f32_16x16x32_bf16 a[48:51], v[112:115], a[8:11], a[48:51]
    ds_read_b64_tr_b16 a[18:19], v36 offset:2048
    s_waitcnt lgkmcnt(2)
    v_mfma_f32_16x16x32_bf16 a[56:59], v[112:115], a[12:15], a[56:59]
    ds_read_b64_tr_b16 a[20:21], v37 offset:0
    v_mfma_f32_16x16x32_bf16 a[36:39], v[116:119], a[0:3], a[36:39]
    ds_read_b64_tr_b16 a[22:23], v37 offset:2048
    v_mfma_f32_16x16x32_bf16 a[44:47], v[116:119], a[4:7], a[44:47]
    ds_read_b64_tr_b16 a[24:25], v38 offset:0
    v_mfma_f32_16x16x32_bf16 a[52:55], v[116:119], a[8:11], a[52:55]
    ds_read_b64_tr_b16 a[26:27], v38 offset:2048
    v_mfma_f32_16x16x32_bf16 a[60:63], v[116:119], a[12:15], a[60:63]
    ds_read_b64_tr_b16 a[28:29], v39 offset:0
    ds_read_b64_tr_b16 a[30:31], v39 offset:2048
    s_waitcnt lgkmcnt(6)
    v_mfma_f32_16x16x32_bf16 a[32:35], v[120:123], a[16:19], a[32:35]
    ds_read_b64_tr_b16 a[0:1], v36 offset:4096
    s_waitcnt lgkmcnt(5)
    v_mfma_f32_16x16x32_bf16 a[40:43], v[120:123], a[20:23], a[40:43]
    ds_read_b64_tr_b16 a[2:3], v36 offset:6144
    s_waitcnt lgkmcnt(4)
    v_mfma_f32_16x16x32_bf16 a[48:51], v[120:123], a[24:27], a[48:51]
    ds_read_b64_tr_b16 a[4:5], v37 offset:4096
    s_waitcnt lgkmcnt(3)
    v_mfma_f32_16x16x32_bf16 a[56:59], v[120:123], a[28:31], a[56:59]
    ds_read_b64_tr_b16 a[6:7], v37 offset:6144
    v_mfma_f32_16x16x32_bf16 a[36:39], v[124:127], a[16:19], a[36:39]
    ds_read_b64_tr_b16 a[8:9], v38 offset:4096
    v_mfma_f32_16x16x32_bf16 a[44:47], v[124:127], a[20:23], a[44:47]
    ds_read_b64_tr_b16 a[10:11], v38 offset:6144
    v_mfma_f32_16x16x32_bf16 a[52:55], v[124:127], a[24:27], a[52:55]
    ds_read_b64_tr_b16 a[12:13], v39 offset:4096
    v_mfma_f32_16x16x32_bf16 a[60:63], v[124:127], a[28:31], a[60:63]
    ds_read_b64_tr_b16 a[14:15], v39 offset:6144
    s_waitcnt lgkmcnt(6)
    v_mfma_f32_16x16x32_bf16 a[32:35], v[128:131], a[0:3], a[32:35]
    s_waitcnt vmcnt(4)
    s_barrier
    s_waitcnt lgkmcnt(4)
    v_mfma_f32_16x16x32_bf16 a[40:43], v[128:131], a[4:7], a[40:43]
    ds_read_b64_tr_b16 a[16:17], v36 offset:8192
    s_waitcnt lgkmcnt(3)
    v_mfma_f32_16x16x32_bf16 a[48:51], v[128:131], a[8:11], a[48:51]
    ds_read_b64_tr_b16 a[18:19], v36 offset:10240
    s_waitcnt lgkmcnt(2)
    v_mfma_f32_16x16x32_bf16 a[56:59], v[128:131], a[12:15], a[56:59]
    ds_read_b64_tr_b16 a[20:21], v37 offset:8192
    v_mfma_f32_16x16x32_bf16 a[36:39], v[132:135], a[0:3], a[36:39]
    ds_read_b64_tr_b16 a[22:23], v37 offset:10240
    v_mfma_f32_16x16x32_bf16 a[44:47], v[132:135], a[4:7], a[44:47]
    ds_read_b64_tr_b16 a[24:25], v38 offset:8192
    v_mfma_f32_16x16x32_bf16 a[52:55], v[132:135], a[8:11], a[52:55]
    ds_read_b64_tr_b16 a[26:27], v38 offset:10240
    v_mfma_f32_16x16x32_bf16 a[60:63], v[132:135], a[12:15], a[60:63]
    ds_read_b64_tr_b16 a[28:29], v39 offset:8192
    ds_read_b64_tr_b16 a[30:31], v39 offset:10240
    s_waitcnt lgkmcnt(6)
    v_mfma_f32_16x16x32_bf16 a[32:35], v[136:139], a[16:19], a[32:35]
    ds_read_b64_tr_b16 a[0:1], v36 offset:12288
    s_waitcnt lgkmcnt(5)
    v_mfma_f32_16x16x32_bf16 a[40:43], v[136:139], a[20:23], a[40:43]
    ds_read_b64_tr_b16 a[2:3], v36 offset:14336
    s_waitcnt lgkmcnt(4)
    v_mfma_f32_16x16x32_bf16 a[48:51], v[136:139], a[24:27], a[48:51]
    ds_read_b64_tr_b16 a[4:5], v37 offset:12288
    s_waitcnt lgkmcnt(3)
    v_mfma_f32_16x16x32_bf16 a[56:59], v[136:139], a[28:31], a[56:59]
    ds_read_b64_tr_b16 a[6:7], v37 offset:14336
    v_mfma_f32_16x16x32_bf16 a[36:39], v[140:143], a[16:19], a[36:39]
    ds_read_b64_tr_b16 a[8:9], v38 offset:12288
    v_mfma_f32_16x16x32_bf16 a[44:47], v[140:143], a[20:23], a[44:47]
    ds_read_b64_tr_b16 a[10:11], v38 offset:14336
    v_mfma_f32_16x16x32_bf16 a[52:55], v[140:143], a[24:27], a[52:55]
    ds_read_b64_tr_b16 a[12:13], v39 offset:12288
    v_mfma_f32_16x16x32_bf16 a[60:63], v[140:143], a[28:31], a[60:63]
    ds_read_b64_tr_b16 a[14:15], v39 offset:14336
    s_waitcnt lgkmcnt(6)
    v_mfma_f32_16x16x32_bf16 a[32:35], v[144:147], a[0:3], a[32:35]
    s_waitcnt vmcnt(0)
    s_barrier
    s_waitcnt lgkmcnt(4)
    v_mfma_f32_16x16x32_bf16 a[40:43], v[144:147], a[4:7], a[40:43]
    ds_read_b64_tr_b16 a[16:17], v36 offset:16384
    s_waitcnt lgkmcnt(3)
    v_mfma_f32_16x16x32_bf16 a[48:51], v[144:147], a[8:11], a[48:51]
    ds_read_b64_tr_b16 a[18:19], v36 offset:18432
    s_waitcnt lgkmcnt(2)
    v_mfma_f32_16x16x32_bf16 a[56:59], v[144:147], a[12:15], a[56:59]
    ds_read_b64_tr_b16 a[20:21], v37 offset:16384
    v_mfma_f32_16x16x32_bf16 a[36:39], v[148:151], a[0:3], a[36:39]
    ds_read_b64_tr_b16 a[22:23], v37 offset:18432
    v_mfma_f32_16x16x32_bf16 a[44:47], v[148:151], a[4:7], a[44:47]
    ds_read_b64_tr_b16 a[24:25], v38 offset:16384
    v_mfma_f32_16x16x32_bf16 a[52:55], v[148:151], a[8:11], a[52:55]
    ds_read_b64_tr_b16 a[26:27], v38 offset:18432
    v_mfma_f32_16x16x32_bf16 a[60:63], v[148:151], a[12:15], a[60:63]
    ds_read_b64_tr_b16 a[28:29], v39 offset:16384
    ds_read_b64_tr_b16 a[30:31], v39 offset:18432
    s_waitcnt lgkmcnt(6)
    v_mfma_f32_16x16x32_bf16 a[32:35], v[152:155], a[16:19], a[32:35]
    s_waitcnt lgkmcnt(4)
    v_mfma_f32_16x16x32_bf16 a[40:43], v[152:155], a[20:23], a[40:43]
    s_waitcnt lgkmcnt(2)
    v_mfma_f32_16x16x32_bf16 a[48:51], v[152:155], a[24:27], a[48:51]
    s_waitcnt lgkmcnt(0)
    v_mfma_f32_16x16x32_bf16 a[56:59], v[152:155], a[28:31], a[56:59]
    v_mfma_f32_16x16x32_bf16 a[36:39], v[156:159], a[16:19], a[36:39]
    v_mfma_f32_16x16x32_bf16 a[44:47], v[156:159], a[20:23], a[44:47]
    v_mfma_f32_16x16x32_bf16 a[52:55], v[156:159], a[24:27], a[52:55]
    v_mfma_f32_16x16x32_bf16 a[60:63], v[156:159], a[28:31], a[60:63]
    v_lshlrev_b32 v34, 4, v1
    s_lshl_b32 s35, s48, 13
    s_add_u32 s34, s31, s35
    s_add_u32 s34, s34, 20480
    v_add_u32 v33, s34, v34
    ds_write_b128 v33, a[32:35] offset:0
    ds_write_b128 v33, a[36:39] offset:1024
    ds_write_b128 v33, a[40:43] offset:2048
    ds_write_b128 v33, a[44:47] offset:3072
    ds_write_b128 v33, a[48:51] offset:4096
    ds_write_b128 v33, a[52:55] offset:5120
    ds_write_b128 v33, a[56:59] offset:6144
    ds_write_b128 v33, a[60:63] offset:7168
    s_waitcnt lgkmcnt(0)
    s_barrier
    s_lshl_b32 s34, s47, 11
    s_add_u32 s34, s34, s35
    s_add_u32 s34, s34, 20480
    v_add_u32 v33, s34, v34
    v_add_u32 v35, 73728, v33
    ds_read_b128 v[40:43], v33 offset:0
    ds_read_b128 v[48:51], v33 offset:36864
    ds_read_b128 v[56:59], v35 offset:0
    ds_read_b128 v[64:67], v35 offset:36864
    ds_read_b128 v[44:47], v33 offset:1024
    ds_read_b128 v[52:55], v33 offset:37888
    ds_read_b128 v[60:63], v35 offset:1024
    ds_read_b128 v[68:71], v35 offset:37888
    s_waitcnt lgkmcnt(6)
    v_add_f32 v40, v40, v48
    s_waitcnt lgkmcnt(4)
    v_add_f32 v56, v56, v64
    v_add_f32 v41, v41, v49
    v_add_f32 v57, v57, v65
    v_add_f32 v42, v42, v50
    v_add_f32 v58, v58, v66
    v_add_f32 v43, v43, v51
    v_add_f32 v59, v59, v67
    v_add_f32 v40, v40, v56
    v_add_f32 v41, v41, v57
    v_add_f32 v42, v42, v58
    v_add_f32 v43, v43, v59
    s_waitcnt lgkmcnt(2)
    v_add_f32 v44, v44, v52
    s_waitcnt lgkmcnt(0)
    v_add_f32 v60, v60, v68
    v_add_f32 v45, v45, v53
    v_add_f32 v61, v61, v69
    v_add_f32 v46, v46, v54
    v_add_f32 v62, v62, v70
    v_add_f32 v47, v47, v55
    v_add_f32 v63, v63, v71
    v_add_f32 v44, v44, v60
    v_add_f32 v45, v45, v61
    v_add_f32 v46, v46, v62
    v_add_f32 v47, v47, v63
    v_and_b32 v33, 15, v1
    v_lshlrev_b32 v76, 16, v104
    v_lshlrev_b32 v77, 16, v100
    v_and_b32 v78, 0xffff0000, v100
    v_add_f32 v40, v40, v76
    v_add_f32 v41, v41, v76
    v_add_f32 v40, v40, v77
    v_add_f32 v41, v41, v78
    v_cvt_pk_bf16_f32 v88, v40, v41
    v_lshlrev_b32 v77, 16, v101
    v_and_b32 v78, 0xffff0000, v101
    v_add_f32 v42, v42, v76
    v_add_f32 v43, v43, v76
    v_add_f32 v42, v42, v77
    v_add_f32 v43, v43, v78
    v_cvt_pk_bf16_f32 v89, v42, v43
    v_lshlrev_b32 v77, 16, v102
    v_and_b32 v78, 0xffff0000, v102
    v_add_f32 v44, v44, v76
    v_add_f32 v45, v45, v76
    v_add_f32 v44, v44, v77
    v_add_f32 v45, v45, v78
    v_cvt_pk_bf16_f32 v90, v44, v45
    v_lshlrev_b32 v77, 16, v103
    v_and_b32 v78, 0xffff0000, v103
    v_add_f32 v46, v46, v76
    v_add_f32 v47, v47, v76
    v_add_f32 v46, v46, v77
    v_add_f32 v47, v47, v78
    v_cvt_pk_bf16_f32 v91, v46, v47
    s_cmp_eq_u32 s48, 0
    s_cselect_b32 s45, -1, 0
    s_mov_b32 s44, -1
    v_cndmask_b32 v92, 0, v90, s[44:45]
    v_cndmask_b32 v93, 0, v91, s[44:45]
    v_mov_b32 v77, 0x3f803f80
    v_mov_b32 v78, 0
    v_mov_b32 v79, 0
    v_dot2_f32_bf16 v78, v88, v77, v78
    v_dot2_f32_bf16 v79, v88, v88, v79
    v_dot2_f32_bf16 v78, v89, v77, v78
    v_dot2_f32_bf16 v79, v89, v89, v79
    v_dot2_f32_bf16 v78, v92, v77, v78
    v_dot2_f32_bf16 v79, v92, v92, v79
    v_dot2_f32_bf16 v78, v93, v77, v78
    v_dot2_f32_bf16 v79, v93, v93, v79
    s_nop 1
    v_mov_b32 v80, v78
    s_nop 1
    v_permlane16_swap_b32 v80, v78
    v_add_f32 v78, v78, v80
    v_mov_b32 v80, v78
    s_nop 1
    v_permlane32_swap_b32 v80, v78
    v_add_f32 v78, v78, v80
    v_mov_b32 v81, v79
    s_nop 1
    v_permlane16_swap_b32 v81, v79
    v_add_f32 v79, v79, v81
    v_mov_b32 v81, v79
    s_nop 1
    v_permlane32_swap_b32 v81, v79
    v_add_f32 v79, v79, v81
    v_cmp_gt_u32 vcc, 16, v1
    s_nop 1
    v_cndmask_b32 v80, v79, v78, vcc
    v_lshlrev_b32 v81, 2, v1
    s_lshl_b32 s39, s36, 7
    s_add_u32 s39, s39, 0x1004000
    s_mov_b64 exec, 0xffffffff
    buffer_atomic_add_f32 v80, v81, s[8:11], s39 offen
    s_mov_b64 exec, -1
    s_lshl_b32 s40, s22, 11
    s_add_u32 s40, s40, 147456
    v_mul_u32_u24 v36, 80, v33
    v_lshl_add_u32 v36, v7, 3, v36
    v_add_u32 v36, s40, v36
    ds_write_b64 v36, v[88:89] offset:0
    ds_write_b64 v36, v[90:91] offset:32
    v_lshrrev_b32 v37, 2, v1
    v_and_b32 v38, 3, v1
    v_mul_u32_u24 v39, 80, v37
    v_lshl_add_u32 v39, v38, 4, v39
    v_add_u32 v39, s40, v39
    ds_read_b128 v[92:95], v39
    s_lshl_b32 s39, s36, 3
    s_add_u32 s39, s39, s24
    s_mul_i32 s39, s39, 1792
    s_lshl_b32 s41, s48, 10
    s_add_u32 s39, s39, s41
    s_lshl_b32 s41, s48, 4
    s_sub_u32 s41, 64, s41
    v_mul_lo_u32 v37, v37, s41
    v_lshl_add_u32 v37, v38, 4, v37
    s_cmp_eq_u32 s48, 0
    s_cselect_b32 s44, -1, 0x77777777
    s_mov_b32 s45, s44
    s_mov_b64 exec, s[44:45]
    s_waitcnt lgkmcnt(0)
    buffer_store_dwordx4 v[92:95], v37, s[16:19], s39 offen sc0 sc1
    s_mov_b64 exec, -1
    s_lshr_b32 s34, s23, 1
    s_lshl_b32 s34, s34, 7
    s_add_u32 s34, s34, 0x100e000
    s_waitcnt vmcnt(0) lgkmcnt(0)
    s_barrier
    v_mov_b32 v10, 0
    v_mov_b32 v11, 1
    v_cmp_eq_u32 vcc, 0, v0
    s_and_saveexec_b64 s[44:45], vcc
    s_cbranch_execz L_pub12
    buffer_atomic_add v11, v10, s[8:11], s34 offen sc1
L_pub12:
    s_mov_b64 exec, -1
    s_nop 1
    s_load_dwordx2 s[20:21], s[0:1], 80
    v_and_b32 v1, 63, v0
    v_lshrrev_b32 v2, 6, v0
    s_nop 0
    v_readfirstlane_b32 s22, v2
    s_lshr_b32 s23, s2, 4
    s_and_b32 s24, s2, 15
    s_and_b32 s47, s22, 3
    s_lshr_b32 s48, s22, 2
    s_lshl_b32 s25, s23, 7
    s_lshl_b32 s26, s47, 5
    s_add_u32 s49, s25, s26
    v_lshrrev_b32 v16, 3, v1
    v_lshrrev_b32 v17, 4, v1
    v_and_b32 v18, 7, v1
    v_xor_b32 v60, v18, v17
    v_xor_b32 v61, 4, v60
    v_lshlrev_b32 v62, 6, v16
    v_mul_u32_u24 v63, 48, v16
    v_add_u32 v63, 960, v63
    v_add_u32 v6, 512, v62
    v_add_u32 v7, 384, v63
    s_lshl_b32 s59, s23, 3
    s_lshl_b32 s26, s47, 1
    s_add_u32 s59, s59, s26
    s_add_u32 s59, s59, s48
    s_mul_i32 s59, s59, 14336
    s_add_u32 s59, s59, 4096
    s_sub_u32 s60, s59, 1024
    s_mul_i32 s26, s24, 86016
    s_mul_i32 s27, s22, 1536
    s_add_u32 s26, s26, s27
    v_lshlrev_b32 v4, 4, v1
    v_add_u32 v4, s26, v4
    v_mov_b32 v5, v4
    s_waitcnt lgkmcnt(0)
    s_add_u32 s4, s20, 0xdff000
    s_addc_u32 s5, s21, 0
    s_and_b32 s5, s5, 0xffff
    s_mov_b32 s6, 0x1c1000
    s_mov_b32 s7, 0x00020000
    s_add_u32 s8, s20, 0x1200000
    s_addc_u32 s9, s21, 0
    s_and_b32 s9, s9, 0xffff
    s_mov_b32 s10, 0x150000
    s_mov_b32 s11, 0x00020000
    s_mov_b32 s12, s20
    s_and_b32 s13, s21, 0xffff
    s_mov_b32 s14, 0x4000000
    s_mov_b32 s15, 0x00020000
    s_lshl_b32 s28, s47, 12
    s_lshl_b32 s29, s48, 11
    s_add_u32 s28, s28, s29
    s_mul_i32 s29, s22, 1536
    s_add_u32 s29, s29, 16384
    s_add_u32 s35, s23, s24
    s_mul_i32 s34, s35, 9363
    s_lshr_b32 s34, s34, 16
    s_mul_i32 s34, s34, 7
    s_sub_u32 s34, s35, s34
    s_add_u32 s52, s34, 0
    s_cmp_ge_u32 s52, 7
    s_cselect_b32 s35, 7, 0
    s_sub_u32 s52, s52, s35
    s_add_u32 s53, s34, 1
    s_cmp_ge_u32 s53, 7
    s_cselect_b32 s35, 7, 0
    s_sub_u32 s53, s53, s35
    s_add_u32 s54, s34, 2
    s_cmp_ge_u32 s54, 7
    s_cselect_b32 s35, 7, 0
    s_sub_u32 s54, s54, s35
    s_add_u32 s55, s34, 3
    s_cmp_ge_u32 s55, 7
    s_cselect_b32 s35, 7, 0
    s_sub_u32 s55, s55, s35
    s_add_u32 s56, s34, 4
    s_cmp_ge_u32 s56, 7
    s_cselect_b32 s35, 7, 0
    s_sub_u32 s56, s56, s35
    s_add_u32 s57, s34, 5
    s_cmp_ge_u32 s57, 7
    s_cselect_b32 s35, 7, 0
    s_sub_u32 s57, s57, s35
    s_add_u32 s58, s34, 6
    s_cmp_ge_u32 s58, 7
    s_cselect_b32 s35, 7, 0
    s_sub_u32 s58, s58, s35
    s_add_u32 m0, s29, 0
    s_mul_i32 s31, s52, 12288
    buffer_load_dwordx4 v4, s[8:11], s31 offen sc1 lds
    s_mov_b64 exec, 0xffffffff
    buffer_load_dwordx4 v5, s[8:11], s31 offen offset:1024 sc1 lds
    s_mov_b64 exec, -1
    s_add_u32 m0, s29, 28672
    s_mul_i32 s31, s53, 12288
    buffer_load_dwordx4 v4, s[8:11], s31 offen sc1 lds
    s_mov_b64 exec, 0xffffffff
    buffer_load_dwordx4 v5, s[8:11], s31 offen offset:1024 sc1 lds
    s_mov_b64 exec, -1
    s_add_u32 m0, s29, 57344
    s_mul_i32 s31, s54, 12288
    buffer_load_dwordx4 v4, s[8:11], s31 offen sc1 lds
    s_mov_b64 exec, 0xffffffff
    buffer_load_dwordx4 v5, s[8:11], s31 offen offset:1024 sc1 lds
    s_mov_b64 exec, -1
    s_add_u32 m0, s29, 86016
    s_mul_i32 s31, s55, 12288
    buffer_load_dwordx4 v4, s[8:11], s31 offen sc1 lds
    s_mov_b64 exec, 0xffffffff
    buffer_load_dwordx4 v5, s[8:11], s31 offen offset:1024 sc1 lds
    s_mov_b64 exec, -1
    s_add_u32 m0, s29, 114688
    s_mul_i32 s31, s56, 12288
    buffer_load_dwordx4 v4, s[8:11], s31 offen sc1 lds
    s_mov_b64 exec, 0xffffffff
    buffer_load_dwordx4 v5, s[8:11], s31 offen offset:1024 sc1 lds
    s_mov_b64 exec, -1
    v_lshrrev_b32 v17, 5, v1
    v_lshlrev_b32 v17, 4, v17
    s_mul_i32 s32, s24, 384
    s_add_u32 s33, s32, 0x1380000
    buffer_load_dwordx4 v[120:123], v17, s[12:15], s33 offen offset:0 sc1
    buffer_load_dwordx4 v[124:127], v17, s[12:15], s33 offen offset:32 sc1
    buffer_load_dwordx4 v[128:131], v17, s[12:15], s33 offen offset:64 sc1
    buffer_load_dwordx4 v[132:135], v17, s[12:15], s33 offen offset:96 sc1
    buffer_load_dwordx4 v[136:139], v17, s[12:15], s33 offen offset:128 sc1
    buffer_load_dwordx4 v[140:143], v17, s[12:15], s33 offen offset:160 sc1
    buffer_load_dwordx4 v[144:147], v17, s[12:15], s33 offen offset:192 sc1
    buffer_load_dwordx4 v[148:151], v17, s[12:15], s33 offen offset:224 sc1
    v_and_b32 v16, 31, v1
    v_lshlrev_b32 v16, 2, v16
    buffer_load_dword v56, v16, s[12:15], s33 offen offset:256 sc1
    s_lshl_b32 s32, s23, 7
    s_add_u32 s32, s32, 0x100e000
    v_mov_b32 v10, 0
    s_cmp_lg_u32 s22, 0
    s_cbranch_scc1 L_aww13
    s_mov_b64 exec, 0x1
    s_mov_b32 s45, 0x40000
L_awp13:
    buffer_load_dword v168, v10, s[12:15], s32 offen sc0 sc1
    s_waitcnt vmcnt(0)
    v_cmp_gt_u32 vcc, 16, v168
    s_cbranch_vccz L_awd13
    s_sub_u32 s45, s45, 1
    s_cmp_lg_u32 s45, 0
    s_cbranch_scc1 L_awp13
L_awd13:
    s_mov_b64 exec, -1
L_aww13:
    s_nop 0
    s_barrier
    v_and_b32 v16, 31, v1
    v_add_u32 v16, s49, v16
    v_lshrrev_b32 v17, 4, v16
    v_lshlrev_b32 v17, 7, v17
    v_and_b32 v16, 15, v16
    v_lshl_add_u32 v17, v16, 2, v17
    s_mov_b32 s32, 0x1004000
    buffer_load_dword v52, v17, s[12:15], s32 offen sc1
    buffer_load_dword v48, v17, s[12:15], s32 offen offset:64 sc1
    s_add_u32 m0, s28, 0
    s_lshl_b32 s30, s52, 3
    v_add_u32 v12, s30, v60
    v_mul_u32_u24 v13, 37, v12
    v_lshrrev_b32 v13, 8, v13
    v_mul_u32_u24 v14, 7, v13
    v_sub_u32 v12, v12, v14
    v_cmp_lt_u32 vcc, 3, v12
    v_lshlrev_b32 v12, 4, v12
    s_nop 0
    v_cndmask_b32 v14, v62, v63, vcc
    v_add_u32 v12, v12, v14
    v_mul_u32_u24 v13, 1792, v13
    v_add_u32 v2, v12, v13
    buffer_load_dwordx4 v2, s[4:7], s59 offen sc1 lds
    v_add_u32 v12, s30, v61
    v_mul_u32_u24 v13, 37, v12
    v_lshrrev_b32 v13, 8, v13
    v_mul_u32_u24 v14, 7, v13
    v_sub_u32 v12, v12, v14
    v_cmp_lt_u32 vcc, 3, v12
    v_lshlrev_b32 v12, 4, v12
    s_nop 0
    v_cndmask_b32 v14, v6, v7, vcc
    v_add_u32 v12, v12, v14
    v_mul_u32_u24 v13, 1792, v13
    v_add_u32 v3, v12, v13
    buffer_load_dwordx4 v3, s[4:7], s60 offen offset:1024 sc1 lds
    s_barrier
    s_add_u32 m0, s28, 28672
    s_lshl_b32 s30, s53, 3
    v_add_u32 v12, s30, v60
    v_mul_u32_u24 v13, 37, v12
    v_lshrrev_b32 v13, 8, v13
    v_mul_u32_u24 v14, 7, v13
    v_sub_u32 v12, v12, v14
    v_cmp_lt_u32 vcc, 3, v12
    v_lshlrev_b32 v12, 4, v12
    s_nop 0
    v_cndmask_b32 v14, v62, v63, vcc
    v_add_u32 v12, v12, v14
    v_mul_u32_u24 v13, 1792, v13
    v_add_u32 v2, v12, v13
    buffer_load_dwordx4 v2, s[4:7], s59 offen sc1 lds
    v_add_u32 v12, s30, v61
    v_mul_u32_u24 v13, 37, v12
    v_lshrrev_b32 v13, 8, v13
    v_mul_u32_u24 v14, 7, v13
    v_sub_u32 v12, v12, v14
    v_cmp_lt_u32 vcc, 3, v12
    v_lshlrev_b32 v12, 4, v12
    s_nop 0
    v_cndmask_b32 v14, v6, v7, vcc
    v_add_u32 v12, v12, v14
    v_mul_u32_u24 v13, 1792, v13
    v_add_u32 v3, v12, v13
    buffer_load_dwordx4 v3, s[4:7], s60 offen offset:1024 sc1 lds
    s_add_u32 m0, s28, 57344
    s_lshl_b32 s30, s54, 3
    v_add_u32 v12, s30, v60
    v_mul_u32_u24 v13, 37, v12
    v_lshrrev_b32 v13, 8, v13
    v_mul_u32_u24 v14, 7, v13
    v_sub_u32 v12, v12, v14
    v_cmp_lt_u32 vcc, 3, v12
    v_lshlrev_b32 v12, 4, v12
    s_nop 0
    v_cndmask_b32 v14, v62, v63, vcc
    v_add_u32 v12, v12, v14
    v_mul_u32_u24 v13, 1792, v13
    v_add_u32 v2, v12, v13
    buffer_load_dwordx4 v2, s[4:7], s59 offen sc1 lds
    v_add_u32 v12, s30, v61
    v_mul_u32_u24 v13, 37, v12
    v_lshrrev_b32 v13, 8, v13
    v_mul_u32_u24 v14, 7, v13
    v_sub_u32 v12, v12, v14
    v_cmp_lt_u32 vcc, 3, v12
    v_lshlrev_b32 v12, 4, v12
    s_nop 0
    v_cndmask_b32 v14, v6, v7, vcc
    v_add_u32 v12, v12, v14
    v_mul_u32_u24 v13, 1792, v13
    v_add_u32 v3, v12, v13
    buffer_load_dwordx4 v3, s[4:7], s60 offen offset:1024 sc1 lds
    s_add_u32 m0, s28, 86016
    s_lshl_b32 s30, s55, 3
    v_add_u32 v12, s30, v60
    v_mul_u32_u24 v13, 37, v12
    v_lshrrev_b32 v13, 8, v13
    v_mul_u32_u24 v14, 7, v13
    v_sub_u32 v12, v12, v14
    v_cmp_lt_u32 vcc, 3, v12
    v_lshlrev_b32 v12, 4, v12
    s_nop 0
    v_cndmask_b32 v14, v62, v63, vcc
    v_add_u32 v12, v12, v14
    v_mul_u32_u24 v13, 1792, v13
    v_add_u32 v2, v12, v13
    buffer_load_dwordx4 v2, s[4:7], s59 offen sc1 lds
    v_add_u32 v12, s30, v61
    v_mul_u32_u24 v13, 37, v12
    v_lshrrev_b32 v13, 8, v13
    v_mul_u32_u24 v14, 7, v13
    v_sub_u32 v12, v12, v14
    v_cmp_lt_u32 vcc, 3, v12
    v_lshlrev_b32 v12, 4, v12
    s_nop 0
    v_cndmask_b32 v14, v6, v7, vcc
    v_add_u32 v12, v12, v14
    v_mul_u32_u24 v13, 1792, v13
    v_add_u32 v3, v12, v13
    buffer_load_dwordx4 v3, s[4:7], s60 offen offset:1024 sc1 lds
    v_and_b32 v16, 31, v1
    v_lshrrev_b32 v17, 5, v1
    v_bfe_u32 v18, v1, 1, 3
    v_xor_b32 v18, v18, v17
    v_lshlrev_b32 v19, 7, v16
    s_lshl_b32 s32, s47, 12
    v_add_u32 v19, s32, v19
    v_xor_b32 v20, 0, v18
    v_lshl_add_u32 v100, v20, 4, v19
    v_xor_b32 v20, 2, v18
    v_lshl_add_u32 v101, v20, 4, v19
    v_xor_b32 v20, 4, v18
    v_lshl_add_u32 v102, v20, 4, v19
    v_xor_b32 v20, 6, v18
    v_lshl_add_u32 v103, v20, 4, v19
    v_bfe_u32 v18, v1, 2, 2
    v_bfe_u32 v19, v1, 4, 1
    v_and_b32 v20, 3, v1
    v_lshlrev_b32 v22, 5, v19
    v_lshl_add_u32 v22, v20, 3, v22
    v_lshl_add_u32 v21, v17, 3, v18
    v_mul_u32_u24 v21, 192, v21
    v_add_u32 v21, v21, v22
    s_lshl_b32 s34, s48, 7
    s_add_u32 s34, s34, 16384
    v_add_u32 v21, s34, v21
    s_cmp_eq_u32 s48, 0
    s_cbranch_scc0 L_pk1b_t1
    s_waitcnt vmcnt(9)
    v_mul_f32 v52, 0x3b124925, v52
    s_waitcnt vmcnt(8)
    v_mul_f32 v48, 0x3b124925, v48
    v_fma_f32 v48, -v52, v52, v48
    v_max_f32 v48, 0, v48
    v_add_f32 v48, 0x3727c5ac, v48
    v_rsq_f32 v48, v48
    s_nop 0
    v_mul_f32 v52, -v52, v48
    v_mul_f32 v50, 0x3e8b97f6, v48
    v_mul_f32 v51, 0x3e8b97f6, v52
    v_mul_f32 v120, v120, v51
    v_mul_f32 v136, v136, v52
    v_mul_f32 v121, v121, v51
    v_mul_f32 v137, v137, v52
    v_mul_f32 v122, v122, v51
    v_mul_f32 v138, v138, v52
    v_mul_f32 v123, v123, v51
    v_mul_f32 v139, v139, v52
    v_mul_f32 v124, v124, v51
    v_mul_f32 v140, v140, v52
    v_mul_f32 v125, v125, v51
    v_mul_f32 v141, v141, v52
    v_mul_f32 v126, v126, v51
    v_mul_f32 v142, v142, v52
    v_mul_f32 v127, v127, v51
    v_mul_f32 v143, v143, v52
    v_mul_f32 v128, v128, v51
    v_mul_f32 v144, v144, v52
    v_mul_f32 v129, v129, v51
    v_mul_f32 v145, v145, v52
    v_mul_f32 v130, v130, v51
    v_mul_f32 v146, v146, v52
    v_mul_f32 v131, v131, v51
    v_mul_f32 v147, v147, v52
    v_mul_f32 v132, v132, v51
    v_mul_f32 v148, v148, v52
    v_mul_f32 v133, v133, v51
    v_mul_f32 v149, v149, v52
    v_mul_f32 v134, v134, v51
    v_mul_f32 v150, v150, v52
    v_mul_f32 v135, v135, v51
    v_mul_f32 v151, v151, v52
    v_add_u32 v104, 0, v100
    v_add_u32 v105, 0, v101
    v_add_u32 v106, 0, v102
    v_add_u32 v107, 0, v103
    v_add_u32 v108, 0, v21
    s_waitcnt vmcnt(6)
    s_barrier
    ds_read_b128 v[64:67], v104
    ds_read_b64_tr_b16 v[76:77], v108 offset:0
    ds_read_b64_tr_b16 v[78:79], v108 offset:768
    ds_read_b64_tr_b16 v[80:81], v108 offset:64
    ds_read_b64_tr_b16 v[82:83], v108 offset:832
    ds_read_b128 v[68:71], v105
    ds_read_b64_tr_b16 v[84:85], v108 offset:3072
    ds_read_b64_tr_b16 v[86:87], v108 offset:3840
    ds_read_b64_tr_b16 v[88:89], v108 offset:3136
    ds_read_b64_tr_b16 v[90:91], v108 offset:3904
    s_waitcnt lgkmcnt(7)
    v_mfma_f32_32x32x16_bf16 a[0:15], v[76:79], v[64:67], 0
    ds_read_b128 v[72:75], v106
    ds_read_b64_tr_b16 v[92:93], v108 offset:6144
    s_waitcnt lgkmcnt(7)
    v_mfma_f32_32x32x16_bf16 a[16:31], v[80:83], v[64:67], 0
    ds_read_b64_tr_b16 v[94:95], v108 offset:6912
    ds_read_b64_tr_b16 v[96:97], v108 offset:6208
    ds_read_b64_tr_b16 v[98:99], v108 offset:6976
    s_waitcnt lgkmcnt(7)
    v_mfma_f32_32x32x16_bf16 a[0:15], v[84:87], v[68:71], a[0:15]
    ds_read_b128 v[64:67], v107
    ds_read_b64_tr_b16 v[76:77], v108 offset:9216
    s_waitcnt lgkmcnt(7)
    v_mfma_f32_32x32x16_bf16 a[16:31], v[88:91], v[68:71], a[16:31]
    ds_read_b64_tr_b16 v[78:79], v108 offset:9984
    ds_read_b64_tr_b16 v[80:81], v108 offset:9280
    ds_read_b64_tr_b16 v[82:83], v108 offset:10048
    s_waitcnt lgkmcnt(7)
    v_mfma_f32_32x32x16_bf16 a[0:15], v[92:95], v[72:75], a[0:15]
    v_add_u32 v110, 28672, v100
    v_add_u32 v111, 28672, v101
    v_add_u32 v112, 28672, v102
    v_add_u32 v113, 28672, v103
    v_add_u32 v114, 28672, v21
    s_waitcnt vmcnt(4)
    s_barrier
    ds_read_b128 v[68:71], v110
    ds_read_b64_tr_b16 v[84:85], v114 offset:0
    s_waitcnt lgkmcnt(7)
    v_mfma_f32_32x32x16_bf16 a[16:31], v[96:99], v[72:75], a[16:31]
    ds_read_b64_tr_b16 v[86:87], v114 offset:768
    ds_read_b64_tr_b16 v[88:89], v114 offset:64
    ds_read_b64_tr_b16 v[90:91], v114 offset:832
    s_waitcnt lgkmcnt(7)
    v_mfma_f32_32x32x16_bf16 a[0:15], v[76:79], v[64:67], a[0:15]
    ds_read_b128 v[72:75], v111
    ds_read_b64_tr_b16 v[92:93], v114 offset:3072
    ds_read_b64_tr_b16 v[94:95], v114 offset:3840
    s_waitcnt lgkmcnt(8)
    v_mfma_f32_32x32x16_bf16 a[16:31], v[80:83], v[64:67], a[16:31]
    ds_read_b64_tr_b16 v[96:97], v114 offset:3136
    ds_read_b64_tr_b16 v[98:99], v114 offset:3904
    s_add_u32 m0, s28, 114688
    s_lshl_b32 s30, s56, 3
    v_add_u32 v12, s30, v60
    v_mul_u32_u24 v13, 37, v12
    v_lshrrev_b32 v13, 8, v13
    v_mul_u32_u24 v14, 7, v13
    v_sub_u32 v12, v12, v14
    v_cmp_lt_u32 vcc, 3, v12
    v_lshlrev_b32 v12, 4, v12
    s_nop 0
    v_cndmask_b32 v14, v62, v63, vcc
    v_add_u32 v12, v12, v14
    v_mul_u32_u24 v13, 1792, v13
    v_add_u32 v2, v12, v13
    buffer_load_dwordx4 v2, s[4:7], s59 offen sc1 lds
    v_add_u32 v12, s30, v61
    v_mul_u32_u24 v13, 37, v12
    v_lshrrev_b32 v13, 8, v13
    v_mul_u32_u24 v14, 7, v13
    v_sub_u32 v12, v12, v14
    v_cmp_lt_u32 vcc, 3, v12
    v_lshlrev_b32 v12, 4, v12
    s_nop 0
    v_cndmask_b32 v14, v6, v7, vcc
    v_add_u32 v12, v12, v14
    v_mul_u32_u24 v13, 1792, v13
    v_add_u32 v3, v12, v13
    buffer_load_dwordx4 v3, s[4:7], s60 offen offset:1024 sc1 lds
    s_waitcnt lgkmcnt(7)
    v_mfma_f32_32x32x16_bf16 a[0:15], v[84:87], v[68:71], a[0:15]
    ds_read_b128 v[64:67], v112
    ds_read_b64_tr_b16 v[76:77], v114 offset:6144
    s_waitcnt lgkmcnt(7)
    v_mfma_f32_32x32x16_bf16 a[16:31], v[88:91], v[68:71], a[16:31]
    ds_read_b64_tr_b16 v[78:79], v114 offset:6912
    ds_read_b64_tr_b16 v[80:81], v114 offset:6208
    ds_read_b64_tr_b16 v[82:83], v114 offset:6976
    s_waitcnt lgkmcnt(7)
    v_mfma_f32_32x32x16_bf16 a[0:15], v[92:95], v[72:75], a[0:15]
    ds_read_b128 v[68:71], v113
    ds_read_b64_tr_b16 v[84:85], v114 offset:9216
    s_waitcnt lgkmcnt(7)
    v_mfma_f32_32x32x16_bf16 a[16:31], v[96:99], v[72:75], a[16:31]
    ds_read_b64_tr_b16 v[86:87], v114 offset:9984
    ds_read_b64_tr_b16 v[88:89], v114 offset:9280
    ds_read_b64_tr_b16 v[90:91], v114 offset:10048
    s_waitcnt lgkmcnt(7)
    v_mfma_f32_32x32x16_bf16 a[0:15], v[76:79], v[64:67], a[0:15]
    v_add_u32 v104, 57344, v100
    v_add_u32 v105, 57344, v101
    v_add_u32 v106, 57344, v102
    v_add_u32 v107, 57344, v103
    v_add_u32 v108, 57344, v21
    s_waitcnt vmcnt(4)
    s_barrier
    ds_read_b128 v[72:75], v104
    ds_read_b64_tr_b16 v[92:93], v108 offset:0
    s_waitcnt lgkmcnt(7)
    v_mfma_f32_32x32x16_bf16 a[16:31], v[80:83], v[64:67], a[16:31]
    ds_read_b64_tr_b16 v[94:95], v108 offset:768
    ds_read_b64_tr_b16 v[96:97], v108 offset:64
    ds_read_b64_tr_b16 v[98:99], v108 offset:832
    s_waitcnt lgkmcnt(7)
    v_mfma_f32_32x32x16_bf16 a[0:15], v[84:87], v[68:71], a[0:15]
    ds_read_b128 v[64:67], v105
    ds_read_b64_tr_b16 v[76:77], v108 offset:3072
    ds_read_b64_tr_b16 v[78:79], v108 offset:3840
    s_waitcnt lgkmcnt(8)
    v_mfma_f32_32x32x16_bf16 a[16:31], v[88:91], v[68:71], a[16:31]
    ds_read_b64_tr_b16 v[80:81], v108 offset:3136
    ds_read_b64_tr_b16 v[82:83], v108 offset:3904
    s_add_u32 m0, s29, 0
    s_mul_i32 s31, s57, 12288
    buffer_load_dwordx4 v4, s[8:11], s31 offen sc1 lds
    s_mov_b64 exec, 0xffffffff
    buffer_load_dwordx4 v5, s[8:11], s31 offen offset:1024 sc1 lds
    s_mov_b64 exec, -1
    s_add_u32 m0, s28, 0
    s_lshl_b32 s30, s57, 3
    v_add_u32 v12, s30, v60
    v_mul_u32_u24 v13, 37, v12
    v_lshrrev_b32 v13, 8, v13
    v_mul_u32_u24 v14, 7, v13
    v_sub_u32 v12, v12, v14
    v_cmp_lt_u32 vcc, 3, v12
    v_lshlrev_b32 v12, 4, v12
    s_nop 0
    v_cndmask_b32 v14, v62, v63, vcc
    v_add_u32 v12, v12, v14
    v_mul_u32_u24 v13, 1792, v13
    v_add_u32 v2, v12, v13
    buffer_load_dwordx4 v2, s[4:7], s59 offen sc1 lds
    v_add_u32 v12, s30, v61
    v_mul_u32_u24 v13, 37, v12
    v_lshrrev_b32 v13, 8, v13
    v_mul_u32_u24 v14, 7, v13
    v_sub_u32 v12, v12, v14
    v_cmp_lt_u32 vcc, 3, v12
    v_lshlrev_b32 v12, 4, v12
    s_nop 0
    v_cndmask_b32 v14, v6, v7, vcc
    v_add_u32 v12, v12, v14
    v_mul_u32_u24 v13, 1792, v13
    v_add_u32 v3, v12, v13
    buffer_load_dwordx4 v3, s[4:7], s60 offen offset:1024 sc1 lds
    s_waitcnt lgkmcnt(7)
    v_mfma_f32_32x32x16_bf16 a[0:15], v[92:95], v[72:75], a[0:15]
    ds_read_b128 v[68:71], v106
    ds_read_b64_tr_b16 v[84:85], v108 offset:6144
    s_waitcnt lgkmcnt(7)
    v_mfma_f32_32x32x16_bf16 a[16:31], v[96:99], v[72:75], a[16:31]
    ds_read_b64_tr_b16 v[86:87], v108 offset:6912
    ds_read_b64_tr_b16 v[88:89], v108 offset:6208
    ds_read_b64_tr_b16 v[90:91], v108 offset:6976
    s_waitcnt lgkmcnt(7)
    v_mfma_f32_32x32x16_bf16 a[0:15], v[76:79], v[64:67], a[0:15]
    ds_read_b128 v[72:75], v107
    ds_read_b64_tr_b16 v[92:93], v108 offset:9216
    s_waitcnt lgkmcnt(7)
    v_mfma_f32_32x32x16_bf16 a[16:31], v[80:83], v[64:67], a[16:31]
    ds_read_b64_tr_b16 v[94:95], v108 offset:9984
    ds_read_b64_tr_b16 v[96:97], v108 offset:9280
    ds_read_b64_tr_b16 v[98:99], v108 offset:10048
    s_waitcnt lgkmcnt(7)
    v_mfma_f32_32x32x16_bf16 a[0:15], v[84:87], v[68:71], a[0:15]
    v_add_u32 v110, 86016, v100
    v_add_u32 v111, 86016, v101
    v_add_u32 v112, 86016, v102
    v_add_u32 v113, 86016, v103
    v_add_u32 v114, 86016, v21
    s_waitcnt vmcnt(6)
    s_barrier
    ds_read_b128 v[64:67], v110
    ds_read_b64_tr_b16 v[76:77], v114 offset:0
    s_waitcnt lgkmcnt(7)
    v_mfma_f32_32x32x16_bf16 a[16:31], v[88:91], v[68:71], a[16:31]
    ds_read_b64_tr_b16 v[78:79], v114 offset:768
    ds_read_b64_tr_b16 v[80:81], v114 offset:64
    ds_read_b64_tr_b16 v[82:83], v114 offset:832
    s_waitcnt lgkmcnt(7)
    v_mfma_f32_32x32x16_bf16 a[0:15], v[92:95], v[72:75], a[0:15]
    ds_read_b128 v[68:71], v111
    ds_read_b64_tr_b16 v[84:85], v114 offset:3072
    ds_read_b64_tr_b16 v[86:87], v114 offset:3840
    s_waitcnt lgkmcnt(8)
    v_mfma_f32_32x32x16_bf16 a[16:31], v[96:99], v[72:75], a[16:31]
    ds_read_b64_tr_b16 v[88:89], v114 offset:3136
    ds_read_b64_tr_b16 v[90:91], v114 offset:3904
    s_add_u32 m0, s29, 28672
    s_mul_i32 s31, s58, 12288
    buffer_load_dwordx4 v4, s[8:11], s31 offen sc1 lds
    s_mov_b64 exec, 0xffffffff
    buffer_load_dwordx4 v5, s[8:11], s31 offen offset:1024 sc1 lds
    s_mov_b64 exec, -1
    s_add_u32 m0, s28, 28672
    s_lshl_b32 s30, s58, 3
    v_add_u32 v12, s30, v60
    v_mul_u32_u24 v13, 37, v12
    v_lshrrev_b32 v13, 8, v13
    v_mul_u32_u24 v14, 7, v13
    v_sub_u32 v12, v12, v14
    v_cmp_lt_u32 vcc, 3, v12
    v_lshlrev_b32 v12, 4, v12
    s_nop 0
    v_cndmask_b32 v14, v62, v63, vcc
    v_add_u32 v12, v12, v14
    v_mul_u32_u24 v13, 1792, v13
    v_add_u32 v2, v12, v13
    buffer_load_dwordx4 v2, s[4:7], s59 offen sc1 lds
    v_add_u32 v12, s30, v61
    v_mul_u32_u24 v13, 37, v12
    v_lshrrev_b32 v13, 8, v13
    v_mul_u32_u24 v14, 7, v13
    v_sub_u32 v12, v12, v14
    v_cmp_lt_u32 vcc, 3, v12
    v_lshlrev_b32 v12, 4, v12
    s_nop 0
    v_cndmask_b32 v14, v6, v7, vcc
    v_add_u32 v12, v12, v14
    v_mul_u32_u24 v13, 1792, v13
    v_add_u32 v3, v12, v13
    buffer_load_dwordx4 v3, s[4:7], s60 offen offset:1024 sc1 lds
    s_waitcnt lgkmcnt(7)
    v_mfma_f32_32x32x16_bf16 a[0:15], v[76:79], v[64:67], a[0:15]
    ds_read_b128 v[72:75], v112
    ds_read_b64_tr_b16 v[92:93], v114 offset:6144
    s_waitcnt lgkmcnt(7)
    v_mfma_f32_32x32x16_bf16 a[16:31], v[80:83], v[64:67], a[16:31]
    ds_read_b64_tr_b16 v[94:95], v114 offset:6912
    ds_read_b64_tr_b16 v[96:97], v114 offset:6208
    ds_read_b64_tr_b16 v[98:99], v114 offset:6976
    s_waitcnt lgkmcnt(7)
    v_mfma_f32_32x32x16_bf16 a[0:15], v[84:87], v[68:71], a[0:15]
    ds_read_b128 v[64:67], v113
    ds_read_b64_tr_b16 v[76:77], v114 offset:9216
    s_waitcnt lgkmcnt(7)
    v_mfma_f32_32x32x16_bf16 a[16:31], v[88:91], v[68:71], a[16:31]
    ds_read_b64_tr_b16 v[78:79], v114 offset:9984
    ds_read_b64_tr_b16 v[80:81], v114 offset:9280
    ds_read_b64_tr_b16 v[82:83], v114 offset:10048
    s_waitcnt lgkmcnt(7)
    v_mfma_f32_32x32x16_bf16 a[0:15], v[92:95], v[72:75], a[0:15]
    v_add_u32 v104, 114688, v100
    v_add_u32 v105, 114688, v101
    v_add_u32 v106, 114688, v102
    v_add_u32 v107, 114688, v103
    v_add_u32 v108, 114688, v21
    s_waitcnt vmcnt(8)
    s_barrier
    ds_read_b128 v[68:71], v104
    ds_read_b64_tr_b16 v[84:85], v108 offset:0
    s_waitcnt lgkmcnt(7)
    v_mfma_f32_32x32x16_bf16 a[16:31], v[96:99], v[72:75], a[16:31]
    ds_read_b64_tr_b16 v[86:87], v108 offset:768
    ds_read_b64_tr_b16 v[88:89], v108 offset:64
    ds_read_b64_tr_b16 v[90:91], v108 offset:832
    s_waitcnt lgkmcnt(7)
    v_mfma_f32_32x32x16_bf16 a[0:15], v[76:79], v[64:67], a[0:15]
    ds_read_b128 v[72:75], v105
    ds_read_b64_tr_b16 v[92:93], v108 offset:3072
    s_waitcnt lgkmcnt(7)
    v_mfma_f32_32x32x16_bf16 a[16:31], v[80:83], v[64:67], a[16:31]
    ds_read_b64_tr_b16 v[94:95], v108 offset:3840
    ds_read_b64_tr_b16 v[96:97], v108 offset:3136
    ds_read_b64_tr_b16 v[98:99], v108 offset:3904
    s_waitcnt lgkmcnt(7)
    v_mfma_f32_32x32x16_bf16 a[0:15], v[84:87], v[68:71], a[0:15]
    ds_read_b128 v[64:67], v106
    ds_read_b64_tr_b16 v[76:77], v108 offset:6144
    s_waitcnt lgkmcnt(7)
    v_mfma_f32_32x32x16_bf16 a[16:31], v[88:91], v[68:71], a[16:31]
    ds_read_b64_tr_b16 v[78:79], v108 offset:6912
    ds_read_b64_tr_b16 v[80:81], v108 offset:6208
    ds_read_b64_tr_b16 v[82:83], v108 offset:6976
    s_waitcnt lgkmcnt(7)
    v_mfma_f32_32x32x16_bf16 a[0:15], v[92:95], v[72:75], a[0:15]
    ds_read_b128 v[68:71], v107
    ds_read_b64_tr_b16 v[84:85], v108 offset:9216
    s_waitcnt lgkmcnt(7)
    v_mfma_f32_32x32x16_bf16 a[16:31], v[96:99], v[72:75], a[16:31]
    ds_read_b64_tr_b16 v[86:87], v108 offset:9984
    ds_read_b64_tr_b16 v[88:89], v108 offset:9280
    ds_read_b64_tr_b16 v[90:91], v108 offset:10048
    s_waitcnt lgkmcnt(7)
    v_mfma_f32_32x32x16_bf16 a[0:15], v[76:79], v[64:67], a[0:15]
    v_add_u32 v110, 0, v100
    v_add_u32 v111, 0, v101
    v_add_u32 v112, 0, v102
    v_add_u32 v113, 0, v103
    v_add_u32 v114, 0, v21
    s_waitcnt vmcnt(4)
    s_barrier
    ds_read_b128 v[72:75], v110
    ds_read_b64_tr_b16 v[92:93], v114 offset:0
    s_waitcnt lgkmcnt(7)
    v_mfma_f32_32x32x16_bf16 a[16:31], v[80:83], v[64:67], a[16:31]
    ds_read_b64_tr_b16 v[94:95], v114 offset:768
    ds_read_b64_tr_b16 v[96:97], v114 offset:64
    ds_read_b64_tr_b16 v[98:99], v114 offset:832
    s_waitcnt lgkmcnt(7)
    v_mfma_f32_32x32x16_bf16 a[0:15], v[84:87], v[68:71], a[0:15]
    ds_read_b128 v[64:67], v111
    ds_read_b64_tr_b16 v[76:77], v114 offset:3072
    s_waitcnt lgkmcnt(7)
    v_mfma_f32_32x32x16_bf16 a[16:31], v[88:91], v[68:71], a[16:31]
    ds_read_b64_tr_b16 v[78:79], v114 offset:3840
    ds_read_b64_tr_b16 v[80:81], v114 offset:3136
    ds_read_b64_tr_b16 v[82:83], v114 offset:3904
    s_waitcnt lgkmcnt(7)
    v_mfma_f32_32x32x16_bf16 a[0:15], v[92:95], v[72:75], a[0:15]
    ds_read_b128 v[68:71], v112
    ds_read_b64_tr_b16 v[84:85], v114 offset:6144
    s_waitcnt lgkmcnt(7)
    v_mfma_f32_32x32x16_bf16 a[16:31], v[96:99], v[72:75], a[16:31]
    ds_read_b64_tr_b16 v[86:87], v114 offset:6912
    ds_read_b64_tr_b16 v[88:89], v114 offset:6208
    ds_read_b64_tr_b16 v[90:91], v114 offset:6976
    s_waitcnt lgkmcnt(7)
    v_mfma_f32_32x32x16_bf16 a[0:15], v[76:79], v[64:67], a[0:15]
    ds_read_b128 v[72:75], v113
    ds_read_b64_tr_b16 v[92:93], v114 offset:9216
    s_waitcnt lgkmcnt(7)
    v_mfma_f32_32x32x16_bf16 a[16:31], v[80:83], v[64:67], a[16:31]
    ds_read_b64_tr_b16 v[94:95], v114 offset:9984
    ds_read_b64_tr_b16 v[96:97], v114 offset:9280
    ds_read_b64_tr_b16 v[98:99], v114 offset:10048
    s_waitcnt lgkmcnt(7)
    v_mfma_f32_32x32x16_bf16 a[0:15], v[84:87], v[68:71], a[0:15]
    v_add_u32 v104, 28672, v100
    v_add_u32 v105, 28672, v101
    v_add_u32 v106, 28672, v102
    v_add_u32 v107, 28672, v103
    v_add_u32 v108, 28672, v21
    s_waitcnt vmcnt(0)
    s_barrier
    ds_read_b128 v[64:67], v104
    ds_read_b64_tr_b16 v[76:77], v108 offset:0
    s_waitcnt lgkmcnt(7)
    v_mfma_f32_32x32x16_bf16 a[16:31], v[88:91], v[68:71], a[16:31]
    ds_read_b64_tr_b16 v[78:79], v108 offset:768
    ds_read_b64_tr_b16 v[80:81], v108 offset:64
    ds_read_b64_tr_b16 v[82:83], v108 offset:832
    s_waitcnt lgkmcnt(7)
    v_mfma_f32_32x32x16_bf16 a[0:15], v[92:95], v[72:75], a[0:15]
    ds_read_b128 v[68:71], v105
    ds_read_b64_tr_b16 v[84:85], v108 offset:3072
    s_waitcnt lgkmcnt(7)
    v_mfma_f32_32x32x16_bf16 a[16:31], v[96:99], v[72:75], a[16:31]
    ds_read_b64_tr_b16 v[86:87], v108 offset:3840
    ds_read_b64_tr_b16 v[88:89], v108 offset:3136
    ds_read_b64_tr_b16 v[90:91], v108 offset:3904
    s_waitcnt lgkmcnt(7)
    v_mfma_f32_32x32x16_bf16 a[0:15], v[76:79], v[64:67], a[0:15]
    ds_read_b128 v[72:75], v106
    ds_read_b64_tr_b16 v[92:93], v108 offset:6144
    s_waitcnt lgkmcnt(7)
    v_mfma_f32_32x32x16_bf16 a[16:31], v[80:83], v[64:67], a[16:31]
    ds_read_b64_tr_b16 v[94:95], v108 offset:6912
    ds_read_b64_tr_b16 v[96:97], v108 offset:6208
    ds_read_b64_tr_b16 v[98:99], v108 offset:6976
    s_waitcnt lgkmcnt(7)
    v_mfma_f32_32x32x16_bf16 a[0:15], v[84:87], v[68:71], a[0:15]
    ds_read_b128 v[64:67], v107
    ds_read_b64_tr_b16 v[76:77], v108 offset:9216
    s_waitcnt lgkmcnt(7)
    v_mfma_f32_32x32x16_bf16 a[16:31], v[88:91], v[68:71], a[16:31]
    ds_read_b64_tr_b16 v[78:79], v108 offset:9984
    ds_read_b64_tr_b16 v[80:81], v108 offset:9280
    ds_read_b64_tr_b16 v[82:83], v108 offset:10048
    s_waitcnt lgkmcnt(7)
    v_mfma_f32_32x32x16_bf16 a[0:15], v[92:95], v[72:75], a[0:15]
    s_waitcnt lgkmcnt(5)
    v_mfma_f32_32x32x16_bf16 a[16:31], v[96:99], v[72:75], a[16:31]
    s_waitcnt lgkmcnt(2)
    v_mfma_f32_32x32x16_bf16 a[0:15], v[76:79], v[64:67], a[0:15]
    s_waitcnt lgkmcnt(0)
    v_mfma_f32_32x32x16_bf16 a[16:31], v[80:83], v[64:67], a[16:31]
    s_lshl_b32 s36, s24, 6
    s_lshl_b32 s37, s23, 2
    s_add_u32 s36, s36, s37
    s_add_u32 s36, s36, s47
    s_lshl_b32 s36, s36, 11
    v_lshlrev_b32 v59, 4, v1
    v_add_u32 v59, s36, v59
    v_cmp_eq_u32 s[38:39], 0, v17
    s_nop 1
    v_accvgpr_read_b32 v64, a0
    v_accvgpr_read_b32 v65, a1
    v_accvgpr_read_b32 v66, a2
    v_accvgpr_read_b32 v67, a3
    v_accvgpr_read_b32 v68, a4
    v_accvgpr_read_b32 v69, a5
    v_accvgpr_read_b32 v70, a6
    v_accvgpr_read_b32 v71, a7
    v_accvgpr_read_b32 v72, a8
    v_accvgpr_read_b32 v73, a9
    v_accvgpr_read_b32 v74, a10
    v_accvgpr_read_b32 v75, a11
    v_accvgpr_read_b32 v76, a12
    v_accvgpr_read_b32 v77, a13
    v_accvgpr_read_b32 v78, a14
    v_accvgpr_read_b32 v79, a15
    v_fma_f32 v64, v64, v50, v120
    v_fma_f32 v65, v65, v50, v121
    v_fma_f32 v66, v66, v50, v122
    v_fma_f32 v67, v67, v50, v123
    v_fma_f32 v68, v68, v50, v124
    v_fma_f32 v69, v69, v50, v125
    v_fma_f32 v70, v70, v50, v126
    v_fma_f32 v71, v71, v50, v127
    v_fma_f32 v72, v72, v50, v128
    v_fma_f32 v73, v73, v50, v129
    v_fma_f32 v74, v74, v50, v130
    v_fma_f32 v75, v75, v50, v131
    v_fma_f32 v76, v76, v50, v132
    v_fma_f32 v77, v77, v50, v133
    v_fma_f32 v78, v78, v50, v134
    v_fma_f32 v79, v79, v50, v135
    v_cvt_pk_bf16_f32 v96, v64, v65
    v_cvt_pk_bf16_f32 v97, v66, v67
    v_cvt_pk_bf16_f32 v98, v68, v69
    v_cvt_pk_bf16_f32 v99, v70, v71
    v_cvt_pk_bf16_f32 v100, v72, v73
    v_cvt_pk_bf16_f32 v101, v74, v75
    v_cvt_pk_bf16_f32 v102, v76, v77
    v_cvt_pk_bf16_f32 v103, v78, v79
    v_mov_b32 v62, 0x3f80
    v_cndmask_b32 v102, v62, v102, s[38:39]
    v_cndmask_b32 v103, 0, v103, s[38:39]
    s_mov_b32 s40, 0x2000000
    buffer_store_dwordx4 v[96:99], v59, s[12:15], s40 offen sc0 sc1
    buffer_store_dwordx4 v[100:103], v59, s[12:15], s40 offen offset:1024 sc0 sc1
    v_accvgpr_read_b32 v64, a16
    v_accvgpr_read_b32 v65, a17
    v_accvgpr_read_b32 v66, a18
    v_accvgpr_read_b32 v67, a19
    v_accvgpr_read_b32 v68, a20
    v_accvgpr_read_b32 v69, a21
    v_accvgpr_read_b32 v70, a22
    v_accvgpr_read_b32 v71, a23
    v_accvgpr_read_b32 v72, a24
    v_accvgpr_read_b32 v73, a25
    v_accvgpr_read_b32 v74, a26
    v_accvgpr_read_b32 v75, a27
    v_accvgpr_read_b32 v76, a28
    v_accvgpr_read_b32 v77, a29
    v_accvgpr_read_b32 v78, a30
    v_accvgpr_read_b32 v79, a31
    v_fma_f32 v64, v64, v48, v136
    v_fma_f32 v65, v65, v48, v137
    v_fma_f32 v66, v66, v48, v138
    v_fma_f32 v67, v67, v48, v139
    v_fma_f32 v68, v68, v48, v140
    v_fma_f32 v69, v69, v48, v141
    v_fma_f32 v70, v70, v48, v142
    v_fma_f32 v71, v71, v48, v143
    v_fma_f32 v72, v72, v48, v144
    v_fma_f32 v73, v73, v48, v145
    v_fma_f32 v74, v74, v48, v146
    v_fma_f32 v75, v75, v48, v147
    v_fma_f32 v76, v76, v48, v148
    v_fma_f32 v77, v77, v48, v149
    v_fma_f32 v78, v78, v48, v150
    v_fma_f32 v79, v79, v48, v151
    v_cvt_pk_bf16_f32 v104, v64, v65
    v_cvt_pk_bf16_f32 v105, v66, v67
    v_cvt_pk_bf16_f32 v106, v68, v69
    v_cvt_pk_bf16_f32 v107, v70, v71
    v_cvt_pk_bf16_f32 v108, v72, v73
    v_cvt_pk_bf16_f32 v109, v74, v75
    v_cvt_pk_bf16_f32 v110, v76, v77
    v_cvt_pk_bf16_f32 v111, v78, v79
    v_cndmask_b32 v110, 0, v110, s[38:39]
    v_cndmask_b32 v111, 0, v111, s[38:39]
    s_mov_b32 s40, 0x2200000
    buffer_store_dwordx4 v[104:107], v59, s[12:15], s40 offen sc0 sc1
    buffer_store_dwordx4 v[108:111], v59, s[12:15], s40 offen offset:1024 sc0 sc1
    s_branch L_pk1b_e2
L_pk1b_t1:
    s_nop 1
    s_waitcnt vmcnt(9)
    v_mul_f32 v52, 0x3b124925, v52
    s_waitcnt vmcnt(8)
    v_mul_f32 v48, 0x3b124925, v48
    v_fma_f32 v48, -v52, v52, v48
    v_max_f32 v48, 0, v48
    v_add_f32 v48, 0x3727c5ac, v48
    v_rsq_f32 v48, v48
    s_nop 0
    v_mul_f32 v52, -v52, v48
    v_and_b32 v57, 31, v1
    v_lshlrev_b32 v57, 2, v57
    s_lshl_b32 s35, s22, 8
    s_add_u32 s35, s35, 144384
    v_add_u32 v57, s35, v57
    s_mov_b64 exec, 0xffffffff
    ds_write_b32 v57, v48
    ds_write_b32 v57, v52 offset:128
    s_mov_b64 exec, -1
    v_lshlrev_b32 v58, 4, v17
    v_add_u32 v58, s35, v58
    ds_read_b128 v[120:123], v58 offset:0
    ds_read_b128 v[136:139], v58 offset:128
    ds_read_b128 v[124:127], v58 offset:32
    ds_read_b128 v[140:143], v58 offset:160
    ds_read_b128 v[128:131], v58 offset:64
    ds_read_b128 v[144:147], v58 offset:192
    ds_read_b128 v[132:135], v58 offset:96
    ds_read_b128 v[148:151], v58 offset:224
    s_waitcnt lgkmcnt(6)
    v_mul_f32 v136, v136, v56
    v_mul_f32 v137, v137, v56
    v_mul_f32 v138, v138, v56
    v_mul_f32 v139, v139, v56
    s_waitcnt lgkmcnt(4)
    v_mul_f32 v140, v140, v56
    v_mul_f32 v141, v141, v56
    v_mul_f32 v142, v142, v56
    v_mul_f32 v143, v143, v56
    s_waitcnt lgkmcnt(2)
    v_mul_f32 v144, v144, v56
    v_mul_f32 v145, v145, v56
    v_mul_f32 v146, v146, v56
    v_mul_f32 v147, v147, v56
    s_waitcnt lgkmcnt(0)
    v_mul_f32 v148, v148, v56
    v_mul_f32 v149, v149, v56
    v_mul_f32 v150, v150, v56
    v_mul_f32 v151, v151, v56
    v_add_u32 v104, 0, v100
    v_add_u32 v105, 0, v101
    v_add_u32 v106, 0, v102
    v_add_u32 v107, 0, v103
    v_add_u32 v108, 0, v21
    s_waitcnt vmcnt(6)
    s_barrier
    ds_read_b128 v[64:67], v104
    ds_read_b64_tr_b16 v[76:77], v108 offset:0
    ds_read_b64_tr_b16 v[78:79], v108 offset:768
    ds_read_b128 v[68:71], v105
    ds_read_b64_tr_b16 v[84:85], v108 offset:3072
    ds_read_b64_tr_b16 v[86:87], v108 offset:3840
    s_waitcnt lgkmcnt(3)
    v_mfma_f32_32x32x16_bf16 a[0:15], v[64:67], v[76:79], 0
    ds_read_b128 v[72:75], v106
    ds_read_b64_tr_b16 v[92:93], v108 offset:6144
    ds_read_b64_tr_b16 v[94:95], v108 offset:6912
    s_waitcnt lgkmcnt(3)
    v_mfma_f32_32x32x16_bf16 a[0:15], v[68:71], v[84:87], a[0:15]
    ds_read_b128 v[64:67], v107
    ds_read_b64_tr_b16 v[76:77], v108 offset:9216
    ds_read_b64_tr_b16 v[78:79], v108 offset:9984
    s_waitcnt lgkmcnt(3)
    v_mfma_f32_32x32x16_bf16 a[0:15], v[72:75], v[92:95], a[0:15]
    v_add_u32 v110, 28672, v100
    v_add_u32 v111, 28672, v101
    v_add_u32 v112, 28672, v102
    v_add_u32 v113, 28672, v103
    v_add_u32 v114, 28672, v21
    s_waitcnt vmcnt(4)
    s_barrier
    ds_read_b128 v[68:71], v110
    ds_read_b64_tr_b16 v[84:85], v114 offset:0
    ds_read_b64_tr_b16 v[86:87], v114 offset:768
    s_waitcnt lgkmcnt(3)
    v_mfma_f32_32x32x16_bf16 a[0:15], v[64:67], v[76:79], a[0:15]
    ds_read_b128 v[72:75], v111
    ds_read_b64_tr_b16 v[92:93], v114 offset:3072
    ds_read_b64_tr_b16 v[94:95], v114 offset:3840
    s_add_u32 m0, s28, 114688
    s_lshl_b32 s30, s56, 3
    v_add_u32 v12, s30, v60
    v_mul_u32_u24 v13, 37, v12
    v_lshrrev_b32 v13, 8, v13
    v_mul_u32_u24 v14, 7, v13
    v_sub_u32 v12, v12, v14
    v_cmp_lt_u32 vcc, 3, v12
    v_lshlrev_b32 v12, 4, v12
    s_nop 0
    v_cndmask_b32 v14, v62, v63, vcc
    v_add_u32 v12, v12, v14
    v_mul_u32_u24 v13, 1792, v13
    v_add_u32 v2, v12, v13
    buffer_load_dwordx4 v2, s[4:7], s59 offen sc1 lds
    v_add_u32 v12, s30, v61
    v_mul_u32_u24 v13, 37, v12
    v_lshrrev_b32 v13, 8, v13
    v_mul_u32_u24 v14, 7, v13
    v_sub_u32 v12, v12, v14
    v_cmp_lt_u32 vcc, 3, v12
    v_lshlrev_b32 v12, 4, v12
    s_nop 0
    v_cndmask_b32 v14, v6, v7, vcc
    v_add_u32 v12, v12, v14
    v_mul_u32_u24 v13, 1792, v13
    v_add_u32 v3, v12, v13
    buffer_load_dwordx4 v3, s[4:7], s60 offen offset:1024 sc1 lds
    s_waitcnt lgkmcnt(3)
    v_mfma_f32_32x32x16_bf16 a[0:15], v[68:71], v[84:87], a[0:15]
    ds_read_b128 v[64:67], v112
    ds_read_b64_tr_b16 v[76:77], v114 offset:6144
    ds_read_b64_tr_b16 v[78:79], v114 offset:6912
    s_waitcnt lgkmcnt(3)
    v_mfma_f32_32x32x16_bf16 a[0:15], v[72:75], v[92:95], a[0:15]
    ds_read_b128 v[68:71], v113
    ds_read_b64_tr_b16 v[84:85], v114 offset:9216
    ds_read_b64_tr_b16 v[86:87], v114 offset:9984
    s_waitcnt lgkmcnt(3)
    v_mfma_f32_32x32x16_bf16 a[0:15], v[64:67], v[76:79], a[0:15]
    v_add_u32 v104, 57344, v100
    v_add_u32 v105, 57344, v101
    v_add_u32 v106, 57344, v102
    v_add_u32 v107, 57344, v103
    v_add_u32 v108, 57344, v21
    s_waitcnt vmcnt(4)
    s_barrier
    ds_read_b128 v[72:75], v104
    ds_read_b64_tr_b16 v[92:93], v108 offset:0
    ds_read_b64_tr_b16 v[94:95], v108 offset:768
    s_waitcnt lgkmcnt(3)
    v_mfma_f32_32x32x16_bf16 a[0:15], v[68:71], v[84:87], a[0:15]
    ds_read_b128 v[64:67], v105
    ds_read_b64_tr_b16 v[76:77], v108 offset:3072
    ds_read_b64_tr_b16 v[78:79], v108 offset:3840
    s_add_u32 m0, s29, 0
    s_mul_i32 s31, s57, 12288
    buffer_load_dwordx4 v4, s[8:11], s31 offen sc1 lds
    s_mov_b64 exec, 0xffffffff
    buffer_load_dwordx4 v5, s[8:11], s31 offen offset:1024 sc1 lds
    s_mov_b64 exec, -1
    s_add_u32 m0, s28, 0
    s_lshl_b32 s30, s57, 3
    v_add_u32 v12, s30, v60
    v_mul_u32_u24 v13, 37, v12
    v_lshrrev_b32 v13, 8, v13
    v_mul_u32_u24 v14, 7, v13
    v_sub_u32 v12, v12, v14
    v_cmp_lt_u32 vcc, 3, v12
    v_lshlrev_b32 v12, 4, v12
    s_nop 0
    v_cndmask_b32 v14, v62, v63, vcc
    v_add_u32 v12, v12, v14
    v_mul_u32_u24 v13, 1792, v13
    v_add_u32 v2, v12, v13
    buffer_load_dwordx4 v2, s[4:7], s59 offen sc1 lds
    v_add_u32 v12, s30, v61
    v_mul_u32_u24 v13, 37, v12
    v_lshrrev_b32 v13, 8, v13
    v_mul_u32_u24 v14, 7, v13
    v_sub_u32 v12, v12, v14
    v_cmp_lt_u32 vcc, 3, v12
    v_lshlrev_b32 v12, 4, v12
    s_nop 0
    v_cndmask_b32 v14, v6, v7, vcc
    v_add_u32 v12, v12, v14
    v_mul_u32_u24 v13, 1792, v13
    v_add_u32 v3, v12, v13
    buffer_load_dwordx4 v3, s[4:7], s60 offen offset:1024 sc1 lds
    s_waitcnt lgkmcnt(3)
    v_mfma_f32_32x32x16_bf16 a[0:15], v[72:75], v[92:95], a[0:15]
    ds_read_b128 v[68:71], v106
    ds_read_b64_tr_b16 v[84:85], v108 offset:6144
    ds_read_b64_tr_b16 v[86:87], v108 offset:6912
    s_waitcnt lgkmcnt(3)
    v_mfma_f32_32x32x16_bf16 a[0:15], v[64:67], v[76:79], a[0:15]
    ds_read_b128 v[72:75], v107
    ds_read_b64_tr_b16 v[92:93], v108 offset:9216
    ds_read_b64_tr_b16 v[94:95], v108 offset:9984
    s_waitcnt lgkmcnt(3)
    v_mfma_f32_32x32x16_bf16 a[0:15], v[68:71], v[84:87], a[0:15]
    v_add_u32 v110, 86016, v100
    v_add_u32 v111, 86016, v101
    v_add_u32 v112, 86016, v102
    v_add_u32 v113, 86016, v103
    v_add_u32 v114, 86016, v21
    s_waitcnt vmcnt(6)
    s_barrier
    ds_read_b128 v[64:67], v110
    ds_read_b64_tr_b16 v[76:77], v114 offset:0
    ds_read_b64_tr_b16 v[78:79], v114 offset:768
    s_waitcnt lgkmcnt(3)
    v_mfma_f32_32x32x16_bf16 a[0:15], v[72:75], v[92:95], a[0:15]
    ds_read_b128 v[68:71], v111
    ds_read_b64_tr_b16 v[84:85], v114 offset:3072
    ds_read_b64_tr_b16 v[86:87], v114 offset:3840
    s_add_u32 m0, s29, 28672
    s_mul_i32 s31, s58, 12288
    buffer_load_dwordx4 v4, s[8:11], s31 offen sc1 lds
    s_mov_b64 exec, 0xffffffff
    buffer_load_dwordx4 v5, s[8:11], s31 offen offset:1024 sc1 lds
    s_mov_b64 exec, -1
    s_add_u32 m0, s28, 28672
    s_lshl_b32 s30, s58, 3
    v_add_u32 v12, s30, v60
    v_mul_u32_u24 v13, 37, v12
    v_lshrrev_b32 v13, 8, v13
    v_mul_u32_u24 v14, 7, v13
    v_sub_u32 v12, v12, v14
    v_cmp_lt_u32 vcc, 3, v12
    v_lshlrev_b32 v12, 4, v12
    s_nop 0
    v_cndmask_b32 v14, v62, v63, vcc
    v_add_u32 v12, v12, v14
    v_mul_u32_u24 v13, 1792, v13
    v_add_u32 v2, v12, v13
    buffer_load_dwordx4 v2, s[4:7], s59 offen sc1 lds
    v_add_u32 v12, s30, v61
    v_mul_u32_u24 v13, 37, v12
    v_lshrrev_b32 v13, 8, v13
    v_mul_u32_u24 v14, 7, v13
    v_sub_u32 v12, v12, v14
    v_cmp_lt_u32 vcc, 3, v12
    v_lshlrev_b32 v12, 4, v12
    s_nop 0
    v_cndmask_b32 v14, v6, v7, vcc
    v_add_u32 v12, v12, v14
    v_mul_u32_u24 v13, 1792, v13
    v_add_u32 v3, v12, v13
    buffer_load_dwordx4 v3, s[4:7], s60 offen offset:1024 sc1 lds
    s_waitcnt lgkmcnt(3)
    v_mfma_f32_32x32x16_bf16 a[0:15], v[64:67], v[76:79], a[0:15]
    ds_read_b128 v[72:75], v112
    ds_read_b64_tr_b16 v[92:93], v114 offset:6144
    ds_read_b64_tr_b16 v[94:95], v114 offset:6912
    s_waitcnt lgkmcnt(3)
    v_mfma_f32_32x32x16_bf16 a[0:15], v[68:71], v[84:87], a[0:15]
    ds_read_b128 v[64:67], v113
    ds_read_b64_tr_b16 v[76:77], v114 offset:9216
    ds_read_b64_tr_b16 v[78:79], v114 offset:9984
    s_waitcnt lgkmcnt(3)
    v_mfma_f32_32x32x16_bf16 a[0:15], v[72:75], v[92:95], a[0:15]
    v_add_u32 v104, 114688, v100
    v_add_u32 v105, 114688, v101
    v_add_u32 v106, 114688, v102
    v_add_u32 v107, 114688, v103
    v_add_u32 v108, 114688, v21
    s_waitcnt vmcnt(8)
    s_barrier
    ds_read_b128 v[68:71], v104
    ds_read_b64_tr_b16 v[84:85], v108 offset:0
    ds_read_b64_tr_b16 v[86:87], v108 offset:768
    s_waitcnt lgkmcnt(3)
    v_mfma_f32_32x32x16_bf16 a[0:15], v[64:67], v[76:79], a[0:15]
    ds_read_b128 v[72:75], v105
    ds_read_b64_tr_b16 v[92:93], v108 offset:3072
    ds_read_b64_tr_b16 v[94:95], v108 offset:3840
    s_waitcnt lgkmcnt(3)
    v_mfma_f32_32x32x16_bf16 a[0:15], v[68:71], v[84:87], a[0:15]
    ds_read_b128 v[64:67], v106
    ds_read_b64_tr_b16 v[76:77], v108 offset:6144
    ds_read_b64_tr_b16 v[78:79], v108 offset:6912
    s_waitcnt lgkmcnt(3)
    v_mfma_f32_32x32x16_bf16 a[0:15], v[72:75], v[92:95], a[0:15]
    ds_read_b128 v[68:71], v107
    ds_read_b64_tr_b16 v[84:85], v108 offset:9216
    ds_read_b64_tr_b16 v[86:87], v108 offset:9984
    s_waitcnt lgkmcnt(3)
    v_mfma_f32_32x32x16_bf16 a[0:15], v[64:67], v[76:79], a[0:15]
    v_add_u32 v110, 0, v100
    v_add_u32 v111, 0, v101
    v_add_u32 v112, 0, v102
    v_add_u32 v113, 0, v103
    v_add_u32 v114, 0, v21
    s_waitcnt vmcnt(4)
    s_barrier
    ds_read_b128 v[72:75], v110
    ds_read_b64_tr_b16 v[92:93], v114 offset:0
    ds_read_b64_tr_b16 v[94:95], v114 offset:768
    s_waitcnt lgkmcnt(3)
    v_mfma_f32_32x32x16_bf16 a[0:15], v[68:71], v[84:87], a[0:15]
    ds_read_b128 v[64:67], v111
    ds_read_b64_tr_b16 v[76:77], v114 offset:3072
    ds_read_b64_tr_b16 v[78:79], v114 offset:3840
    s_waitcnt lgkmcnt(3)
    v_mfma_f32_32x32x16_bf16 a[0:15], v[72:75], v[92:95], a[0:15]
    ds_read_b128 v[68:71], v112
    ds_read_b64_tr_b16 v[84:85], v114 offset:6144
    ds_read_b64_tr_b16 v[86:87], v114 offset:6912
    s_waitcnt lgkmcnt(3)
    v_mfma_f32_32x32x16_bf16 a[0:15], v[64:67], v[76:79], a[0:15]
    ds_read_b128 v[72:75], v113
    ds_read_b64_tr_b16 v[92:93], v114 offset:9216
    ds_read_b64_tr_b16 v[94:95], v114 offset:9984
    s_waitcnt lgkmcnt(3)
    v_mfma_f32_32x32x16_bf16 a[0:15], v[68:71], v[84:87], a[0:15]
    v_add_u32 v104, 28672, v100
    v_add_u32 v105, 28672, v101
    v_add_u32 v106, 28672, v102
    v_add_u32 v107, 28672, v103
    v_add_u32 v108, 28672, v21
    s_waitcnt vmcnt(0)
    s_barrier
    ds_read_b128 v[64:67], v104
    ds_read_b64_tr_b16 v[76:77], v108 offset:0
    ds_read_b64_tr_b16 v[78:79], v108 offset:768
    s_waitcnt lgkmcnt(3)
    v_mfma_f32_32x32x16_bf16 a[0:15], v[72:75], v[92:95], a[0:15]
    ds_read_b128 v[68:71], v105
    ds_read_b64_tr_b16 v[84:85], v108 offset:3072
    ds_read_b64_tr_b16 v[86:87], v108 offset:3840
    s_waitcnt lgkmcnt(3)
    v_mfma_f32_32x32x16_bf16 a[0:15], v[64:67], v[76:79], a[0:15]
    ds_read_b128 v[72:75], v106
    ds_read_b64_tr_b16 v[92:93], v108 offset:6144
    ds_read_b64_tr_b16 v[94:95], v108 offset:6912
    s_waitcnt lgkmcnt(3)
    v_mfma_f32_32x32x16_bf16 a[0:15], v[68:71], v[84:87], a[0:15]
    ds_read_b128 v[64:67], v107
    ds_read_b64_tr_b16 v[76:77], v108 offset:9216
    ds_read_b64_tr_b16 v[78:79], v108 offset:9984
    s_waitcnt lgkmcnt(3)
    v_mfma_f32_32x32x16_bf16 a[0:15], v[72:75], v[92:95], a[0:15]
    s_waitcnt lgkmcnt(0)
    v_mfma_f32_32x32x16_bf16 a[0:15], v[64:67], v[76:79], a[0:15]
    s_lshl_b32 s36, s24, 6
    s_lshl_b32 s37, s23, 2
    s_add_u32 s36, s36, s37
    s_add_u32 s36, s36, s47
    s_lshl_b32 s36, s36, 11
    v_lshlrev_b32 v59, 4, v1
    v_add_u32 v59, s36, v59
    v_and_b32 v62, 31, v1
    v_cmp_gt_u32 s[42:43], 28, v62
    v_cmp_eq_u32 vcc, 28, v62
    v_mov_b32 v63, 0x3f803f80
    s_nop 0
    v_cndmask_b32 v63, 0, v63, vcc
    v_accvgpr_read_b32 v64, a0
    v_accvgpr_read_b32 v65, a1
    v_accvgpr_read_b32 v66, a2
    v_accvgpr_read_b32 v67, a3
    v_accvgpr_read_b32 v68, a4
    v_accvgpr_read_b32 v69, a5
    v_accvgpr_read_b32 v70, a6
    v_accvgpr_read_b32 v71, a7
    v_accvgpr_read_b32 v72, a8
    v_accvgpr_read_b32 v73, a9
    v_accvgpr_read_b32 v74, a10
    v_accvgpr_read_b32 v75, a11
    v_accvgpr_read_b32 v76, a12
    v_accvgpr_read_b32 v77, a13
    v_accvgpr_read_b32 v78, a14
    v_accvgpr_read_b32 v79, a15
    v_fma_f32 v64, v64, v120, v136
    v_fma_f32 v65, v65, v121, v137
    v_fma_f32 v66, v66, v122, v138
    v_fma_f32 v67, v67, v123, v139
    v_fma_f32 v68, v68, v124, v140
    v_fma_f32 v69, v69, v125, v141
    v_fma_f32 v70, v70, v126, v142
    v_fma_f32 v71, v71, v127, v143
    v_fma_f32 v72, v72, v128, v144
    v_fma_f32 v73, v73, v129, v145
    v_fma_f32 v74, v74, v130, v146
    v_fma_f32 v75, v75, v131, v147
    v_fma_f32 v76, v76, v132, v148
    v_fma_f32 v77, v77, v133, v149
    v_fma_f32 v78, v78, v134, v150
    v_fma_f32 v79, v79, v135, v151
    v_cvt_pk_bf16_f32 v96, v64, v65
    v_cndmask_b32 v96, v63, v96, s[42:43]
    v_cvt_pk_bf16_f32 v97, v66, v67
    v_cndmask_b32 v97, v63, v97, s[42:43]
    v_cvt_pk_bf16_f32 v98, v68, v69
    v_cndmask_b32 v98, v63, v98, s[42:43]
    v_cvt_pk_bf16_f32 v99, v70, v71
    v_cndmask_b32 v99, v63, v99, s[42:43]
    v_cvt_pk_bf16_f32 v100, v72, v73
    v_cndmask_b32 v100, v63, v100, s[42:43]
    v_cvt_pk_bf16_f32 v101, v74, v75
    v_cndmask_b32 v101, v63, v101, s[42:43]
    v_cvt_pk_bf16_f32 v102, v76, v77
    v_cndmask_b32 v102, v63, v102, s[42:43]
    v_cvt_pk_bf16_f32 v103, v78, v79
    v_cndmask_b32 v103, v63, v103, s[42:43]
    s_mov_b32 s40, 0x2400000
    buffer_store_dwordx4 v[96:99], v59, s[12:15], s40 offen sc0 sc1
    buffer_store_dwordx4 v[100:103], v59, s[12:15], s40 offen offset:1024 sc0 sc1
L_pk1b_e2:
    s_nop 1
    s_lshl_b32 s34, s24, 7
    s_lshl_b32 s35, s23, 2
    s_add_u32 s34, s34, s35
    s_add_u32 s34, s34, 0x100e800
    s_waitcnt vmcnt(0) lgkmcnt(0)
    s_barrier
    v_mov_b32 v10, 0
    v_mov_b32 v11, 1
    v_cmp_eq_u32 vcc, 0, v0
    s_and_saveexec_b64 s[44:45], vcc
    s_cbranch_execz L_pub14
    buffer_atomic_add v11, v10, s[12:15], s34 offen sc1
L_pub14:
    s_mov_b64 exec, -1
    s_nop 1
    s_load_dwordx2 s[20:21], s[0:1], 80
    v_and_b32 v1, 63, v0
    v_lshrrev_b32 v2, 6, v0
    s_nop 0
    v_readfirstlane_b32 s22, v2
    s_lshr_b32 s23, s2, 4
    s_and_b32 s24, s2, 15
    s_and_b32 s38, s22, 3
    s_lshr_b32 s39, s22, 2
    v_lshlrev_b32 v2, 4, v1
    s_lshl_b32 s25, s24, 17
    s_lshl_b32 s26, s23, 2
    s_sub_u32 s26, s26, 8
    s_mul_i32 s27, s22, 3
    s_add_u32 s34, s27, 0
    s_lshr_b32 s35, s34, 1
    s_add_i32 s35, s35, s26
    s_lshl_b32 s36, s35, 11
    s_and_b32 s37, s34, 1
    s_lshl_b32 s37, s37, 10
    s_add_u32 s36, s36, s37
    s_cmp_lt_i32 s35, 0
    s_cselect_b32 s72, 0x40000000, s36
    s_add_u32 s34, s27, 1
    s_lshr_b32 s35, s34, 1
    s_add_i32 s35, s35, s26
    s_lshl_b32 s36, s35, 11
    s_and_b32 s37, s34, 1
    s_lshl_b32 s37, s37, 10
    s_add_u32 s36, s36, s37
    s_cmp_lt_i32 s35, 0
    s_cselect_b32 s73, 0x40000000, s36
    s_add_u32 s34, s27, 2
    s_lshr_b32 s35, s34, 1
    s_add_i32 s35, s35, s26
    s_lshl_b32 s36, s35, 11
    s_and_b32 s37, s34, 1
    s_lshl_b32 s37, s37, 10
    s_add_u32 s36, s36, s37
    s_cmp_lt_i32 s35, 0
    s_cselect_b32 s74, 0x40000000, s36
    s_lshl_b32 s29, s27, 10
    s_waitcnt lgkmcnt(0)
    s_add_u32 s28, s25, 0x2000000
    s_add_u32 s4, s20, s28
    s_addc_u32 s5, s21, 0
    s_and_b32 s5, s5, 0xffff
    s_mov_b32 s6, 0x20000
    s_mov_b32 s7, 0x00020000
    s_add_u32 s28, s25, 0x2200000
    s_add_u32 s8, s20, s28
    s_addc_u32 s9, s21, 0
    s_and_b32 s9, s9, 0xffff
    s_mov_b32 s10, 0x20000
    s_mov_b32 s11, 0x00020000
    s_add_u32 s28, s25, 0x2400000
    s_add_u32 s12, s20, s28
    s_addc_u32 s13, s21, 0
    s_and_b32 s13, s13, 0xffff
    s_mov_b32 s14, 0x20000
    s_mov_b32 s15, 0x00020000
    s_mov_b32 s92, s20
    s_and_b32 s93, s21, 0xffff
    s_mov_b32 s94, 0x4000000
    s_mov_b32 s95, 0x00020000
    s_lshl_b32 s34, s24, 7
    s_add_u32 s34, s34, 0x100e800
    v_add_u32 v10, s23, v1
    v_subrev_u32 v10, 2, v10
    v_max_i32 v10, 0, v10
    v_lshlrev_b32 v10, 2, v10
    s_cmp_lg_u32 s22, 0
    s_cbranch_scc1 L_aww15
    s_mov_b64 exec, 0x7
    s_mov_b32 s45, 0x40000
L_awp15:
    buffer_load_dword v168, v10, s[92:95], s34 offen sc0 sc1
    s_waitcnt vmcnt(0)
    v_cmp_gt_u32 vcc, 1, v168
    s_cbranch_vccz L_awd15
    s_sub_u32 s45, s45, 1
    s_cmp_lg_u32 s45, 0
    s_cbranch_scc1 L_awp15
L_awd15:
    s_mov_b64 exec, -1
L_aww15:
    s_nop 0
    s_barrier
    s_add_u32 m0, s29, 0
    s_nop 0
    buffer_load_dwordx4 v2, s[8:11], s72 offen sc1 lds
    s_add_u32 m0, s29, 1024
    s_nop 0
    buffer_load_dwordx4 v2, s[8:11], s73 offen sc1 lds
    s_add_u32 m0, s29, 2048
    s_nop 0
    buffer_load_dwordx4 v2, s[8:11], s74 offen sc1 lds
    s_lshl_b32 s30, s23, 13
    s_lshl_b32 s31, s22, 10
    s_add_u32 s30, s30, s31
    s_add_u32 m0, s31, 49152
    s_nop 0
    buffer_load_dwordx4 v2, s[4:7], s30 offen sc1 lds
    s_barrier
    s_add_u32 m0, s29, 24576
    s_nop 0
    buffer_load_dwordx4 v2, s[12:15], s72 offen sc1 lds
    s_add_u32 m0, s29, 25600
    s_nop 0
    buffer_load_dwordx4 v2, s[12:15], s73 offen sc1 lds
    s_add_u32 m0, s29, 26624
    s_nop 0
    buffer_load_dwordx4 v2, s[12:15], s74 offen sc1 lds
    s_add_u32 s16, s20, 0x2600000
    s_addc_u32 s17, s21, 0
    s_and_b32 s17, s17, 0xffff
    s_mov_b32 s18, 0x200000
    s_mov_b32 s19, 0x00020000
    v_and_b32 v4, 31, v1
    v_lshrrev_b32 v5, 5, v1
    v_mov_b32 v18, 0xf14a
    v_mul_lo_u32 v18, v18, v5
    v_add_u32 v19, s29, v2
    v_lshlrev_b32 v6, 2, v5
    v_sub_u32 v6, v4, v6
    v_cmp_ge_i32 s[40:41], v6, 0
    v_cmp_ge_i32 s[42:43], v6, 1
    v_cmp_ge_i32 s[44:45], v6, 2
    v_cmp_ge_i32 s[46:47], v6, 3
    v_cmp_ge_i32 s[48:49], v6, 8
    v_cmp_ge_i32 s[50:51], v6, 9
    v_cmp_ge_i32 s[52:53], v6, 10
    v_cmp_ge_i32 s[54:55], v6, 11
    v_cmp_ge_i32 s[56:57], v6, 16
    v_cmp_ge_i32 s[58:59], v6, 17
    v_cmp_ge_i32 s[60:61], v6, 18
    v_cmp_ge_i32 s[62:63], v6, 19
    v_cmp_ge_i32 s[64:65], v6, 24
    v_cmp_ge_i32 s[66:67], v6, 25
    v_cmp_ge_i32 s[68:69], v6, 26
    v_cmp_ge_i32 s[70:71], v6, 27
    v_mov_b32 v7, 0xffff
    v_mov_b32 v16, 0xffff0000
    v_cndmask_b32 v8, 0, v7, s[40:41]
    v_cndmask_b32 v17, 0, v16, s[42:43]
    v_or_b32 v8, v8, v17
    v_cndmask_b32 v9, 0, v7, s[44:45]
    v_cndmask_b32 v17, 0, v16, s[46:47]
    v_or_b32 v9, v9, v17
    v_cndmask_b32 v10, 0, v7, s[48:49]
    v_cndmask_b32 v17, 0, v16, s[50:51]
    v_or_b32 v10, v10, v17
    v_cndmask_b32 v11, 0, v7, s[52:53]
    v_cndmask_b32 v17, 0, v16, s[54:55]
    v_or_b32 v11, v11, v17
    v_cndmask_b32 v12, 0, v7, s[56:57]
    v_cndmask_b32 v17, 0, v16, s[58:59]
    v_or_b32 v12, v12, v17
    v_cndmask_b32 v13, 0, v7, s[60:61]
    v_cndmask_b32 v17, 0, v16, s[62:63]
    v_or_b32 v13, v13, v17
    v_cndmask_b32 v14, 0, v7, s[64:65]
    v_cndmask_b32 v17, 0, v16, s[66:67]
    v_or_b32 v14, v14, v17
    v_cndmask_b32 v15, 0, v7, s[68:69]
    v_cndmask_b32 v17, 0, v16, s[70:71]
    v_or_b32 v15, v15, v17
    s_waitcnt vmcnt(3)
    s_add_u32 s34, s27, 0
    s_and_b32 s34, s34, 1
    s_cmp_eq_u32 s72, 0x40000000
    s_cselect_b32 s35, s34, 0
    s_cmp_eq_u32 s35, 0
    s_cbranch_scc1 L_pk2b_np0
    ds_write_b32 v19, v18 offset:8
L_pk2b_np0:
    s_add_u32 s34, s27, 1
    s_and_b32 s34, s34, 1
    s_cmp_eq_u32 s73, 0x40000000
    s_cselect_b32 s35, s34, 0
    s_cmp_eq_u32 s35, 0
    s_cbranch_scc1 L_pk2b_np1
    ds_write_b32 v19, v18 offset:1032
L_pk2b_np1:
    s_add_u32 s34, s27, 2
    s_and_b32 s34, s34, 1
    s_cmp_eq_u32 s74, 0x40000000
    s_cselect_b32 s35, s34, 0
    s_cmp_eq_u32 s35, 0
    s_cbranch_scc1 L_pk2b_np2
    ds_write_b32 v19, v18 offset:2056
L_pk2b_np2:
    s_waitcnt lgkmcnt(0)
    s_barrier
    s_lshl_b32 s35, s38, 11
    v_add_u32 v28, s35, v2
    ds_read_b128 v[20:23], v28 offset:49152
    ds_read_b128 v[24:27], v28 offset:50176
    s_mul_i32 s36, s22, 4096
    s_add_u32 s36, s36, 57344
    v_add_u32 v44, s36, v2
    s_xor_b32 s37, s22, 4
    s_mul_i32 s37, s37, 4096
    s_add_u32 s37, s37, 57344
    v_add_u32 v45, s37, v2
    s_cmp_eq_u32 s39, 0
    s_cbranch_scc0 L_pk2b_h1
    ds_read_b128 a[0:3], v28 offset:0
    ds_read_b128 a[4:7], v28 offset:1024
    ds_read_b128 a[8:11], v28 offset:16384
    ds_read_b128 a[12:15], v28 offset:17408
    ds_read_b128 a[16:19], v28 offset:2048
    ds_read_b128 a[20:23], v28 offset:3072
    ds_read_b128 a[24:27], v28 offset:4096
    ds_read_b128 a[28:31], v28 offset:5120
    ds_read_b128 a[32:35], v28 offset:6144
    ds_read_b128 a[36:39], v28 offset:7168
    s_waitcnt lgkmcnt(9)
    v_mfma_f32_32x32x16_bf16 v[48:63], a[0:3], v[20:23], 0
    s_waitcnt lgkmcnt(8)
    v_mfma_f32_32x32x16_bf16 v[48:63], a[4:7], v[24:27], v[48:63]
    s_waitcnt lgkmcnt(7)
    v_mfma_f32_32x32x16_bf16 v[64:79], a[8:11], v[20:23], 0
    s_waitcnt lgkmcnt(6)
    v_mfma_f32_32x32x16_bf16 v[64:79], a[12:15], v[24:27], v[64:79]
    s_waitcnt lgkmcnt(5)
    v_mfma_f32_32x32x16_bf16 v[80:95], a[16:19], v[20:23], 0
    s_waitcnt lgkmcnt(4)
    v_mfma_f32_32x32x16_bf16 v[80:95], a[20:23], v[24:27], v[80:95]
    s_waitcnt lgkmcnt(3)
    v_mfma_f32_32x32x16_bf16 v[96:111], a[24:27], v[20:23], 0
    s_waitcnt lgkmcnt(2)
    v_mfma_f32_32x32x16_bf16 v[96:111], a[28:31], v[24:27], v[96:111]
    s_nop 3
    v_cndmask_b32 v48, v48, v64, s[40:41]
    v_cndmask_b32 v49, v49, v65, s[42:43]
    v_cndmask_b32 v50, v50, v66, s[44:45]
    v_cndmask_b32 v51, v51, v67, s[46:47]
    v_cndmask_b32 v52, v52, v68, s[48:49]
    v_cndmask_b32 v53, v53, v69, s[50:51]
    v_cndmask_b32 v54, v54, v70, s[52:53]
    v_cndmask_b32 v55, v55, v71, s[54:55]
    v_cndmask_b32 v56, v56, v72, s[56:57]
    v_cndmask_b32 v57, v57, v73, s[58:59]
    v_cndmask_b32 v58, v58, v74, s[60:61]
    v_cndmask_b32 v59, v59, v75, s[62:63]
    v_cndmask_b32 v60, v60, v76, s[64:65]
    v_cndmask_b32 v61, v61, v77, s[66:67]
    v_cndmask_b32 v62, v62, v78, s[68:69]
    v_cndmask_b32 v63, v63, v79, s[70:71]
    s_waitcnt lgkmcnt(1)
    v_mfma_f32_32x32x16_bf16 v[64:79], a[32:35], v[20:23], 0
    s_waitcnt lgkmcnt(0)
    v_mfma_f32_32x32x16_bf16 v[64:79], a[36:39], v[24:27], v[64:79]
    v_max3_f32 v30, v48, v49, v50
    v_max3_f32 v30, v30, v51, v52
    v_max3_f32 v30, v30, v53, v54
    v_max3_f32 v30, v30, v55, v56
    v_max3_f32 v30, v30, v57, v58
    v_max3_f32 v30, v30, v59, v60
    v_max3_f32 v30, v30, v61, v62
    v_max_f32 v30, v30, v63
    v_max3_f32 v30, v30, v80, v81
    v_max3_f32 v30, v30, v82, v83
    v_max3_f32 v30, v30, v84, v85
    v_max3_f32 v30, v30, v86, v87
    v_max3_f32 v30, v30, v88, v89
    v_max3_f32 v30, v30, v90, v91
    v_max3_f32 v30, v30, v92, v93
    v_max3_f32 v30, v30, v94, v95
    v_max3_f32 v30, v30, v96, v97
    v_max3_f32 v30, v30, v98, v99
    v_max3_f32 v30, v30, v100, v101
    v_max3_f32 v30, v30, v102, v103
    v_max3_f32 v30, v30, v104, v105
    v_max3_f32 v30, v30, v106, v107
    v_max3_f32 v30, v30, v108, v109
    v_max3_f32 v30, v30, v110, v111
    v_max3_f32 v30, v30, v64, v65
    v_max3_f32 v30, v30, v66, v67
    v_max3_f32 v30, v30, v68, v69
    v_max3_f32 v30, v30, v70, v71
    v_max3_f32 v30, v30, v72, v73
    v_max3_f32 v30, v30, v74, v75
    v_max3_f32 v30, v30, v76, v77
    v_max3_f32 v30, v30, v78, v79
    v_mov_b32 v31, v30
    s_nop 1
    v_permlane32_swap_b32 v31, v30
    v_max_f32 v30, v30, v31
    ds_write_b32 v44, v30
    s_waitcnt vmcnt(0)
    s_waitcnt lgkmcnt(0)
    s_barrier
    ds_read_b32 v31, v45
    ds_read_b128 a[40:43], v28 offset:24576
    ds_read_b128 a[44:47], v28 offset:25600
    ds_read_b128 a[48:51], v28 offset:40960
    ds_read_b128 a[52:55], v28 offset:41984
    ds_read_b128 a[56:59], v28 offset:26624
    ds_read_b128 a[60:63], v28 offset:27648
    ds_read_b128 a[64:67], v28 offset:28672
    ds_read_b128 a[68:71], v28 offset:29696
    ds_read_b128 a[72:75], v28 offset:30720
    ds_read_b128 a[76:79], v28 offset:31744
    s_waitcnt lgkmcnt(10)
    v_max_f32 v30, v30, v31
    v_sub_f32 v112, 0, v30
    v_sub_f32 v113, 0, v30
    v_sub_f32 v114, 0, v30
    v_sub_f32 v115, 0, v30
    v_sub_f32 v116, 0, v30
    v_sub_f32 v117, 0, v30
    v_sub_f32 v118, 0, v30
    v_sub_f32 v119, 0, v30
    v_sub_f32 v120, 0, v30
    v_sub_f32 v121, 0, v30
    v_sub_f32 v122, 0, v30
    v_sub_f32 v123, 0, v30
    v_sub_f32 v124, 0, v30
    v_sub_f32 v125, 0, v30
    v_sub_f32 v126, 0, v30
    v_sub_f32 v127, 0, v30
    s_nop 1
    v_mfma_f32_32x32x16_bf16 v[48:63], a[0:3], v[20:23], v[112:127]
    v_mfma_f32_32x32x16_bf16 v[48:63], a[4:7], v[24:27], v[48:63]
    v_mfma_f32_32x32x16_bf16 v[64:79], a[8:11], v[20:23], v[112:127]
    v_mfma_f32_32x32x16_bf16 v[64:79], a[12:15], v[24:27], v[64:79]
    v_mfma_f32_32x32x16_bf16 v[80:95], a[16:19], v[20:23], v[112:127]
    v_mfma_f32_32x32x16_bf16 v[80:95], a[20:23], v[24:27], v[80:95]
    v_mfma_f32_32x32x16_bf16 v[96:111], a[24:27], v[20:23], v[112:127]
    v_mfma_f32_32x32x16_bf16 v[96:111], a[28:31], v[24:27], v[96:111]
    s_nop 7
    v_cndmask_b32 v48, v48, v64, s[40:41]
    v_cndmask_b32 v49, v49, v65, s[42:43]
    v_cndmask_b32 v50, v50, v66, s[44:45]
    v_cndmask_b32 v51, v51, v67, s[46:47]
    v_cndmask_b32 v52, v52, v68, s[48:49]
    v_cndmask_b32 v53, v53, v69, s[50:51]
    v_cndmask_b32 v54, v54, v70, s[52:53]
    v_cndmask_b32 v55, v55, v71, s[54:55]
    v_cndmask_b32 v56, v56, v72, s[56:57]
    v_cndmask_b32 v57, v57, v73, s[58:59]
    v_cndmask_b32 v58, v58, v74, s[60:61]
    v_cndmask_b32 v59, v59, v75, s[62:63]
    v_cndmask_b32 v60, v60, v76, s[64:65]
    v_cndmask_b32 v61, v61, v77, s[66:67]
    v_cndmask_b32 v62, v62, v78, s[68:69]
    v_cndmask_b32 v63, v63, v79, s[70:71]
    v_mfma_f32_32x32x16_bf16 v[64:79], a[32:35], v[20:23], v[112:127]
    v_mfma_f32_32x32x16_bf16 v[64:79], a[36:39], v[24:27], v[64:79]
    v_exp_f32 v48, v48
    v_exp_f32 v49, v49
    v_exp_f32 v50, v50
    v_exp_f32 v51, v51
    v_exp_f32 v52, v52
    v_exp_f32 v53, v53
    v_exp_f32 v54, v54
    v_exp_f32 v55, v55
    v_exp_f32 v56, v56
    v_exp_f32 v57, v57
    v_exp_f32 v58, v58
    v_exp_f32 v59, v59
    v_exp_f32 v60, v60
    v_exp_f32 v61, v61
    v_exp_f32 v62, v62
    v_exp_f32 v63, v63
    v_cvt_pk_bf16_f32 v144, v48, v49
    v_cvt_pk_bf16_f32 v145, v50, v51
    v_cvt_pk_bf16_f32 v146, v52, v53
    v_cvt_pk_bf16_f32 v147, v54, v55
    v_cvt_pk_bf16_f32 v148, v56, v57
    v_cvt_pk_bf16_f32 v149, v58, v59
    v_cvt_pk_bf16_f32 v150, v60, v61
    v_cvt_pk_bf16_f32 v151, v62, v63
    v_and_b32 v152, v8, v144
    v_xor_b32 v144, v144, v152
    v_and_b32 v153, v9, v145
    v_xor_b32 v145, v145, v153
    v_and_b32 v154, v10, v146
    v_xor_b32 v146, v146, v154
    v_and_b32 v155, v11, v147
    v_xor_b32 v147, v147, v155
    v_and_b32 v156, v12, v148
    v_xor_b32 v148, v148, v156
    v_and_b32 v157, v13, v149
    v_xor_b32 v149, v149, v157
    v_and_b32 v158, v14, v150
    v_xor_b32 v150, v150, v158
    v_and_b32 v159, v15, v151
    v_xor_b32 v151, v151, v159
    s_waitcnt lgkmcnt(9)
    v_mfma_f32_32x32x16_bf16 v[128:143], a[40:43], v[144:147], 0
    s_waitcnt lgkmcnt(8)
    v_mfma_f32_32x32x16_bf16 v[128:143], a[44:47], v[148:151], v[128:143]
    s_waitcnt lgkmcnt(7)
    v_mfma_f32_32x32x16_bf16 v[128:143], a[48:51], v[152:155], v[128:143]
    s_waitcnt lgkmcnt(6)
    v_mfma_f32_32x32x16_bf16 v[128:143], a[52:55], v[156:159], v[128:143]
    v_exp_f32 v80, v80
    v_exp_f32 v81, v81
    v_exp_f32 v82, v82
    v_exp_f32 v83, v83
    v_exp_f32 v84, v84
    v_exp_f32 v85, v85
    v_exp_f32 v86, v86
    v_exp_f32 v87, v87
    v_exp_f32 v88, v88
    v_exp_f32 v89, v89
    v_exp_f32 v90, v90
    v_exp_f32 v91, v91
    v_exp_f32 v92, v92
    v_exp_f32 v93, v93
    v_exp_f32 v94, v94
    v_exp_f32 v95, v95
    v_cvt_pk_bf16_f32 v160, v80, v81
    v_cvt_pk_bf16_f32 v161, v82, v83
    v_cvt_pk_bf16_f32 v162, v84, v85
    v_cvt_pk_bf16_f32 v163, v86, v87
    v_cvt_pk_bf16_f32 v164, v88, v89
    v_cvt_pk_bf16_f32 v165, v90, v91
    v_cvt_pk_bf16_f32 v166, v92, v93
    v_cvt_pk_bf16_f32 v167, v94, v95
    s_waitcnt lgkmcnt(5)
    v_mfma_f32_32x32x16_bf16 v[128:143], a[56:59], v[160:163], v[128:143]
    s_waitcnt lgkmcnt(4)
    v_mfma_f32_32x32x16_bf16 v[128:143], a[60:63], v[164:167], v[128:143]
    v_exp_f32 v96, v96
    v_exp_f32 v97, v97
    v_exp_f32 v98, v98
    v_exp_f32 v99, v99
    v_exp_f32 v100, v100
    v_exp_f32 v101, v101
    v_exp_f32 v102, v102
    v_exp_f32 v103, v103
    v_exp_f32 v104, v104
    v_exp_f32 v105, v105
    v_exp_f32 v106, v106
    v_exp_f32 v107, v107
    v_exp_f32 v108, v108
    v_exp_f32 v109, v109
    v_exp_f32 v110, v110
    v_exp_f32 v111, v111
    v_cvt_pk_bf16_f32 v144, v96, v97
    v_cvt_pk_bf16_f32 v145, v98, v99
    v_cvt_pk_bf16_f32 v146, v100, v101
    v_cvt_pk_bf16_f32 v147, v102, v103
    v_cvt_pk_bf16_f32 v148, v104, v105
    v_cvt_pk_bf16_f32 v149, v106, v107
    v_cvt_pk_bf16_f32 v150, v108, v109
    v_cvt_pk_bf16_f32 v151, v110, v111
    s_waitcnt lgkmcnt(3)
    v_mfma_f32_32x32x16_bf16 v[128:143], a[64:67], v[144:147], v[128:143]
    s_waitcnt lgkmcnt(2)
    v_mfma_f32_32x32x16_bf16 v[128:143], a[68:71], v[148:151], v[128:143]
    v_exp_f32 v64, v64
    v_exp_f32 v65, v65
    v_exp_f32 v66, v66
    v_exp_f32 v67, v67
    v_exp_f32 v68, v68
    v_exp_f32 v69, v69
    v_exp_f32 v70, v70
    v_exp_f32 v71, v71
    v_exp_f32 v72, v72
    v_exp_f32 v73, v73
    v_exp_f32 v74, v74
    v_exp_f32 v75, v75
    v_exp_f32 v76, v76
    v_exp_f32 v77, v77
    v_exp_f32 v78, v78
    v_exp_f32 v79, v79
    v_cvt_pk_bf16_f32 v152, v64, v65
    v_cvt_pk_bf16_f32 v153, v66, v67
    v_cvt_pk_bf16_f32 v154, v68, v69
    v_cvt_pk_bf16_f32 v155, v70, v71
    v_cvt_pk_bf16_f32 v156, v72, v73
    v_cvt_pk_bf16_f32 v157, v74, v75
    v_cvt_pk_bf16_f32 v158, v76, v77
    v_cvt_pk_bf16_f32 v159, v78, v79
    s_waitcnt lgkmcnt(1)
    v_mfma_f32_32x32x16_bf16 v[128:143], a[72:75], v[152:155], v[128:143]
    s_waitcnt lgkmcnt(0)
    v_mfma_f32_32x32x16_bf16 v[128:143], a[76:79], v[156:159], v[128:143]
    s_nop 11
    ds_write_b128 v44, v[136:139] offset:1024
    ds_write_b128 v44, v[140:143] offset:2048
    ds_write_b32 v44, v140 offset:3072
    s_waitcnt lgkmcnt(0)
    s_barrier
    ds_read_b128 v[144:147], v45 offset:1024
    ds_read_b128 v[148:151], v45 offset:2048
    ds_read_b32 v32, v45 offset:3072
    s_waitcnt lgkmcnt(0)
    v_add_f32 v32, v32, v140
    v_mov_b32 v33, v32
    s_nop 1
    v_permlane32_swap_b32 v33, v32
    v_rcp_f32 v33, v32
    v_add_f32 v128, v128, v144
    v_mul_f32 v128, v128, v33
    v_add_f32 v129, v129, v145
    v_mul_f32 v129, v129, v33
    v_add_f32 v130, v130, v146
    v_mul_f32 v130, v130, v33
    v_add_f32 v131, v131, v147
    v_mul_f32 v131, v131, v33
    v_add_f32 v132, v132, v148
    v_mul_f32 v132, v132, v33
    v_add_f32 v133, v133, v149
    v_mul_f32 v133, v133, v33
    v_add_f32 v134, v134, v150
    v_mul_f32 v134, v134, v33
    v_add_f32 v135, v135, v151
    v_mul_f32 v135, v135, v33
    v_cvt_pk_bf16_f32 v152, v128, v129
    v_cvt_pk_bf16_f32 v153, v130, v131
    v_cvt_pk_bf16_f32 v154, v132, v133
    v_cvt_pk_bf16_f32 v155, v134, v135
    s_lshl_b32 s37, s23, 2
    s_add_u32 s37, s37, s38
    s_lshl_b32 s37, s37, 15
    s_lshl_b32 s36, s24, 10
    s_add_u32 s37, s37, s36
    v_bfe_u32 v35, v1, 4, 1
    v_lshlrev_b32 v35, 14, v35
    v_and_b32 v36, 15, v1
    v_lshl_add_u32 v35, v36, 4, v35
    v_lshl_add_u32 v35, v5, 8, v35
    buffer_store_dwordx4 v[152:155], v35, s[16:19], s37 offen offset:0 sc0 sc1
    s_branch L_pk2b_done
L_pk2b_h1:
    s_waitcnt lgkmcnt(0)
    ds_read_b128 a[0:3], v28 offset:8192
    ds_read_b128 a[4:7], v28 offset:9216
    ds_read_b128 a[8:11], v28 offset:10240
    ds_read_b128 a[12:15], v28 offset:11264
    ds_read_b128 a[16:19], v28 offset:12288
    ds_read_b128 a[20:23], v28 offset:13312
    ds_read_b128 a[24:27], v28 offset:14336
    ds_read_b128 a[28:31], v28 offset:15360
    s_waitcnt lgkmcnt(7)
    v_mfma_f32_32x32x16_bf16 v[48:63], a[0:3], v[20:23], 0
    s_waitcnt lgkmcnt(6)
    v_mfma_f32_32x32x16_bf16 v[48:63], a[4:7], v[24:27], v[48:63]
    s_waitcnt lgkmcnt(5)
    v_mfma_f32_32x32x16_bf16 v[64:79], a[8:11], v[20:23], 0
    s_waitcnt lgkmcnt(4)
    v_mfma_f32_32x32x16_bf16 v[64:79], a[12:15], v[24:27], v[64:79]
    s_waitcnt lgkmcnt(3)
    v_mfma_f32_32x32x16_bf16 v[80:95], a[16:19], v[20:23], 0
    s_waitcnt lgkmcnt(2)
    v_mfma_f32_32x32x16_bf16 v[80:95], a[20:23], v[24:27], v[80:95]
    s_waitcnt lgkmcnt(1)
    v_mfma_f32_32x32x16_bf16 v[96:111], a[24:27], v[20:23], 0
    s_waitcnt lgkmcnt(0)
    v_mfma_f32_32x32x16_bf16 v[96:111], a[28:31], v[24:27], v[96:111]
    v_max3_f32 v30, v48, v49, v50
    v_max3_f32 v30, v30, v51, v52
    v_max3_f32 v30, v30, v53, v54
    v_max3_f32 v30, v30, v55, v56
    v_max3_f32 v30, v30, v57, v58
    v_max3_f32 v30, v30, v59, v60
    v_max3_f32 v30, v30, v61, v62
    v_max_f32 v30, v30, v63
    v_max3_f32 v30, v30, v64, v65
    v_max3_f32 v30, v30, v66, v67
    v_max3_f32 v30, v30, v68, v69
    v_max3_f32 v30, v30, v70, v71
    v_max3_f32 v30, v30, v72, v73
    v_max3_f32 v30, v30, v74, v75
    v_max3_f32 v30, v30, v76, v77
    v_max3_f32 v30, v30, v78, v79
    v_max3_f32 v30, v30, v80, v81
    v_max3_f32 v30, v30, v82, v83
    v_max3_f32 v30, v30, v84, v85
    v_max3_f32 v30, v30, v86, v87
    v_max3_f32 v30, v30, v88, v89
    v_max3_f32 v30, v30, v90, v91
    v_max3_f32 v30, v30, v92, v93
    v_max3_f32 v30, v30, v94, v95
    v_max3_f32 v30, v30, v96, v97
    v_max3_f32 v30, v30, v98, v99
    v_max3_f32 v30, v30, v100, v101
    v_max3_f32 v30, v30, v102, v103
    v_max3_f32 v30, v30, v104, v105
    v_max3_f32 v30, v30, v106, v107
    v_max3_f32 v30, v30, v108, v109
    v_max3_f32 v30, v30, v110, v111
    v_mov_b32 v31, v30
    s_nop 1
    v_permlane32_swap_b32 v31, v30
    v_max_f32 v30, v30, v31
    ds_write_b32 v44, v30
    s_waitcnt vmcnt(0)
    s_waitcnt lgkmcnt(0)
    s_barrier
    ds_read_b32 v31, v45
    ds_read_b128 a[40:43], v28 offset:32768
    ds_read_b128 a[44:47], v28 offset:33792
    ds_read_b128 a[48:51], v28 offset:34816
    ds_read_b128 a[52:55], v28 offset:35840
    ds_read_b128 a[56:59], v28 offset:36864
    ds_read_b128 a[60:63], v28 offset:37888
    ds_read_b128 a[64:67], v28 offset:38912
    ds_read_b128 a[68:71], v28 offset:39936
    s_waitcnt lgkmcnt(8)
    v_max_f32 v30, v30, v31
    v_sub_f32 v112, 0, v30
    v_sub_f32 v113, 0, v30
    v_sub_f32 v114, 0, v30
    v_sub_f32 v115, 0, v30
    v_sub_f32 v116, 0, v30
    v_sub_f32 v117, 0, v30
    v_sub_f32 v118, 0, v30
    v_sub_f32 v119, 0, v30
    v_sub_f32 v120, 0, v30
    v_sub_f32 v121, 0, v30
    v_sub_f32 v122, 0, v30
    v_sub_f32 v123, 0, v30
    v_sub_f32 v124, 0, v30
    v_sub_f32 v125, 0, v30
    v_sub_f32 v126, 0, v30
    v_sub_f32 v127, 0, v30
    s_nop 1
    v_mfma_f32_32x32x16_bf16 v[48:63], a[0:3], v[20:23], v[112:127]
    v_mfma_f32_32x32x16_bf16 v[48:63], a[4:7], v[24:27], v[48:63]
    v_mfma_f32_32x32x16_bf16 v[64:79], a[8:11], v[20:23], v[112:127]
    v_mfma_f32_32x32x16_bf16 v[64:79], a[12:15], v[24:27], v[64:79]
    v_mfma_f32_32x32x16_bf16 v[80:95], a[16:19], v[20:23], v[112:127]
    v_mfma_f32_32x32x16_bf16 v[80:95], a[20:23], v[24:27], v[80:95]
    v_mfma_f32_32x32x16_bf16 v[96:111], a[24:27], v[20:23], v[112:127]
    v_mfma_f32_32x32x16_bf16 v[96:111], a[28:31], v[24:27], v[96:111]
    s_nop 5
    v_exp_f32 v48, v48
    v_exp_f32 v49, v49
    v_exp_f32 v50, v50
    v_exp_f32 v51, v51
    v_exp_f32 v52, v52
    v_exp_f32 v53, v53
    v_exp_f32 v54, v54
    v_exp_f32 v55, v55
    v_exp_f32 v56, v56
    v_exp_f32 v57, v57
    v_exp_f32 v58, v58
    v_exp_f32 v59, v59
    v_exp_f32 v60, v60
    v_exp_f32 v61, v61
    v_exp_f32 v62, v62
    v_exp_f32 v63, v63
    v_cvt_pk_bf16_f32 v144, v48, v49
    v_cvt_pk_bf16_f32 v145, v50, v51
    v_cvt_pk_bf16_f32 v146, v52, v53
    v_cvt_pk_bf16_f32 v147, v54, v55
    v_cvt_pk_bf16_f32 v148, v56, v57
    v_cvt_pk_bf16_f32 v149, v58, v59
    v_cvt_pk_bf16_f32 v150, v60, v61
    v_cvt_pk_bf16_f32 v151, v62, v63
    s_waitcnt lgkmcnt(7)
    v_mfma_f32_32x32x16_bf16 v[128:143], a[40:43], v[144:147], 0
    s_waitcnt lgkmcnt(6)
    v_mfma_f32_32x32x16_bf16 v[128:143], a[44:47], v[148:151], v[128:143]
    v_exp_f32 v64, v64
    v_exp_f32 v65, v65
    v_exp_f32 v66, v66
    v_exp_f32 v67, v67
    v_exp_f32 v68, v68
    v_exp_f32 v69, v69
    v_exp_f32 v70, v70
    v_exp_f32 v71, v71
    v_exp_f32 v72, v72
    v_exp_f32 v73, v73
    v_exp_f32 v74, v74
    v_exp_f32 v75, v75
    v_exp_f32 v76, v76
    v_exp_f32 v77, v77
    v_exp_f32 v78, v78
    v_exp_f32 v79, v79
    v_cvt_pk_bf16_f32 v152, v64, v65
    v_cvt_pk_bf16_f32 v153, v66, v67
    v_cvt_pk_bf16_f32 v154, v68, v69
    v_cvt_pk_bf16_f32 v155, v70, v71
    v_cvt_pk_bf16_f32 v156, v72, v73
    v_cvt_pk_bf16_f32 v157, v74, v75
    v_cvt_pk_bf16_f32 v158, v76, v77
    v_cvt_pk_bf16_f32 v159, v78, v79
    s_waitcnt lgkmcnt(5)
    v_mfma_f32_32x32x16_bf16 v[128:143], a[48:51], v[152:155], v[128:143]
    s_waitcnt lgkmcnt(4)
    v_mfma_f32_32x32x16_bf16 v[128:143], a[52:55], v[156:159], v[128:143]
    v_exp_f32 v80, v80
    v_exp_f32 v81, v81
    v_exp_f32 v82, v82
    v_exp_f32 v83, v83
    v_exp_f32 v84, v84
    v_exp_f32 v85, v85
    v_exp_f32 v86, v86
    v_exp_f32 v87, v87
    v_exp_f32 v88, v88
    v_exp_f32 v89, v89
    v_exp_f32 v90, v90
    v_exp_f32 v91, v91
    v_exp_f32 v92, v92
    v_exp_f32 v93, v93
    v_exp_f32 v94, v94
    v_exp_f32 v95, v95
    v_cvt_pk_bf16_f32 v160, v80, v81
    v_cvt_pk_bf16_f32 v161, v82, v83
    v_cvt_pk_bf16_f32 v162, v84, v85
    v_cvt_pk_bf16_f32 v163, v86, v87
    v_cvt_pk_bf16_f32 v164, v88, v89
    v_cvt_pk_bf16_f32 v165, v90, v91
    v_cvt_pk_bf16_f32 v166, v92, v93
    v_cvt_pk_bf16_f32 v167, v94, v95
    s_waitcnt lgkmcnt(3)
    v_mfma_f32_32x32x16_bf16 v[128:143], a[56:59], v[160:163], v[128:143]
    s_waitcnt lgkmcnt(2)
    v_mfma_f32_32x32x16_bf16 v[128:143], a[60:63], v[164:167], v[128:143]
    v_exp_f32 v96, v96
    v_exp_f32 v97, v97
    v_exp_f32 v98, v98
    v_exp_f32 v99, v99
    v_exp_f32 v100, v100
    v_exp_f32 v101, v101
    v_exp_f32 v102, v102
    v_exp_f32 v103, v103
    v_exp_f32 v104, v104
    v_exp_f32 v105, v105
    v_exp_f32 v106, v106
    v_exp_f32 v107, v107
    v_exp_f32 v108, v108
    v_exp_f32 v109, v109
    v_exp_f32 v110, v110
    v_exp_f32 v111, v111
    v_cvt_pk_bf16_f32 v144, v96, v97
    v_cvt_pk_bf16_f32 v145, v98, v99
    v_cvt_pk_bf16_f32 v146, v100, v101
    v_cvt_pk_bf16_f32 v147, v102, v103
    v_cvt_pk_bf16_f32 v148, v104, v105
    v_cvt_pk_bf16_f32 v149, v106, v107
    v_cvt_pk_bf16_f32 v150, v108, v109
    v_cvt_pk_bf16_f32 v151, v110, v111
    s_waitcnt lgkmcnt(1)
    v_mfma_f32_32x32x16_bf16 v[128:143], a[64:67], v[144:147], v[128:143]
    s_waitcnt lgkmcnt(0)
    v_mfma_f32_32x32x16_bf16 v[128:143], a[68:71], v[148:151], v[128:143]
    s_nop 11
    ds_write_b128 v44, v[128:131] offset:1024
    ds_write_b128 v44, v[132:135] offset:2048
    ds_write_b32 v44, v140 offset:3072
    s_waitcnt lgkmcnt(0)
    s_barrier
    ds_read_b128 v[144:147], v45 offset:1024
    ds_read_b128 v[148:151], v45 offset:2048
    ds_read_b32 v32, v45 offset:3072
    s_waitcnt lgkmcnt(0)
    v_add_f32 v32, v32, v140
    v_mov_b32 v33, v32
    s_nop 1
    v_permlane32_swap_b32 v33, v32
    v_rcp_f32 v33, v32
    v_add_f32 v136, v136, v144
    v_mul_f32 v136, v136, v33
    v_add_f32 v137, v137, v145
    v_mul_f32 v137, v137, v33
    v_add_f32 v138, v138, v146
    v_mul_f32 v138, v138, v33
    v_add_f32 v139, v139, v147
    v_mul_f32 v139, v139, v33
    v_add_f32 v140, v140, v148
    v_mul_f32 v140, v140, v33
    v_add_f32 v141, v141, v149
    v_mul_f32 v141, v141, v33
    v_add_f32 v142, v142, v150
    v_mul_f32 v142, v142, v33
    v_add_f32 v143, v143, v151
    v_mul_f32 v143, v143, v33
    v_cvt_pk_bf16_f32 v152, v136, v137
    v_cvt_pk_bf16_f32 v153, v138, v139
    v_cvt_pk_bf16_f32 v154, v140, v141
    v_cvt_pk_bf16_f32 v155, v142, v143
    v_cmp_eq_u32 vcc, 0, v5
    s_nop 1
    v_cndmask_b32 v154, 0, v154, vcc
    v_cndmask_b32 v155, 0, v155, vcc
    s_lshl_b32 s37, s23, 2
    s_add_u32 s37, s37, s38
    s_lshl_b32 s37, s37, 15
    s_lshl_b32 s36, s24, 10
    s_add_u32 s37, s37, s36
    v_bfe_u32 v35, v1, 4, 1
    v_lshlrev_b32 v35, 14, v35
    v_and_b32 v36, 15, v1
    v_lshl_add_u32 v35, v36, 4, v35
    v_lshl_add_u32 v35, v5, 8, v35
    buffer_store_dwordx4 v[152:155], v35, s[16:19], s37 offen offset:512 sc0 sc1
L_pk2b_done:
    s_nop 1
    s_lshl_b32 s34, s23, 7
    s_add_u32 s34, s34, 0x100d000
    s_waitcnt vmcnt(0) lgkmcnt(0)
    s_barrier
    v_mov_b32 v10, 0
    v_mov_b32 v11, 1
    v_cmp_eq_u32 vcc, 0, v0
    s_and_saveexec_b64 s[44:45], vcc
    s_cbranch_execz L_pub16
    buffer_atomic_add v11, v10, s[92:95], s34 offen sc1
L_pub16:
    s_mov_b64 exec, -1
    s_nop 1
    s_cmp_ge_u32 s2, 224
    s_cbranch_scc1 L_pk3b_idle
    s_load_dwordx2 s[20:21], s[0:1], 80
    s_load_dwordx2 s[8:9], s[0:1], 16
    s_load_dwordx2 s[48:49], s[0:1], 32
    v_and_b32 v1, 63, v0
    v_lshrrev_b32 v2, 6, v0
    s_nop 0
    v_readfirstlane_b32 s22, v2
    s_lshr_b32 s23, s2, 5
    s_and_b32 s24, s2, 31
    v_lshlrev_b32 v2, 4, v1
    v_lshrrev_b32 v3, 3, v1
    v_bfe_u32 v4, v1, 4, 2
    v_lshlrev_b32 v4, 1, v4
    v_and_b32 v5, 7, v1
    v_xor_b32 v4, v4, v5
    v_mul_u32_u24 v5, 896, v3
    v_lshl_add_u32 v5, v4, 4, v5
    s_lshl_b32 s25, s23, 7
    v_add_u32 v5, s25, v5
    s_waitcnt lgkmcnt(0)
    s_add_u32 s4, s20, 0x2600000
    s_addc_u32 s5, s21, 0
    s_and_b32 s5, s5, 0xffff
    s_mov_b32 s6, 0x200000
    s_mov_b32 s7, 0x00020000
    s_and_b32 s9, s9, 0xffff
    s_mov_b32 s10, 0x62000
    s_mov_b32 s11, 0x00020000
    s_add_u32 s12, s20, 0xe00000
    s_addc_u32 s13, s21, 0
    s_and_b32 s13, s13, 0xffff
    s_mov_b32 s14, 0x1c0000
    s_mov_b32 s15, 0x00020000
    s_mov_b32 s16, s20
    s_and_b32 s17, s21, 0xffff
    s_mov_b32 s18, 0x4000000
    s_mov_b32 s19, 0x00020000
    s_mul_i32 s30, s22, 7168
    s_lshl_b32 s32, s22, 10
    s_add_u32 m0, s32, 65536
    s_add_u32 s31, s30, 0
    buffer_load_dwordx4 v5, s[8:11], s31 offen sc1 lds
    s_add_u32 m0, s32, 73728
    s_add_u32 s31, s30, 57344
    buffer_load_dwordx4 v5, s[8:11], s31 offen sc1 lds
    s_add_u32 m0, s32, 81920
    s_add_u32 s31, s30, 114688
    buffer_load_dwordx4 v5, s[8:11], s31 offen sc1 lds
    s_add_u32 m0, s32, 90112
    s_add_u32 s31, s30, 172032
    buffer_load_dwordx4 v5, s[8:11], s31 offen sc1 lds
    s_add_u32 m0, s32, 98304
    s_add_u32 s31, s30, 229376
    buffer_load_dwordx4 v5, s[8:11], s31 offen sc1 lds
    s_add_u32 m0, s32, 106496
    s_add_u32 s31, s30, 286720
    buffer_load_dwordx4 v5, s[8:11], s31 offen sc1 lds
    s_add_u32 m0, s32, 114688
    s_add_u32 s31, s30, 344064
    buffer_load_dwordx4 v5, s[8:11], s31 offen sc1 lds
    s_lshr_b32 s34, s24, 1
    s_lshl_b32 s34, s34, 7
    s_add_u32 s34, s34, 0x100d000
    v_mov_b32 v10, 0
    s_cmp_lg_u32 s22, 0
    s_cbranch_scc1 L_aww17
    s_mov_b64 exec, 0x1
    s_mov_b32 s45, 0x40000
L_awp17:
    buffer_load_dword v168, v10, s[16:19], s34 offen sc0 sc1
    s_waitcnt vmcnt(0)
    v_cmp_gt_u32 vcc, 16, v168
    s_cbranch_vccz L_awd17
    s_sub_u32 s45, s45, 1
    s_cmp_lg_u32 s45, 0
    s_cbranch_scc1 L_awp17
L_awd17:
    s_mov_b64 exec, -1
L_aww17:
    s_nop 0
    s_barrier
    s_lshl_b32 s32, s22, 13
    s_lshl_b32 s29, s24, 16
    s_add_u32 s30, s29, s32
    s_add_u32 m0, s32, 0
    s_add_u32 s31, s30, 0
    buffer_load_dwordx4 v2, s[4:7], s31 offen sc1 lds
    s_add_u32 m0, s32, 1024
    s_add_u32 s31, s30, 1024
    buffer_load_dwordx4 v2, s[4:7], s31 offen sc1 lds
    s_barrier
    s_add_u32 m0, s32, 2048
    s_add_u32 s31, s30, 2048
    buffer_load_dwordx4 v2, s[4:7], s31 offen sc1 lds
    s_add_u32 m0, s32, 3072
    s_add_u32 s31, s30, 3072
    buffer_load_dwordx4 v2, s[4:7], s31 offen sc1 lds
    s_add_u32 m0, s32, 4096
    s_add_u32 s31, s30, 4096
    buffer_load_dwordx4 v2, s[4:7], s31 offen sc1 lds
    s_add_u32 m0, s32, 5120
    s_add_u32 s31, s30, 5120
    buffer_load_dwordx4 v2, s[4:7], s31 offen sc1 lds
    s_add_u32 m0, s32, 6144
    s_add_u32 s31, s30, 6144
    buffer_load_dwordx4 v2, s[4:7], s31 offen sc1 lds
    s_add_u32 m0, s32, 7168
    s_add_u32 s31, s30, 7168
    buffer_load_dwordx4 v2, s[4:7], s31 offen sc1 lds
    s_lshl_b32 s35, s22, 10
    s_add_u32 m0, s35, 122880
    s_and_b32 s34, s22, 1
    s_lshl_b32 s34, s34, 3
    v_add_u32 v20, s34, v3
    v_lshlrev_b32 v21, 6, v20
    v_mul_u32_u24 v22, 48, v20
    v_add_u32 v22, 960, v22
    s_lshl_b32 s34, s23, 3
    v_add_u32 v12, s34, v4
    v_mul_u32_u24 v13, 37, v12
    v_lshrrev_b32 v13, 8, v13
    v_mul_u32_u24 v14, 7, v13
    v_sub_u32 v12, v12, v14
    v_cmp_lt_u32 vcc, 3, v12
    v_lshlrev_b32 v12, 4, v12
    s_nop 0
    v_cndmask_b32 v14, v21, v22, vcc
    v_add_u32 v12, v12, v14
    v_mul_u32_u24 v13, 1792, v13
    v_add_u32 v23, v12, v13
    s_lshl_b32 s34, s24, 2
    s_lshr_b32 s35, s22, 1
    s_add_u32 s34, s34, s35
    s_mul_i32 s34, s34, 14336
    buffer_load_dwordx4 v23, s[12:15], s34 offen sc1 lds
    s_and_b32 s33, s22, 1
    s_lshr_b32 s34, s22, 1
    s_lshl_b32 s35, s33, 15
    v_add_u32 v6, s35, v2
    v_lshrrev_b32 v7, 4, v1
    v_bfe_u32 v8, v1, 2, 2
    v_and_b32 v9, 3, v1
    v_lshrrev_b32 v10, 1, v7
    v_and_b32 v11, 1, v7
    v_lshlrev_b32 v12, 4, v10
    v_lshl_add_u32 v12, v11, 2, v12
    v_add_u32 v12, v12, v8
    v_lshlrev_b32 v12, 7, v12
    v_lshl_add_u32 v12, v9, 3, v12
    v_lshrrev_b32 v13, 1, v8
    v_lshl_add_u32 v13, v11, 1, v13
    v_xor_b32 v14, s34, v13
    v_lshl_add_u32 v16, v14, 5, v12
    v_add_u32 v16, 65536, v16
    v_add_u32 v13, 2, v13
    v_and_b32 v13, 3, v13
    v_xor_b32 v14, s34, v13
    v_lshl_add_u32 v17, v14, 5, v12
    v_add_u32 v17, 65536, v17
    v_lshl_add_u32 v14, v7, 2, v8
    v_bfe_u32 v15, v14, 1, 2
    v_lshlrev_b32 v14, 7, v14
    v_lshl_add_u32 v14, v9, 3, v14
    s_lshl_b32 s38, s33, 12
    s_add_u32 s38, s38, 122880
    v_add_u32 v14, s38, v14
    v_xor_b32 v20, s34, v15
    v_lshl_add_u32 v18, v20, 5, v14
    s_waitcnt vmcnt(0)
    s_barrier
    ds_read_b128 v[48:51], v6 offset:0
    ds_read_b128 v[52:55], v6 offset:16384
    ds_read_b64_tr_b16 v[72:73], v16 offset:0
    ds_read_b64_tr_b16 v[74:75], v16 offset:1024
    ds_read_b128 v[56:59], v6 offset:1024
    ds_read_b128 v[60:63], v6 offset:17408
    ds_read_b64_tr_b16 v[76:77], v17 offset:3584
    ds_read_b64_tr_b16 v[78:79], v17 offset:4608
    ds_read_b128 v[64:67], v6 offset:2048
    ds_read_b128 v[68:71], v6 offset:18432
    ds_read_b64_tr_b16 v[80:81], v16 offset:7168
    ds_read_b64_tr_b16 v[82:83], v16 offset:8192
    s_waitcnt lgkmcnt(8)
    v_mfma_f32_16x16x32_bf16 v[32:35], v[48:51], v[72:75], 0
    v_mfma_f32_16x16x32_bf16 v[36:39], v[52:55], v[72:75], 0
    ds_read_b128 v[48:51], v6 offset:3072
    ds_read_b128 v[52:55], v6 offset:19456
    ds_read_b64_tr_b16 v[72:73], v17 offset:10752
    ds_read_b64_tr_b16 v[74:75], v17 offset:11776
    s_waitcnt lgkmcnt(8)
    v_mfma_f32_16x16x32_bf16 v[32:35], v[56:59], v[76:79], v[32:35]
    v_mfma_f32_16x16x32_bf16 v[36:39], v[60:63], v[76:79], v[36:39]
    ds_read_b128 v[56:59], v6 offset:4096
    ds_read_b128 v[60:63], v6 offset:20480
    ds_read_b64_tr_b16 v[76:77], v16 offset:14336
    ds_read_b64_tr_b16 v[78:79], v16 offset:15360
    s_waitcnt lgkmcnt(8)
    v_mfma_f32_16x16x32_bf16 v[32:35], v[64:67], v[80:83], v[32:35]
    v_mfma_f32_16x16x32_bf16 v[36:39], v[68:71], v[80:83], v[36:39]
    ds_read_b128 v[64:67], v6 offset:5120
    ds_read_b128 v[68:71], v6 offset:21504
    ds_read_b64_tr_b16 v[80:81], v17 offset:17920
    ds_read_b64_tr_b16 v[82:83], v17 offset:18944
    s_waitcnt lgkmcnt(8)
    v_mfma_f32_16x16x32_bf16 v[32:35], v[48:51], v[72:75], v[32:35]
    v_mfma_f32_16x16x32_bf16 v[36:39], v[52:55], v[72:75], v[36:39]
    ds_read_b128 v[48:51], v6 offset:6144
    ds_read_b128 v[52:55], v6 offset:22528
    ds_read_b64_tr_b16 v[72:73], v16 offset:21504
    ds_read_b64_tr_b16 v[74:75], v16 offset:22528
    s_waitcnt lgkmcnt(8)
    v_mfma_f32_16x16x32_bf16 v[32:35], v[56:59], v[76:79], v[32:35]
    v_mfma_f32_16x16x32_bf16 v[36:39], v[60:63], v[76:79], v[36:39]
    ds_read_b128 v[56:59], v6 offset:7168
    ds_read_b128 v[60:63], v6 offset:23552
    ds_read_b64_tr_b16 v[76:77], v17 offset:25088
    ds_read_b64_tr_b16 v[78:79], v17 offset:26112
    s_waitcnt lgkmcnt(8)
    v_mfma_f32_16x16x32_bf16 v[32:35], v[64:67], v[80:83], v[32:35]
    v_mfma_f32_16x16x32_bf16 v[36:39], v[68:71], v[80:83], v[36:39]
    ds_read_b128 v[64:67], v6 offset:8192
    ds_read_b128 v[68:71], v6 offset:24576
    ds_read_b64_tr_b16 v[80:81], v16 offset:28672
    ds_read_b64_tr_b16 v[82:83], v16 offset:29696
    s_waitcnt lgkmcnt(8)
    v_mfma_f32_16x16x32_bf16 v[32:35], v[48:51], v[72:75], v[32:35]
    v_mfma_f32_16x16x32_bf16 v[36:39], v[52:55], v[72:75], v[36:39]
    ds_read_b128 v[48:51], v6 offset:9216
    ds_read_b128 v[52:55], v6 offset:25600
    ds_read_b64_tr_b16 v[72:73], v17 offset:32256
    ds_read_b64_tr_b16 v[74:75], v17 offset:33280
    s_waitcnt lgkmcnt(8)
    v_mfma_f32_16x16x32_bf16 v[32:35], v[56:59], v[76:79], v[32:35]
    v_mfma_f32_16x16x32_bf16 v[36:39], v[60:63], v[76:79], v[36:39]
    ds_read_b128 v[56:59], v6 offset:10240
    ds_read_b128 v[60:63], v6 offset:26624
    ds_read_b64_tr_b16 v[76:77], v16 offset:35840
    ds_read_b64_tr_b16 v[78:79], v16 offset:36864
    s_waitcnt lgkmcnt(8)
    v_mfma_f32_16x16x32_bf16 v[32:35], v[64:67], v[80:83], v[32:35]
    v_mfma_f32_16x16x32_bf16 v[36:39], v[68:71], v[80:83], v[36:39]
    ds_read_b128 v[64:67], v6 offset:11264
    ds_read_b128 v[68:71], v6 offset:27648
    ds_read_b64_tr_b16 v[80:81], v17 offset:39424
    ds_read_b64_tr_b16 v[82:83], v17 offset:40448
    s_waitcnt lgkmcnt(8)
    v_mfma_f32_16x16x32_bf16 v[32:35], v[48:51], v[72:75], v[32:35]
    v_mfma_f32_16x16x32_bf16 v[36:39], v[52:55], v[72:75], v[36:39]
    ds_read_b128 v[48:51], v6 offset:12288
    ds_read_b128 v[52:55], v6 offset:28672
    ds_read_b64_tr_b16 v[72:73], v16 offset:43008
    ds_read_b64_tr_b16 v[74:75], v16 offset:44032
    s_waitcnt lgkmcnt(8)
    v_mfma_f32_16x16x32_bf16 v[32:35], v[56:59], v[76:79], v[32:35]
    v_mfma_f32_16x16x32_bf16 v[36:39], v[60:63], v[76:79], v[36:39]
    ds_read_b128 v[56:59], v6 offset:13312
    ds_read_b128 v[60:63], v6 offset:29696
    ds_read_b64_tr_b16 v[76:77], v17 offset:46592
    ds_read_b64_tr_b16 v[78:79], v17 offset:47616
    s_waitcnt lgkmcnt(8)
    v_mfma_f32_16x16x32_bf16 v[32:35], v[64:67], v[80:83], v[32:35]
    v_mfma_f32_16x16x32_bf16 v[36:39], v[68:71], v[80:83], v[36:39]
    ds_read_b128 v[64:67], v6 offset:14336
    ds_read_b128 v[68:71], v6 offset:30720
    ds_read_b64_tr_b16 v[80:81], v16 offset:50176
    ds_read_b64_tr_b16 v[82:83], v16 offset:51200
    s_waitcnt lgkmcnt(8)
    v_mfma_f32_16x16x32_bf16 v[32:35], v[48:51], v[72:75], v[32:35]
    v_mfma_f32_16x16x32_bf16 v[36:39], v[52:55], v[72:75], v[36:39]
    ds_read_b128 v[48:51], v6 offset:15360
    ds_read_b128 v[52:55], v6 offset:31744
    ds_read_b64_tr_b16 v[72:73], v17 offset:53760
    ds_read_b64_tr_b16 v[74:75], v17 offset:54784
    ds_read_b64_tr_b16 v[96:97], v18 offset:0
    ds_read_b64_tr_b16 v[98:99], v18 offset:2048
    s_waitcnt lgkmcnt(10)
    v_mfma_f32_16x16x32_bf16 v[32:35], v[56:59], v[76:79], v[32:35]
    v_mfma_f32_16x16x32_bf16 v[36:39], v[60:63], v[76:79], v[36:39]
    s_waitcnt lgkmcnt(6)
    v_mfma_f32_16x16x32_bf16 v[32:35], v[64:67], v[80:83], v[32:35]
    v_mfma_f32_16x16x32_bf16 v[36:39], v[68:71], v[80:83], v[36:39]
    s_waitcnt lgkmcnt(2)
    v_mfma_f32_16x16x32_bf16 v[32:35], v[48:51], v[72:75], v[32:35]
    v_mfma_f32_16x16x32_bf16 v[36:39], v[52:55], v[72:75], v[36:39]
    s_waitcnt lgkmcnt(1)
    v_lshlrev_b32 v104, 16, v96
    v_and_b32 v105, 0xffff0000, v96
    s_nop 3
    v_add_f32 v32, v32, v104
    v_add_f32 v33, v33, v105
    v_cvt_pk_bf16_f32 v112, v32, v33
    v_lshlrev_b32 v104, 16, v97
    v_and_b32 v105, 0xffff0000, v97
    v_add_f32 v34, v34, v104
    v_add_f32 v35, v35, v105
    v_cvt_pk_bf16_f32 v113, v34, v35
    s_waitcnt lgkmcnt(0)
    v_lshlrev_b32 v104, 16, v98
    v_and_b32 v105, 0xffff0000, v98
    v_add_f32 v36, v36, v104
    v_add_f32 v37, v37, v105
    v_cvt_pk_bf16_f32 v114, v36, v37
    v_lshlrev_b32 v104, 16, v99
    v_and_b32 v105, 0xffff0000, v99
    v_add_f32 v38, v38, v104
    v_add_f32 v39, v39, v105
    v_cvt_pk_bf16_f32 v115, v38, v39
    s_lshl_b32 s39, s24, 1
    s_add_u32 s39, s39, s33
    s_mul_i32 s39, s39, 28672
    s_lshl_b32 s40, s23, 3
    s_lshl_b32 s41, s34, 1
    s_add_u32 s40, s40, s41
    s_lshl_b32 s40, s40, 9
    s_add_u32 s39, s39, s40
    s_add_u32 s39, s39, 0x2a00000
    v_bfe_u32 v21, v1, 3, 1
    v_lshlrev_b32 v21, 9, v21
    v_lshl_add_u32 v21, v7, 7, v21
    v_and_b32 v22, 7, v1
    v_lshl_add_u32 v21, v22, 4, v21
    buffer_store_dwordx4 v[112:115], v21, s[16:19], s39 offen sc0 sc1
    v_and_b32 v22, 15, v1
    v_mul_u32_u24 v23, 136, v22
    v_lshl_add_u32 v23, v7, 3, v23
    s_mul_i32 s41, s34, 2176
    s_lshl_b32 s42, s33, 6
    s_add_u32 s41, s41, s42
    s_add_u32 s41, s41, 131072
    v_add_u32 v23, s41, v23
    ds_write_b64 v23, v[112:113] offset:0
    ds_write_b64 v23, v[114:115] offset:32
    v_lshl_add_u32 v24, v7, 2, v8
    v_mul_u32_u24 v24, 136, v24
    v_lshl_add_u32 v24, v9, 3, v24
    v_add_u32 v24, s41, v24
    ds_read_b64_tr_b16 v[120:121], v24 offset:0
    ds_read_b64_tr_b16 v[122:123], v24 offset:32
    s_lshl_b32 s42, s24, 2
    s_lshl_b32 s43, s33, 1
    s_add_u32 s42, s42, s43
    s_mul_i32 s43, s42, 14336
    s_lshl_b32 s44, s23, 4
    s_lshl_b32 s45, s34, 2
    s_add_u32 s44, s44, s45
    s_lshl_b32 s44, s44, 7
    s_add_u32 s43, s43, s44
    s_add_u32 s43, s43, 0x2800000
    v_lshlrev_b32 v25, 7, v7
    v_lshl_add_u32 v25, v22, 3, v25
    v_mov_b32 v26, 0x3f803f80
    v_mov_b32 v28, 0
    v_mov_b32 v29, 0
    v_mov_b32 v30, 0
    v_mov_b32 v31, 0
    s_add_u32 s44, s43, 0
    s_waitcnt lgkmcnt(1)
    buffer_store_dwordx2 v[120:121], v25, s[16:19], s44 offen sc0 sc1
    v_dot2_f32_bf16 v28, v120, v26, v28
    v_dot2_f32_bf16 v29, v120, v120, v29
    v_dot2_f32_bf16 v28, v121, v26, v28
    v_dot2_f32_bf16 v29, v121, v121, v29
    s_add_u32 s44, s43, 14336
    s_waitcnt lgkmcnt(0)
    buffer_store_dwordx2 v[122:123], v25, s[16:19], s44 offen sc0 sc1
    v_dot2_f32_bf16 v30, v122, v26, v30
    v_dot2_f32_bf16 v31, v122, v122, v31
    v_dot2_f32_bf16 v30, v123, v26, v30
    v_dot2_f32_bf16 v31, v123, v123, v31
    v_cmp_gt_u32 vcc, 16, v1
    v_lshlrev_b32 v27, 2, v1
    s_lshl_b32 s44, s42, 7
    s_add_u32 s44, s44, 0x1008000
    v_mov_b32 v104, v28
    s_nop 1
    v_permlane16_swap_b32 v104, v28
    v_add_f32 v28, v28, v104
    v_mov_b32 v104, v28
    s_nop 1
    v_permlane32_swap_b32 v104, v28
    v_add_f32 v28, v28, v104
    v_mov_b32 v105, v29
    s_nop 1
    v_permlane16_swap_b32 v105, v29
    v_add_f32 v29, v29, v105
    v_mov_b32 v105, v29
    s_nop 1
    v_permlane32_swap_b32 v105, v29
    v_add_f32 v29, v29, v105
    v_cndmask_b32 v106, v29, v28, vcc
    v_mov_b32 v104, v30
    s_nop 1
    v_permlane16_swap_b32 v104, v30
    v_add_f32 v30, v30, v104
    v_mov_b32 v104, v30
    s_nop 1
    v_permlane32_swap_b32 v104, v30
    v_add_f32 v30, v30, v104
    v_mov_b32 v105, v31
    s_nop 1
    v_permlane16_swap_b32 v105, v31
    v_add_f32 v31, v31, v105
    v_mov_b32 v105, v31
    s_nop 1
    v_permlane32_swap_b32 v105, v31
    v_add_f32 v31, v31, v105
    v_cndmask_b32 v107, v31, v30, vcc
    s_mov_b64 exec, 0xffffffff
    buffer_atomic_add_f32 v106, v27, s[16:19], s44 offen
    buffer_atomic_add_f32 v107, v27, s[16:19], s44 offen offset:128
    s_mov_b64 exec, -1
    s_and_b32 s34, s2, 7
    s_lshl_b32 s34, s34, 7
    s_add_u32 s34, s34, 0x100dc00
    s_waitcnt vmcnt(0) lgkmcnt(0)
    s_barrier
    v_mov_b32 v10, 0
    v_mov_b32 v11, 1
    v_cmp_eq_u32 vcc, 0, v0
    s_and_saveexec_b64 s[44:45], vcc
    s_cbranch_execz L_pub18
    buffer_atomic_add v11, v10, s[16:19], s34 offen sc1
L_pub18:
    s_mov_b64 exec, -1
L_pk3b_skip:
    s_nop 1
    s_cmp_ge_u32 s2, 224
    s_cbranch_scc1 L_pg1b_skip
    s_load_dwordx2 s[20:21], s[0:1], 80
    s_load_dwordx2 s[4:5], s[0:1], 32
    s_load_dwordx2 s[12:13], s[0:1], 40
    s_load_dwordx2 s[92:93], s[0:1], 48
    v_and_b32 v1, 63, v0
    v_lshrrev_b32 v2, 6, v0
    s_nop 0
    v_readfirstlane_b32 s22, v2
    s_and_b32 s25, s2, 7
    s_lshr_b32 s26, s2, 3
    s_and_b32 s24, s25, 1
    s_lshl_b32 s24, s24, 2
    s_and_b32 s27, s26, 3
    s_add_u32 s24, s24, s27
    s_lshr_b32 s23, s25, 1
    s_mul_i32 s23, s23, 7
    s_lshr_b32 s27, s26, 2
    s_add_u32 s23, s23, s27
    s_and_b32 s47, s22, 3
    s_lshr_b32 s48, s22, 2
    v_lshrrev_b32 v3, 3, v1
    v_bfe_u32 v4, v1, 4, 2
    v_lshlrev_b32 v4, 1, v4
    v_and_b32 v5, 7, v1
    v_xor_b32 v4, v4, v5
    v_mul_u32_u24 v5, 3584, v3
    v_lshl_add_u32 v5, v4, 4, v5
    s_mul_i32 s27, s47, 1835008
    s_mul_i32 s28, s48, 57344
    s_add_u32 s27, s27, s28
    s_lshl_b32 s28, s23, 7
    s_add_u32 s27, s27, s28
    v_add_u32 v5, s27, v5
    v_lshrrev_b32 v7, 4, v1
    v_and_b32 v8, 7, v1
    v_lshlrev_b32 v8, 4, v8
    v_lshl_add_u32 v8, v7, 7, v8
    v_bfe_u32 v9, v1, 3, 1
    v_lshl_add_u32 v6, v9, 9, v8
    s_cmp_eq_u32 s48, 0
    s_cselect_b64 s[50:51], -1, 0
    v_cndmask_b32 v9, v8, v6, s[50:51]
    s_waitcnt lgkmcnt(0)
    s_and_b32 s5, s5, 0xffff
    s_mov_b32 s6, 0x700000
    s_mov_b32 s7, 0x00020000
    s_mov_b32 s8, s20
    s_and_b32 s9, s21, 0xffff
    s_mov_b32 s10, 0x4000000
    s_mov_b32 s11, 0x00020000
    s_and_b32 s13, s13, 0xffff
    s_mov_b32 s14, 0xe00
    s_mov_b32 s15, 0x00020000
    s_mul_i32 s29, s47, 458752
    s_mul_i32 s30, s24, 3584
    s_add_u32 s29, s29, s30
    s_add_u32 s29, s29, 0x2a00000
    s_lshl_b32 s30, s48, 11
    s_add_u32 s29, s29, s30
    s_mul_i32 s31, s47, 36864
    s_lshl_b32 s30, s48, 11
    s_add_u32 s49, s31, s30
    v_add_u32 v4, 27648, v5
    s_add_u32 m0, s49, 0
    s_mov_b32 s32, 0
    buffer_load_dwordx4 v5, s[4:7], s32 offen sc1 lds
    buffer_load_dwordx4 v4, s[4:7], s32 offen offset:1024 sc1 lds
    s_add_u32 m0, s49, 4096
    s_mov_b32 s32, 114688
    buffer_load_dwordx4 v5, s[4:7], s32 offen sc1 lds
    buffer_load_dwordx4 v4, s[4:7], s32 offen offset:1024 sc1 lds
    s_add_u32 m0, s49, 8192
    s_mov_b32 s32, 229376
    buffer_load_dwordx4 v5, s[4:7], s32 offen sc1 lds
    buffer_load_dwordx4 v4, s[4:7], s32 offen offset:1024 sc1 lds
    s_add_u32 m0, s49, 12288
    s_mov_b32 s32, 344064
    buffer_load_dwordx4 v5, s[4:7], s32 offen sc1 lds
    buffer_load_dwordx4 v4, s[4:7], s32 offen offset:1024 sc1 lds
    s_add_u32 m0, s49, 16384
    s_mov_b32 s32, 458752
    buffer_load_dwordx4 v5, s[4:7], s32 offen sc1 lds
    buffer_load_dwordx4 v4, s[4:7], s32 offen offset:1024 sc1 lds
    s_add_u32 m0, s49, 20480
    s_mov_b32 s32, 573440
    buffer_load_dwordx4 v5, s[4:7], s32 offen sc1 lds
    buffer_load_dwordx4 v4, s[4:7], s32 offen offset:1024 sc1 lds
    s_add_u32 m0, s49, 24576
    s_mov_b32 s32, 688128
    buffer_load_dwordx4 v5, s[4:7], s32 offen sc1 lds
    buffer_load_dwordx4 v4, s[4:7], s32 offen offset:1024 sc1 lds
    s_add_u32 m0, s49, 28672
    s_mov_b32 s32, 802816
    buffer_load_dwordx4 v5, s[4:7], s32 offen sc1 lds
    buffer_load_dwordx4 v4, s[4:7], s32 offen offset:1024 sc1 lds
    s_add_u32 m0, s49, 32768
    s_mov_b32 s32, 917504
    buffer_load_dwordx4 v5, s[4:7], s32 offen sc1 lds
    buffer_load_dwordx4 v4, s[4:7], s32 offen offset:1024 sc1 lds
    s_lshr_b32 s36, s47, 1
    s_lshl_b32 s37, s23, 7
    s_lshl_b32 s38, s36, 6
    s_add_u32 s37, s37, s38
    v_lshlrev_b32 v33, 3, v7
    buffer_load_dwordx2 v[100:101], v33, s[12:15], s37 offen sc1
    buffer_load_dwordx2 v[102:103], v33, s[12:15], s37 offen offset:32 sc1
    s_mov_b32 s34, 0x100dc00
    v_lshlrev_b32 v10, 7, v1
    s_cmp_lg_u32 s22, 0
    s_cbranch_scc1 L_aww19
    s_mov_b64 exec, 0xff
    s_mov_b32 s45, 0x40000
L_awp19:
    buffer_load_dword v168, v10, s[8:11], s34 offen sc0 sc1
    s_waitcnt vmcnt(0)
    v_cmp_gt_u32 vcc, 28, v168
    s_cbranch_vccz L_awd19
    s_sub_u32 s45, s45, 1
    s_cmp_lg_u32 s45, 0
    s_cbranch_scc1 L_awp19
L_awd19:
    s_mov_b64 exec, -1
L_aww19:
    s_nop 0
    s_barrier
    v_lshrrev_b32 v10, 2, v1
    v_lshlrev_b32 v10, 7, v10
    v_and_b32 v11, 3, v1
    v_lshl_add_u32 v10, v11, 4, v10
    s_lshl_b32 s34, s22, 11
    s_add_u32 s34, s34, 0x1008000
    buffer_load_dwordx4 v[16:19], v10, s[8:11], s34 offen sc1
    buffer_load_dwordx4 v[20:23], v10, s[8:11], s34 offen offset:64 sc1
    s_add_u32 s33, s29, 0
    buffer_load_dwordx4 v[112:115], v6, s[8:11], s33 offen sc1
    buffer_load_dwordx4 v[116:119], v9, s[8:11], s33 offen offset:1024 sc1
    s_barrier
    s_add_u32 s33, s29, 28672
    buffer_load_dwordx4 v[120:123], v6, s[8:11], s33 offen sc1
    buffer_load_dwordx4 v[124:127], v9, s[8:11], s33 offen offset:1024 sc1
    s_add_u32 s33, s29, 57344
    buffer_load_dwordx4 v[128:131], v6, s[8:11], s33 offen sc1
    buffer_load_dwordx4 v[132:135], v9, s[8:11], s33 offen offset:1024 sc1
    s_add_u32 s33, s29, 86016
    buffer_load_dwordx4 v[136:139], v6, s[8:11], s33 offen sc1
    buffer_load_dwordx4 v[140:143], v9, s[8:11], s33 offen offset:1024 sc1
    s_add_u32 s33, s29, 114688
    buffer_load_dwordx4 v[144:147], v6, s[8:11], s33 offen sc1
    buffer_load_dwordx4 v[148:151], v9, s[8:11], s33 offen offset:1024 sc1
    s_add_u32 s33, s29, 143360
    buffer_load_dwordx4 v[152:155], v6, s[8:11], s33 offen sc1
    buffer_load_dwordx4 v[156:159], v9, s[8:11], s33 offen offset:1024 sc1
    s_add_u32 s33, s29, 172032
    buffer_load_dwordx4 v[160:163], v6, s[8:11], s33 offen sc1
    buffer_load_dwordx4 v[164:167], v9, s[8:11], s33 offen offset:1024 sc1
    v_bfe_u32 v12, v1, 2, 2
    v_and_b32 v13, 3, v1
    v_and_b32 v14, 1, v7
    v_lshlrev_b32 v15, 2, v7
    v_add_u32 v15, v15, v12
    v_lshlrev_b32 v15, 7, v15
    v_lshl_add_u32 v15, v13, 3, v15
    v_add_u32 v15, s31, v15
    v_lshrrev_b32 v32, 1, v12
    v_lshl_add_u32 v32, v14, 1, v32
    v_xor_b32 v33, 0, v32
    v_lshl_add_u32 v36, v33, 5, v15
    v_xor_b32 v33, 1, v32
    v_lshl_add_u32 v37, v33, 5, v15
    v_xor_b32 v33, 2, v32
    v_lshl_add_u32 v38, v33, 5, v15
    v_xor_b32 v33, 3, v32
    v_lshl_add_u32 v39, v33, 5, v15
    s_waitcnt vmcnt(15)
    v_mul_f32 v16, 0x3b124925, v16
    s_waitcnt vmcnt(14)
    v_mul_f32 v20, 0x3b124925, v20
    v_fma_f32 v20, -v16, v16, v20
    v_max_f32 v20, 0, v20
    v_add_f32 v34, 0x3727c5ac, v20
    v_rcp_f32 v34, v34
    s_nop 0
    v_mul_f32 v35, v20, v34
    v_add_f32 v35, 0x3727c5ac, v35
    v_rcp_f32 v35, v35
    s_nop 0
    v_mul_f32 v34, v34, v35
    v_sqrt_f32 v20, v34
    s_nop 0
    v_mul_f32 v16, -v16, v20
    v_mul_f32 v17, 0x3b124925, v17
    v_mul_f32 v21, 0x3b124925, v21
    v_fma_f32 v21, -v17, v17, v21
    v_max_f32 v21, 0, v21
    v_add_f32 v34, 0x3727c5ac, v21
    v_rcp_f32 v34, v34
    s_nop 0
    v_mul_f32 v35, v21, v34
    v_add_f32 v35, 0x3727c5ac, v35
    v_rcp_f32 v35, v35
    s_nop 0
    v_mul_f32 v34, v34, v35
    v_sqrt_f32 v21, v34
    s_nop 0
    v_mul_f32 v17, -v17, v21
    v_mul_f32 v18, 0x3b124925, v18
    v_mul_f32 v22, 0x3b124925, v22
    v_fma_f32 v22, -v18, v18, v22
    v_max_f32 v22, 0, v22
    v_add_f32 v34, 0x3727c5ac, v22
    v_rcp_f32 v34, v34
    s_nop 0
    v_mul_f32 v35, v22, v34
    v_add_f32 v35, 0x3727c5ac, v35
    v_rcp_f32 v35, v35
    s_nop 0
    v_mul_f32 v34, v34, v35
    v_sqrt_f32 v22, v34
    s_nop 0
    v_mul_f32 v18, -v18, v22
    v_mul_f32 v19, 0x3b124925, v19
    v_mul_f32 v23, 0x3b124925, v23
    v_fma_f32 v23, -v19, v19, v23
    v_max_f32 v23, 0, v23
    v_add_f32 v34, 0x3727c5ac, v23
    v_rcp_f32 v34, v34
    s_nop 0
    v_mul_f32 v35, v23, v34
    v_add_f32 v35, 0x3727c5ac, v35
    v_rcp_f32 v35, v35
    s_nop 0
    v_mul_f32 v34, v34, v35
    v_sqrt_f32 v23, v34
    s_nop 0
    v_mul_f32 v19, -v19, v23
    v_lshlrev_b32 v34, 4, v1
    s_lshl_b32 s34, s22, 10
    s_add_u32 s34, s34, 147456
    v_add_u32 v34, s34, v34
    ds_write_b128 v34, v[20:23]
    ds_write_b128 v34, v[16:19] offset:8192
    v_lshlrev_b32 v35, 4, v7
    s_lshl_b32 s34, s47, 11
    s_add_u32 s34, s34, 147456
    v_add_u32 v35, s34, v35
    s_waitcnt vmcnt(12)
    s_waitcnt lgkmcnt(0)
    s_barrier
    ds_read_b64_tr_b16 a[0:1], v36 offset:0
    ds_read_b64_tr_b16 a[2:3], v36 offset:2048
    ds_read_b64_tr_b16 a[4:5], v37 offset:0
    ds_read_b64_tr_b16 a[6:7], v37 offset:2048
    ds_read_b64_tr_b16 a[8:9], v38 offset:0
    ds_read_b64_tr_b16 a[10:11], v38 offset:2048
    ds_read_b64_tr_b16 a[12:13], v39 offset:0
    ds_read_b64_tr_b16 a[14:15], v39 offset:2048
    ds_read_b128 v[56:59], v35 offset:0
    ds_read_b128 v[64:67], v35 offset:8192
    ds_read_b128 v[60:63], v35 offset:64
    ds_read_b128 v[68:71], v35 offset:8256
    ds_read_b128 v[72:75], v35 offset:128
    ds_read_b128 v[80:83], v35 offset:8320
    ds_read_b128 v[76:79], v35 offset:192
    s_waitcnt lgkmcnt(13)
    ds_read_b128 v[84:87], v35 offset:8384
    v_lshlrev_b32 v88, 16, v112
    v_and_b32 v89, 0xffff0000, v112
    v_lshlrev_b32 v90, 16, v113
    v_and_b32 v91, 0xffff0000, v113
    s_waitcnt lgkmcnt(6)
    v_fma_f32 v88, v88, v56, v64
    v_fma_f32 v89, v89, v57, v65
    v_fma_f32 v90, v90, v58, v66
    v_fma_f32 v91, v91, v59, v67
    v_cvt_pk_bf16_f32 v40, v88, v89
    v_cvt_pk_bf16_f32 v41, v90, v91
    v_lshlrev_b32 v92, 16, v114
    v_and_b32 v93, 0xffff0000, v114
    v_lshlrev_b32 v94, 16, v115
    v_and_b32 v95, 0xffff0000, v115
    s_waitcnt lgkmcnt(4)
    v_fma_f32 v92, v92, v60, v68
    v_fma_f32 v93, v93, v61, v69
    v_fma_f32 v94, v94, v62, v70
    v_fma_f32 v95, v95, v63, v71
    v_cvt_pk_bf16_f32 v42, v92, v93
    v_cvt_pk_bf16_f32 v43, v94, v95
    v_lshlrev_b32 v88, 16, v116
    v_and_b32 v89, 0xffff0000, v116
    v_lshlrev_b32 v90, 16, v117
    v_and_b32 v91, 0xffff0000, v117
    v_fma_f32 v88, v88, v56, v64
    v_fma_f32 v89, v89, v57, v65
    v_fma_f32 v90, v90, v58, v66
    v_fma_f32 v91, v91, v59, v67
    v_cvt_pk_bf16_f32 v44, v88, v89
    v_cvt_pk_bf16_f32 v45, v90, v91
    v_lshlrev_b32 v92, 16, v118
    v_and_b32 v93, 0xffff0000, v118
    v_lshlrev_b32 v94, 16, v119
    v_and_b32 v95, 0xffff0000, v119
    v_fma_f32 v92, v92, v60, v68
    v_fma_f32 v93, v93, v61, v69
    v_fma_f32 v94, v94, v62, v70
    v_fma_f32 v95, v95, v63, v71
    v_cvt_pk_bf16_f32 v46, v92, v93
    v_cvt_pk_bf16_f32 v47, v94, v95
    v_mfma_f32_16x16x32_bf16 a[32:35], a[0:3], v[40:43], 0
    s_waitcnt vmcnt(8)
    s_barrier
    ds_read_b64_tr_b16 a[16:17], v36 offset:4096
    ds_read_b64_tr_b16 a[18:19], v36 offset:6144
    ds_read_b64_tr_b16 a[20:21], v37 offset:4096
    ds_read_b64_tr_b16 a[22:23], v37 offset:6144
    ds_read_b64_tr_b16 a[24:25], v38 offset:4096
    v_mfma_f32_16x16x32_bf16 a[40:43], a[4:7], v[40:43], 0
    ds_read_b64_tr_b16 a[26:27], v38 offset:6144
    ds_read_b64_tr_b16 a[28:29], v39 offset:4096
    ds_read_b64_tr_b16 a[30:31], v39 offset:6144
    v_lshlrev_b32 v88, 16, v120
    v_and_b32 v89, 0xffff0000, v120
    v_lshlrev_b32 v90, 16, v121
    v_and_b32 v91, 0xffff0000, v121
    v_mfma_f32_16x16x32_bf16 a[48:51], a[8:11], v[40:43], 0
    s_waitcnt lgkmcnt(10)
    v_fma_f32 v88, v88, v72, v80
    v_fma_f32 v89, v89, v73, v81
    v_fma_f32 v90, v90, v74, v82
    v_fma_f32 v91, v91, v75, v83
    v_cvt_pk_bf16_f32 v48, v88, v89
    v_cvt_pk_bf16_f32 v49, v90, v91
    v_lshlrev_b32 v92, 16, v122
    v_mfma_f32_16x16x32_bf16 a[56:59], a[12:15], v[40:43], 0
    v_and_b32 v93, 0xffff0000, v122
    v_lshlrev_b32 v94, 16, v123
    v_and_b32 v95, 0xffff0000, v123
    s_waitcnt lgkmcnt(8)
    v_fma_f32 v92, v92, v76, v84
    v_fma_f32 v93, v93, v77, v85
    v_fma_f32 v94, v94, v78, v86
    v_fma_f32 v95, v95, v79, v87
    v_mfma_f32_16x16x32_bf16 a[36:39], a[0:3], v[44:47], 0
    v_cvt_pk_bf16_f32 v50, v92, v93
    v_cvt_pk_bf16_f32 v51, v94, v95
    v_lshlrev_b32 v88, 16, v124
    v_and_b32 v89, 0xffff0000, v124
    s_add_u32 s33, s29, 200704
    buffer_load_dwordx4 v[168:171], v6, s[8:11], s33 offen sc1
    v_lshlrev_b32 v90, 16, v125
    v_and_b32 v91, 0xffff0000, v125
    v_mfma_f32_16x16x32_bf16 a[44:47], a[4:7], v[44:47], 0
    v_fma_f32 v88, v88, v72, v80
    v_fma_f32 v89, v89, v73, v81
    v_fma_f32 v90, v90, v74, v82
    v_fma_f32 v91, v91, v75, v83
    v_cvt_pk_bf16_f32 v52, v88, v89
    v_cvt_pk_bf16_f32 v53, v90, v91
    v_lshlrev_b32 v92, 16, v126
    v_mfma_f32_16x16x32_bf16 a[52:55], a[8:11], v[44:47], 0
    v_and_b32 v93, 0xffff0000, v126
    v_lshlrev_b32 v94, 16, v127
    v_and_b32 v95, 0xffff0000, v127
    v_fma_f32 v92, v92, v76, v84
    v_fma_f32 v93, v93, v77, v85
    v_fma_f32 v94, v94, v78, v86
    v_fma_f32 v95, v95, v79, v87
    v_mfma_f32_16x16x32_bf16 a[60:63], a[12:15], v[44:47], 0
    v_cvt_pk_bf16_f32 v54, v92, v93
    v_cvt_pk_bf16_f32 v55, v94, v95
    ds_read_b128 v[56:59], v35 offset:256
    ds_read_b128 v[64:67], v35 offset:8448
    ds_read_b128 v[60:63], v35 offset:320
    ds_read_b128 v[68:71], v35 offset:8512
    buffer_load_dwordx4 v[172:175], v9, s[8:11], s33 offen offset:1024 sc1
    s_waitcnt lgkmcnt(10)
    v_mfma_f32_16x16x32_bf16 a[32:35], a[16:19], v[48:51], a[32:35]
    ds_read_b64_tr_b16 a[0:1], v36 offset:8192
    ds_read_b64_tr_b16 a[2:3], v36 offset:10240
    ds_read_b64_tr_b16 a[4:5], v37 offset:8192
    ds_read_b64_tr_b16 a[6:7], v37 offset:10240
    ds_read_b64_tr_b16 a[8:9], v38 offset:8192
    s_waitcnt lgkmcnt(13)
    ds_read_b64_tr_b16 a[10:11], v38 offset:10240
    v_mfma_f32_16x16x32_bf16 a[40:43], a[20:23], v[48:51], a[40:43]
    ds_read_b64_tr_b16 a[12:13], v39 offset:8192
    s_waitcnt lgkmcnt(13)
    ds_read_b64_tr_b16 a[14:15], v39 offset:10240
    v_lshlrev_b32 v88, 16, v128
    v_and_b32 v89, 0xffff0000, v128
    v_lshlrev_b32 v90, 16, v129
    v_and_b32 v91, 0xffff0000, v129
    s_waitcnt lgkmcnt(10)
    v_fma_f32 v88, v88, v56, v64
    v_mfma_f32_16x16x32_bf16 a[48:51], a[24:27], v[48:51], a[48:51]
    v_fma_f32 v89, v89, v57, v65
    v_fma_f32 v90, v90, v58, v66
    v_fma_f32 v91, v91, v59, v67
    v_cvt_pk_bf16_f32 v40, v88, v89
    v_cvt_pk_bf16_f32 v41, v90, v91
    v_lshlrev_b32 v92, 16, v130
    v_and_b32 v93, 0xffff0000, v130
    v_mfma_f32_16x16x32_bf16 a[56:59], a[28:31], v[48:51], a[56:59]
    v_lshlrev_b32 v94, 16, v131
    v_and_b32 v95, 0xffff0000, v131
    s_waitcnt lgkmcnt(8)
    v_fma_f32 v92, v92, v60, v68
    v_fma_f32 v93, v93, v61, v69
    v_fma_f32 v94, v94, v62, v70
    v_fma_f32 v95, v95, v63, v71
    v_cvt_pk_bf16_f32 v42, v92, v93
    v_mfma_f32_16x16x32_bf16 a[36:39], a[16:19], v[52:55], a[36:39]
    v_cvt_pk_bf16_f32 v43, v94, v95
    v_lshlrev_b32 v88, 16, v132
    v_and_b32 v89, 0xffff0000, v132
    s_add_u32 s33, s29, 229376
    buffer_load_dwordx4 v[112:115], v6, s[8:11], s33 offen sc1
    v_lshlrev_b32 v90, 16, v133
    v_and_b32 v91, 0xffff0000, v133
    v_mfma_f32_16x16x32_bf16 a[44:47], a[20:23], v[52:55], a[44:47]
    v_fma_f32 v88, v88, v56, v64
    v_fma_f32 v89, v89, v57, v65
    v_fma_f32 v90, v90, v58, v66
    v_fma_f32 v91, v91, v59, v67
    v_cvt_pk_bf16_f32 v44, v88, v89
    v_cvt_pk_bf16_f32 v45, v90, v91
    v_lshlrev_b32 v92, 16, v134
    v_mfma_f32_16x16x32_bf16 a[52:55], a[24:27], v[52:55], a[52:55]
    v_and_b32 v93, 0xffff0000, v134
    v_lshlrev_b32 v94, 16, v135
    v_and_b32 v95, 0xffff0000, v135
    v_fma_f32 v92, v92, v60, v68
    v_fma_f32 v93, v93, v61, v69
    v_fma_f32 v94, v94, v62, v70
    v_fma_f32 v95, v95, v63, v71
    v_mfma_f32_16x16x32_bf16 a[60:63], a[28:31], v[52:55], a[60:63]
    v_cvt_pk_bf16_f32 v46, v92, v93
    v_cvt_pk_bf16_f32 v47, v94, v95
    ds_read_b128 v[72:75], v35 offset:384
    ds_read_b128 v[80:83], v35 offset:8576
    ds_read_b128 v[76:79], v35 offset:448
    ds_read_b128 v[84:87], v35 offset:8640
    buffer_load_dwordx4 v[116:119], v9, s[8:11], s33 offen offset:1024 sc1
    s_waitcnt lgkmcnt(10)
    v_mfma_f32_16x16x32_bf16 a[32:35], a[0:3], v[40:43], a[32:35]
    s_waitcnt vmcnt(8)
    s_barrier
    ds_read_b64_tr_b16 a[16:17], v36 offset:12288
    ds_read_b64_tr_b16 a[18:19], v36 offset:14336
    ds_read_b64_tr_b16 a[20:21], v37 offset:12288
    ds_read_b64_tr_b16 a[22:23], v37 offset:14336
    ds_read_b64_tr_b16 a[24:25], v38 offset:12288
    s_waitcnt lgkmcnt(13)
    ds_read_b64_tr_b16 a[26:27], v38 offset:14336
    v_mfma_f32_16x16x32_bf16 a[40:43], a[4:7], v[40:43], a[40:43]
    ds_read_b64_tr_b16 a[28:29], v39 offset:12288
    s_waitcnt lgkmcnt(13)
    ds_read_b64_tr_b16 a[30:31], v39 offset:14336
    v_lshlrev_b32 v88, 16, v136
    v_and_b32 v89, 0xffff0000, v136
    v_lshlrev_b32 v90, 16, v137
    v_and_b32 v91, 0xffff0000, v137
    s_waitcnt lgkmcnt(10)
    v_fma_f32 v88, v88, v72, v80
    v_mfma_f32_16x16x32_bf16 a[48:51], a[8:11], v[40:43], a[48:51]
    v_fma_f32 v89, v89, v73, v81
    v_fma_f32 v90, v90, v74, v82
    v_fma_f32 v91, v91, v75, v83
    v_cvt_pk_bf16_f32 v48, v88, v89
    v_cvt_pk_bf16_f32 v49, v90, v91
    v_lshlrev_b32 v92, 16, v138
    s_add_u32 m0, s49, 0
    s_mov_b32 s32, 1032192
    buffer_load_dwordx4 v5, s[4:7], s32 offen sc1 lds
    v_mfma_f32_16x16x32_bf16 a[56:59], a[12:15], v[40:43], a[56:59]
    v_and_b32 v93, 0xffff0000, v138
    v_lshlrev_b32 v94, 16, v139
    v_and_b32 v95, 0xffff0000, v139
    s_waitcnt lgkmcnt(8)
    v_fma_f32 v92, v92, v76, v84
    v_fma_f32 v93, v93, v77, v85
    v_fma_f32 v94, v94, v78, v86
    v_fma_f32 v95, v95, v79, v87
    v_mfma_f32_16x16x32_bf16 a[36:39], a[0:3], v[44:47], a[36:39]
    v_cvt_pk_bf16_f32 v50, v92, v93
    v_cvt_pk_bf16_f32 v51, v94, v95
    v_lshlrev_b32 v88, 16, v140
    v_and_b32 v89, 0xffff0000, v140
    buffer_load_dwordx4 v4, s[4:7], s32 offen offset:1024 sc1 lds
    v_lshlrev_b32 v90, 16, v141
    v_and_b32 v91, 0xffff0000, v141
    v_mfma_f32_16x16x32_bf16 a[44:47], a[4:7], v[44:47], a[44:47]
    v_fma_f32 v88, v88, v72, v80
    v_fma_f32 v89, v89, v73, v81
    v_fma_f32 v90, v90, v74, v82
    v_fma_f32 v91, v91, v75, v83
    v_cvt_pk_bf16_f32 v52, v88, v89
    v_cvt_pk_bf16_f32 v53, v90, v91
    v_lshlrev_b32 v92, 16, v142
    v_mfma_f32_16x16x32_bf16 a[52:55], a[8:11], v[44:47], a[52:55]
    v_and_b32 v93, 0xffff0000, v142
    v_lshlrev_b32 v94, 16, v143
    s_add_u32 s33, s29, 258048
    buffer_load_dwordx4 v[120:123], v6, s[8:11], s33 offen sc1
    v_and_b32 v95, 0xffff0000, v143
    v_fma_f32 v92, v92, v76, v84
    v_fma_f32 v93, v93, v77, v85
    v_fma_f32 v94, v94, v78, v86
    v_mfma_f32_16x16x32_bf16 a[60:63], a[12:15], v[44:47], a[60:63]
    v_fma_f32 v95, v95, v79, v87
    v_cvt_pk_bf16_f32 v54, v92, v93
    v_cvt_pk_bf16_f32 v55, v94, v95
    ds_read_b128 v[56:59], v35 offset:512
    ds_read_b128 v[64:67], v35 offset:8704
    ds_read_b128 v[60:63], v35 offset:576
    ds_read_b128 v[68:71], v35 offset:8768
    buffer_load_dwordx4 v[124:127], v9, s[8:11], s33 offen offset:1024 sc1
    s_waitcnt lgkmcnt(10)
    v_mfma_f32_16x16x32_bf16 a[32:35], a[16:19], v[48:51], a[32:35]
    ds_read_b64_tr_b16 a[0:1], v36 offset:16384
    ds_read_b64_tr_b16 a[2:3], v36 offset:18432
    ds_read_b64_tr_b16 a[4:5], v37 offset:16384
    ds_read_b64_tr_b16 a[6:7], v37 offset:18432
    ds_read_b64_tr_b16 a[8:9], v38 offset:16384
    s_waitcnt lgkmcnt(13)
    ds_read_b64_tr_b16 a[10:11], v38 offset:18432
    ds_read_b64_tr_b16 a[12:13], v39 offset:16384
    v_mfma_f32_16x16x32_bf16 a[40:43], a[20:23], v[48:51], a[40:43]
    s_waitcnt lgkmcnt(13)
    ds_read_b64_tr_b16 a[14:15], v39 offset:18432
    v_lshlrev_b32 v88, 16, v144
    v_and_b32 v89, 0xffff0000, v144
    v_lshlrev_b32 v90, 16, v145
    v_and_b32 v91, 0xffff0000, v145
    s_waitcnt lgkmcnt(10)
    v_fma_f32 v88, v88, v56, v64
    v_fma_f32 v89, v89, v57, v65
    v_mfma_f32_16x16x32_bf16 a[48:51], a[24:27], v[48:51], a[48:51]
    v_fma_f32 v90, v90, v58, v66
    v_fma_f32 v91, v91, v59, v67
    v_cvt_pk_bf16_f32 v40, v88, v89
    v_cvt_pk_bf16_f32 v41, v90, v91
    v_lshlrev_b32 v92, 16, v146
    s_add_u32 m0, s49, 4096
    s_mov_b32 s32, 1146880
    buffer_load_dwordx4 v5, s[4:7], s32 offen sc1 lds
    v_and_b32 v93, 0xffff0000, v146
    v_mfma_f32_16x16x32_bf16 a[56:59], a[28:31], v[48:51], a[56:59]
    v_lshlrev_b32 v94, 16, v147
    v_and_b32 v95, 0xffff0000, v147
    s_waitcnt lgkmcnt(8)
    v_fma_f32 v92, v92, v60, v68
    v_fma_f32 v93, v93, v61, v69
    v_fma_f32 v94, v94, v62, v70
    v_fma_f32 v95, v95, v63, v71
    v_cvt_pk_bf16_f32 v42, v92, v93
    v_mfma_f32_16x16x32_bf16 a[36:39], a[16:19], v[52:55], a[36:39]
    v_cvt_pk_bf16_f32 v43, v94, v95
    v_lshlrev_b32 v88, 16, v148
    v_and_b32 v89, 0xffff0000, v148
    buffer_load_dwordx4 v4, s[4:7], s32 offen offset:1024 sc1 lds
    v_lshlrev_b32 v90, 16, v149
    v_and_b32 v91, 0xffff0000, v149
    v_fma_f32 v88, v88, v56, v64
    v_mfma_f32_16x16x32_bf16 a[44:47], a[20:23], v[52:55], a[44:47]
    v_fma_f32 v89, v89, v57, v65
    v_fma_f32 v90, v90, v58, v66
    v_fma_f32 v91, v91, v59, v67
    v_cvt_pk_bf16_f32 v44, v88, v89
    v_cvt_pk_bf16_f32 v45, v90, v91
    v_lshlrev_b32 v92, 16, v150
    v_and_b32 v93, 0xffff0000, v150
    v_mfma_f32_16x16x32_bf16 a[52:55], a[24:27], v[52:55], a[52:55]
    v_lshlrev_b32 v94, 16, v151
    s_add_u32 s33, s29, 286720
    buffer_load_dwordx4 v[128:131], v6, s[8:11], s33 offen sc1
    v_and_b32 v95, 0xffff0000, v151
    v_fma_f32 v92, v92, v60, v68
    v_fma_f32 v93, v93, v61, v69
    v_fma_f32 v94, v94, v62, v70
    v_fma_f32 v95, v95, v63, v71
    v_mfma_f32_16x16x32_bf16 a[60:63], a[28:31], v[52:55], a[60:63]
    v_cvt_pk_bf16_f32 v46, v92, v93
    v_cvt_pk_bf16_f32 v47, v94, v95
    ds_read_b128 v[72:75], v35 offset:640
    ds_read_b128 v[80:83], v35 offset:8832
    ds_read_b128 v[76:79], v35 offset:704
    ds_read_b128 v[84:87], v35 offset:8896
    buffer_load_dwordx4 v[132:135], v9, s[8:11], s33 offen offset:1024 sc1
    s_waitcnt lgkmcnt(10)
    v_mfma_f32_16x16x32_bf16 a[32:35], a[0:3], v[40:43], a[32:35]
    s_waitcnt vmcnt(12)
    s_barrier
    ds_read_b64_tr_b16 a[16:17], v36 offset:20480
    ds_read_b64_tr_b16 a[18:19], v36 offset:22528
    ds_read_b64_tr_b16 a[20:21], v37 offset:20480
    ds_read_b64_tr_b16 a[22:23], v37 offset:22528
    ds_read_b64_tr_b16 a[24:25], v38 offset:20480
    s_waitcnt lgkmcnt(13)
    ds_read_b64_tr_b16 a[26:27], v38 offset:22528
    v_mfma_f32_16x16x32_bf16 a[40:43], a[4:7], v[40:43], a[40:43]
    ds_read_b64_tr_b16 a[28:29], v39 offset:20480
    s_waitcnt lgkmcnt(13)
    ds_read_b64_tr_b16 a[30:31], v39 offset:22528
    v_lshlrev_b32 v88, 16, v152
    v_and_b32 v89, 0xffff0000, v152
    v_lshlrev_b32 v90, 16, v153
    v_and_b32 v91, 0xffff0000, v153
    s_waitcnt lgkmcnt(10)
    v_fma_f32 v88, v88, v72, v80
    v_mfma_f32_16x16x32_bf16 a[48:51], a[8:11], v[40:43], a[48:51]
    v_fma_f32 v89, v89, v73, v81
    v_fma_f32 v90, v90, v74, v82
    v_fma_f32 v91, v91, v75, v83
    v_cvt_pk_bf16_f32 v48, v88, v89
    v_cvt_pk_bf16_f32 v49, v90, v91
    v_lshlrev_b32 v92, 16, v154
    s_add_u32 m0, s49, 8192
    s_mov_b32 s32, 1261568
    buffer_load_dwordx4 v5, s[4:7], s32 offen sc1 lds
    v_mfma_f32_16x16x32_bf16 a[56:59], a[12:15], v[40:43], a[56:59]
    v_and_b32 v93, 0xffff0000, v154
    v_lshlrev_b32 v94, 16, v155
    v_and_b32 v95, 0xffff0000, v155
    s_waitcnt lgkmcnt(8)
    v_fma_f32 v92, v92, v76, v84
    v_fma_f32 v93, v93, v77, v85
    v_fma_f32 v94, v94, v78, v86
    v_fma_f32 v95, v95, v79, v87
    v_mfma_f32_16x16x32_bf16 a[36:39], a[0:3], v[44:47], a[36:39]
    v_cvt_pk_bf16_f32 v50, v92, v93
    v_cvt_pk_bf16_f32 v51, v94, v95
    v_lshlrev_b32 v88, 16, v156
    v_and_b32 v89, 0xffff0000, v156
    buffer_load_dwordx4 v4, s[4:7], s32 offen offset:1024 sc1 lds
    v_lshlrev_b32 v90, 16, v157
    v_and_b32 v91, 0xffff0000, v157
    v_mfma_f32_16x16x32_bf16 a[44:47], a[4:7], v[44:47], a[44:47]
    v_fma_f32 v88, v88, v72, v80
    v_fma_f32 v89, v89, v73, v81
    v_fma_f32 v90, v90, v74, v82
    v_fma_f32 v91, v91, v75, v83
    v_cvt_pk_bf16_f32 v52, v88, v89
    v_cvt_pk_bf16_f32 v53, v90, v91
    v_lshlrev_b32 v92, 16, v158
    v_mfma_f32_16x16x32_bf16 a[52:55], a[8:11], v[44:47], a[52:55]
    v_and_b32 v93, 0xffff0000, v158
    v_lshlrev_b32 v94, 16, v159
    s_add_u32 s33, s29, 315392
    buffer_load_dwordx4 v[136:139], v6, s[8:11], s33 offen sc1
    v_and_b32 v95, 0xffff0000, v159
    v_fma_f32 v92, v92, v76, v84
    v_fma_f32 v93, v93, v77, v85
    v_fma_f32 v94, v94, v78, v86
    v_mfma_f32_16x16x32_bf16 a[60:63], a[12:15], v[44:47], a[60:63]
    v_fma_f32 v95, v95, v79, v87
    v_cvt_pk_bf16_f32 v54, v92, v93
    v_cvt_pk_bf16_f32 v55, v94, v95
    ds_read_b128 v[56:59], v35 offset:768
    ds_read_b128 v[64:67], v35 offset:8960
    ds_read_b128 v[60:63], v35 offset:832
    ds_read_b128 v[68:71], v35 offset:9024
    buffer_load_dwordx4 v[140:143], v9, s[8:11], s33 offen offset:1024 sc1
    s_waitcnt lgkmcnt(10)
    v_mfma_f32_16x16x32_bf16 a[32:35], a[16:19], v[48:51], a[32:35]
    ds_read_b64_tr_b16 a[0:1], v36 offset:24576
    ds_read_b64_tr_b16 a[2:3], v36 offset:26624
    ds_read_b64_tr_b16 a[4:5], v37 offset:24576
    ds_read_b64_tr_b16 a[6:7], v37 offset:26624
    ds_read_b64_tr_b16 a[8:9], v38 offset:24576
    s_waitcnt lgkmcnt(13)
    ds_read_b64_tr_b16 a[10:11], v38 offset:26624
    ds_read_b64_tr_b16 a[12:13], v39 offset:24576
    v_mfma_f32_16x16x32_bf16 a[40:43], a[20:23], v[48:51], a[40:43]
    s_waitcnt lgkmcnt(13)
    ds_read_b64_tr_b16 a[14:15], v39 offset:26624
    v_lshlrev_b32 v88, 16, v160
    v_and_b32 v89, 0xffff0000, v160
    v_lshlrev_b32 v90, 16, v161
    v_and_b32 v91, 0xffff0000, v161
    s_waitcnt lgkmcnt(10)
    v_fma_f32 v88, v88, v56, v64
    v_fma_f32 v89, v89, v57, v65
    v_mfma_f32_16x16x32_bf16 a[48:51], a[24:27], v[48:51], a[48:51]
    v_fma_f32 v90, v90, v58, v66
    v_fma_f32 v91, v91, v59, v67
    v_cvt_pk_bf16_f32 v40, v88, v89
    v_cvt_pk_bf16_f32 v41, v90, v91
    v_lshlrev_b32 v92, 16, v162
    s_add_u32 m0, s49, 12288
    s_mov_b32 s32, 1376256
    buffer_load_dwordx4 v5, s[4:7], s32 offen sc1 lds
    v_and_b32 v93, 0xffff0000, v162
    v_mfma_f32_16x16x32_bf16 a[56:59], a[28:31], v[48:51], a[56:59]
    v_lshlrev_b32 v94, 16, v163
    v_and_b32 v95, 0xffff0000, v163
    s_waitcnt lgkmcnt(8)
    v_fma_f32 v92, v92, v60, v68
    v_fma_f32 v93, v93, v61, v69
    v_fma_f32 v94, v94, v62, v70
    v_fma_f32 v95, v95, v63, v71
    v_cvt_pk_bf16_f32 v42, v92, v93
    v_mfma_f32_16x16x32_bf16 a[36:39], a[16:19], v[52:55], a[36:39]
    v_cvt_pk_bf16_f32 v43, v94, v95
    v_lshlrev_b32 v88, 16, v164
    v_and_b32 v89, 0xffff0000, v164
    buffer_load_dwordx4 v4, s[4:7], s32 offen offset:1024 sc1 lds
    v_lshlrev_b32 v90, 16, v165
    v_and_b32 v91, 0xffff0000, v165
    v_fma_f32 v88, v88, v56, v64
    v_mfma_f32_16x16x32_bf16 a[44:47], a[20:23], v[52:55], a[44:47]
    v_fma_f32 v89, v89, v57, v65
    v_fma_f32 v90, v90, v58, v66
    v_fma_f32 v91, v91, v59, v67
    v_cvt_pk_bf16_f32 v44, v88, v89
    v_cvt_pk_bf16_f32 v45, v90, v91
    v_lshlrev_b32 v92, 16, v166
    v_and_b32 v93, 0xffff0000, v166
    v_mfma_f32_16x16x32_bf16 a[52:55], a[24:27], v[52:55], a[52:55]
    v_lshlrev_b32 v94, 16, v167
    s_add_u32 s33, s29, 344064
    buffer_load_dwordx4 v[144:147], v6, s[8:11], s33 offen sc1
    v_and_b32 v95, 0xffff0000, v167
    v_fma_f32 v92, v92, v60, v68
    v_fma_f32 v93, v93, v61, v69
    v_fma_f32 v94, v94, v62, v70
    v_fma_f32 v95, v95, v63, v71
    v_mfma_f32_16x16x32_bf16 a[60:63], a[28:31], v[52:55], a[60:63]
    v_cvt_pk_bf16_f32 v46, v92, v93
    v_cvt_pk_bf16_f32 v47, v94, v95
    ds_read_b128 v[72:75], v35 offset:896
    ds_read_b128 v[80:83], v35 offset:9088
    ds_read_b128 v[76:79], v35 offset:960
    ds_read_b128 v[84:87], v35 offset:9152
    buffer_load_dwordx4 v[148:151], v9, s[8:11], s33 offen offset:1024 sc1
    s_waitcnt lgkmcnt(10)
    v_mfma_f32_16x16x32_bf16 a[32:35], a[0:3], v[40:43], a[32:35]
    s_waitcnt vmcnt(16)
    s_barrier
    ds_read_b64_tr_b16 a[16:17], v36 offset:28672
    ds_read_b64_tr_b16 a[18:19], v36 offset:30720
    ds_read_b64_tr_b16 a[20:21], v37 offset:28672
    ds_read_b64_tr_b16 a[22:23], v37 offset:30720
    ds_read_b64_tr_b16 a[24:25], v38 offset:28672
    s_waitcnt lgkmcnt(13)
    ds_read_b64_tr_b16 a[26:27], v38 offset:30720
    v_mfma_f32_16x16x32_bf16 a[40:43], a[4:7], v[40:43], a[40:43]
    ds_read_b64_tr_b16 a[28:29], v39 offset:28672
    s_waitcnt lgkmcnt(13)
    ds_read_b64_tr_b16 a[30:31], v39 offset:30720
    v_lshlrev_b32 v88, 16, v168
    v_and_b32 v89, 0xffff0000, v168
    v_lshlrev_b32 v90, 16, v169
    v_and_b32 v91, 0xffff0000, v169
    s_waitcnt lgkmcnt(10)
    v_fma_f32 v88, v88, v72, v80
    v_mfma_f32_16x16x32_bf16 a[48:51], a[8:11], v[40:43], a[48:51]
    v_fma_f32 v89, v89, v73, v81
    v_fma_f32 v90, v90, v74, v82
    v_fma_f32 v91, v91, v75, v83
    v_cvt_pk_bf16_f32 v48, v88, v89
    v_cvt_pk_bf16_f32 v49, v90, v91
    v_lshlrev_b32 v92, 16, v170
    s_add_u32 m0, s49, 16384
    s_mov_b32 s32, 1490944
    buffer_load_dwordx4 v5, s[4:7], s32 offen sc1 lds
    v_mfma_f32_16x16x32_bf16 a[56:59], a[12:15], v[40:43], a[56:59]
    v_and_b32 v93, 0xffff0000, v170
    v_lshlrev_b32 v94, 16, v171
    v_and_b32 v95, 0xffff0000, v171
    s_waitcnt lgkmcnt(8)
    v_fma_f32 v92, v92, v76, v84
    v_fma_f32 v93, v93, v77, v85
    v_fma_f32 v94, v94, v78, v86
    v_fma_f32 v95, v95, v79, v87
    v_mfma_f32_16x16x32_bf16 a[36:39], a[0:3], v[44:47], a[36:39]
    v_cvt_pk_bf16_f32 v50, v92, v93
    v_cvt_pk_bf16_f32 v51, v94, v95
    v_lshlrev_b32 v88, 16, v172
    v_and_b32 v89, 0xffff0000, v172
    buffer_load_dwordx4 v4, s[4:7], s32 offen offset:1024 sc1 lds
    v_lshlrev_b32 v90, 16, v173
    v_and_b32 v91, 0xffff0000, v173
    v_mfma_f32_16x16x32_bf16 a[44:47], a[4:7], v[44:47], a[44:47]
    v_fma_f32 v88, v88, v72, v80
    v_fma_f32 v89, v89, v73, v81
    v_fma_f32 v90, v90, v74, v82
    v_fma_f32 v91, v91, v75, v83
    v_cvt_pk_bf16_f32 v52, v88, v89
    v_cvt_pk_bf16_f32 v53, v90, v91
    v_lshlrev_b32 v92, 16, v174
    v_mfma_f32_16x16x32_bf16 a[52:55], a[8:11], v[44:47], a[52:55]
    v_and_b32 v93, 0xffff0000, v174
    v_lshlrev_b32 v94, 16, v175
    s_add_u32 s33, s29, 372736
    buffer_load_dwordx4 v[152:155], v6, s[8:11], s33 offen sc1
    v_and_b32 v95, 0xffff0000, v175
    v_fma_f32 v92, v92, v76, v84
    v_fma_f32 v93, v93, v77, v85
    v_fma_f32 v94, v94, v78, v86
    v_mfma_f32_16x16x32_bf16 a[60:63], a[12:15], v[44:47], a[60:63]
    v_fma_f32 v95, v95, v79, v87
    v_cvt_pk_bf16_f32 v54, v92, v93
    v_cvt_pk_bf16_f32 v55, v94, v95
    ds_read_b128 v[56:59], v35 offset:1024
    ds_read_b128 v[64:67], v35 offset:9216
    ds_read_b128 v[60:63], v35 offset:1088
    ds_read_b128 v[68:71], v35 offset:9280
    buffer_load_dwordx4 v[156:159], v9, s[8:11], s33 offen offset:1024 sc1
    s_waitcnt lgkmcnt(10)
    v_mfma_f32_16x16x32_bf16 a[32:35], a[16:19], v[48:51], a[32:35]
    ds_read_b64_tr_b16 a[0:1], v36 offset:32768
    ds_read_b64_tr_b16 a[2:3], v36 offset:34816
    ds_read_b64_tr_b16 a[4:5], v37 offset:32768
    ds_read_b64_tr_b16 a[6:7], v37 offset:34816
    ds_read_b64_tr_b16 a[8:9], v38 offset:32768
    s_waitcnt lgkmcnt(13)
    ds_read_b64_tr_b16 a[10:11], v38 offset:34816
    ds_read_b64_tr_b16 a[12:13], v39 offset:32768
    v_mfma_f32_16x16x32_bf16 a[40:43], a[20:23], v[48:51], a[40:43]
    s_waitcnt lgkmcnt(13)
    ds_read_b64_tr_b16 a[14:15], v39 offset:34816
    v_lshlrev_b32 v88, 16, v112
    v_and_b32 v89, 0xffff0000, v112
    v_lshlrev_b32 v90, 16, v113
    v_and_b32 v91, 0xffff0000, v113
    s_waitcnt lgkmcnt(10)
    v_fma_f32 v88, v88, v56, v64
    v_fma_f32 v89, v89, v57, v65
    v_mfma_f32_16x16x32_bf16 a[48:51], a[24:27], v[48:51], a[48:51]
    v_fma_f32 v90, v90, v58, v66
    v_fma_f32 v91, v91, v59, v67
    v_cvt_pk_bf16_f32 v40, v88, v89
    v_cvt_pk_bf16_f32 v41, v90, v91
    v_lshlrev_b32 v92, 16, v114
    s_add_u32 m0, s49, 20480
    s_mov_b32 s32, 1605632
    buffer_load_dwordx4 v5, s[4:7], s32 offen sc1 lds
    v_and_b32 v93, 0xffff0000, v114
    v_mfma_f32_16x16x32_bf16 a[56:59], a[28:31], v[48:51], a[56:59]
    v_lshlrev_b32 v94, 16, v115
    v_and_b32 v95, 0xffff0000, v115
    s_waitcnt lgkmcnt(8)
    v_fma_f32 v92, v92, v60, v68
    v_fma_f32 v93, v93, v61, v69
    v_fma_f32 v94, v94, v62, v70
    v_fma_f32 v95, v95, v63, v71
    v_cvt_pk_bf16_f32 v42, v92, v93
    v_mfma_f32_16x16x32_bf16 a[36:39], a[16:19], v[52:55], a[36:39]
    v_cvt_pk_bf16_f32 v43, v94, v95
    v_lshlrev_b32 v88, 16, v116
    v_and_b32 v89, 0xffff0000, v116
    buffer_load_dwordx4 v4, s[4:7], s32 offen offset:1024 sc1 lds
    v_lshlrev_b32 v90, 16, v117
    v_and_b32 v91, 0xffff0000, v117
    v_fma_f32 v88, v88, v56, v64
    v_mfma_f32_16x16x32_bf16 a[44:47], a[20:23], v[52:55], a[44:47]
    v_fma_f32 v89, v89, v57, v65
    v_fma_f32 v90, v90, v58, v66
    v_fma_f32 v91, v91, v59, v67
    v_cvt_pk_bf16_f32 v44, v88, v89
    v_cvt_pk_bf16_f32 v45, v90, v91
    v_lshlrev_b32 v92, 16, v118
    v_and_b32 v93, 0xffff0000, v118
    v_mfma_f32_16x16x32_bf16 a[52:55], a[24:27], v[52:55], a[52:55]
    v_lshlrev_b32 v94, 16, v119
    s_add_u32 s33, s29, 401408
    buffer_load_dwordx4 v[160:163], v6, s[8:11], s33 offen sc1
    v_and_b32 v95, 0xffff0000, v119
    v_fma_f32 v92, v92, v60, v68
    v_fma_f32 v93, v93, v61, v69
    v_fma_f32 v94, v94, v62, v70
    v_fma_f32 v95, v95, v63, v71
    v_mfma_f32_16x16x32_bf16 a[60:63], a[28:31], v[52:55], a[60:63]
    v_cvt_pk_bf16_f32 v46, v92, v93
    v_cvt_pk_bf16_f32 v47, v94, v95
    ds_read_b128 v[72:75], v35 offset:1152
    ds_read_b128 v[80:83], v35 offset:9344
    ds_read_b128 v[76:79], v35 offset:1216
    ds_read_b128 v[84:87], v35 offset:9408
    buffer_load_dwordx4 v[164:167], v9, s[8:11], s33 offen offset:1024 sc1
    s_waitcnt lgkmcnt(10)
    v_mfma_f32_16x16x32_bf16 a[32:35], a[0:3], v[40:43], a[32:35]
    s_waitcnt vmcnt(16)
    s_barrier
    ds_read_b64_tr_b16 a[16:17], v36 offset:0
    ds_read_b64_tr_b16 a[18:19], v36 offset:2048
    ds_read_b64_tr_b16 a[20:21], v37 offset:0
    ds_read_b64_tr_b16 a[22:23], v37 offset:2048
    ds_read_b64_tr_b16 a[24:25], v38 offset:0
    s_waitcnt lgkmcnt(13)
    ds_read_b64_tr_b16 a[26:27], v38 offset:2048
    v_mfma_f32_16x16x32_bf16 a[40:43], a[4:7], v[40:43], a[40:43]
    ds_read_b64_tr_b16 a[28:29], v39 offset:0
    s_waitcnt lgkmcnt(13)
    ds_read_b64_tr_b16 a[30:31], v39 offset:2048
    v_lshlrev_b32 v88, 16, v120
    v_and_b32 v89, 0xffff0000, v120
    v_lshlrev_b32 v90, 16, v121
    v_and_b32 v91, 0xffff0000, v121
    s_waitcnt lgkmcnt(10)
    v_fma_f32 v88, v88, v72, v80
    v_mfma_f32_16x16x32_bf16 a[48:51], a[8:11], v[40:43], a[48:51]
    v_fma_f32 v89, v89, v73, v81
    v_fma_f32 v90, v90, v74, v82
    v_fma_f32 v91, v91, v75, v83
    v_cvt_pk_bf16_f32 v48, v88, v89
    v_cvt_pk_bf16_f32 v49, v90, v91
    v_lshlrev_b32 v92, 16, v122
    s_add_u32 m0, s49, 24576
    s_mov_b32 s32, 1720320
    buffer_load_dwordx4 v5, s[4:7], s32 offen sc1 lds
    v_mfma_f32_16x16x32_bf16 a[56:59], a[12:15], v[40:43], a[56:59]
    v_and_b32 v93, 0xffff0000, v122
    v_lshlrev_b32 v94, 16, v123
    v_and_b32 v95, 0xffff0000, v123
    s_waitcnt lgkmcnt(8)
    v_fma_f32 v92, v92, v76, v84
    v_fma_f32 v93, v93, v77, v85
    v_fma_f32 v94, v94, v78, v86
    v_fma_f32 v95, v95, v79, v87
    v_mfma_f32_16x16x32_bf16 a[36:39], a[0:3], v[44:47], a[36:39]
    v_cvt_pk_bf16_f32 v50, v92, v93
    v_cvt_pk_bf16_f32 v51, v94, v95
    v_lshlrev_b32 v88, 16, v124
    v_and_b32 v89, 0xffff0000, v124
    buffer_load_dwordx4 v4, s[4:7], s32 offen offset:1024 sc1 lds
    v_lshlrev_b32 v90, 16, v125
    v_and_b32 v91, 0xffff0000, v125
    v_mfma_f32_16x16x32_bf16 a[44:47], a[4:7], v[44:47], a[44:47]
    v_fma_f32 v88, v88, v72, v80
    v_fma_f32 v89, v89, v73, v81
    v_fma_f32 v90, v90, v74, v82
    v_fma_f32 v91, v91, v75, v83
    v_cvt_pk_bf16_f32 v52, v88, v89
    v_cvt_pk_bf16_f32 v53, v90, v91
    v_lshlrev_b32 v92, 16, v126
    v_mfma_f32_16x16x32_bf16 a[52:55], a[8:11], v[44:47], a[52:55]
    v_and_b32 v93, 0xffff0000, v126
    v_lshlrev_b32 v94, 16, v127
    s_add_u32 s33, s29, 430080
    buffer_load_dwordx4 v[168:171], v6, s[8:11], s33 offen sc1
    v_and_b32 v95, 0xffff0000, v127
    v_fma_f32 v92, v92, v76, v84
    v_fma_f32 v93, v93, v77, v85
    v_fma_f32 v94, v94, v78, v86
    v_mfma_f32_16x16x32_bf16 a[60:63], a[12:15], v[44:47], a[60:63]
    v_fma_f32 v95, v95, v79, v87
    v_cvt_pk_bf16_f32 v54, v92, v93
    v_cvt_pk_bf16_f32 v55, v94, v95
    ds_read_b128 v[56:59], v35 offset:1280
    ds_read_b128 v[64:67], v35 offset:9472
    ds_read_b128 v[60:63], v35 offset:1344
    ds_read_b128 v[68:71], v35 offset:9536
    buffer_load_dwordx4 v[172:175], v9, s[8:11], s33 offen offset:1024 sc1
    s_waitcnt lgkmcnt(10)
    v_mfma_f32_16x16x32_bf16 a[32:35], a[16:19], v[48:51], a[32:35]
    ds_read_b64_tr_b16 a[0:1], v36 offset:4096
    ds_read_b64_tr_b16 a[2:3], v36 offset:6144
    ds_read_b64_tr_b16 a[4:5], v37 offset:4096
    ds_read_b64_tr_b16 a[6:7], v37 offset:6144
    ds_read_b64_tr_b16 a[8:9], v38 offset:4096
    s_waitcnt lgkmcnt(13)
    ds_read_b64_tr_b16 a[10:11], v38 offset:6144
    v_mfma_f32_16x16x32_bf16 a[40:43], a[20:23], v[48:51], a[40:43]
    ds_read_b64_tr_b16 a[12:13], v39 offset:4096
    s_waitcnt lgkmcnt(13)
    ds_read_b64_tr_b16 a[14:15], v39 offset:6144
    v_lshlrev_b32 v88, 16, v128
    v_and_b32 v89, 0xffff0000, v128
    v_lshlrev_b32 v90, 16, v129
    v_and_b32 v91, 0xffff0000, v129
    s_waitcnt lgkmcnt(10)
    v_fma_f32 v88, v88, v56, v64
    v_mfma_f32_16x16x32_bf16 a[48:51], a[24:27], v[48:51], a[48:51]
    v_fma_f32 v89, v89, v57, v65
    v_fma_f32 v90, v90, v58, v66
    v_fma_f32 v91, v91, v59, v67
    v_cvt_pk_bf16_f32 v40, v88, v89
    v_cvt_pk_bf16_f32 v41, v90, v91
    v_lshlrev_b32 v92, 16, v130
    v_mfma_f32_16x16x32_bf16 a[56:59], a[28:31], v[48:51], a[56:59]
    v_and_b32 v93, 0xffff0000, v130
    v_lshlrev_b32 v94, 16, v131
    v_and_b32 v95, 0xffff0000, v131
    s_waitcnt lgkmcnt(8)
    v_fma_f32 v92, v92, v60, v68
    v_fma_f32 v93, v93, v61, v69
    v_fma_f32 v94, v94, v62, v70
    v_fma_f32 v95, v95, v63, v71
    v_mfma_f32_16x16x32_bf16 a[36:39], a[16:19], v[52:55], a[36:39]
    v_cvt_pk_bf16_f32 v42, v92, v93
    v_cvt_pk_bf16_f32 v43, v94, v95
    v_lshlrev_b32 v88, 16, v132
    v_and_b32 v89, 0xffff0000, v132
    v_lshlrev_b32 v90, 16, v133
    v_and_b32 v91, 0xffff0000, v133
    v_mfma_f32_16x16x32_bf16 a[44:47], a[20:23], v[52:55], a[44:47]
    v_fma_f32 v88, v88, v56, v64
    v_fma_f32 v89, v89, v57, v65
    v_fma_f32 v90, v90, v58, v66
    v_fma_f32 v91, v91, v59, v67
    v_cvt_pk_bf16_f32 v44, v88, v89
    v_cvt_pk_bf16_f32 v45, v90, v91
    v_lshlrev_b32 v92, 16, v134
    v_mfma_f32_16x16x32_bf16 a[52:55], a[24:27], v[52:55], a[52:55]
    v_and_b32 v93, 0xffff0000, v134
    v_lshlrev_b32 v94, 16, v135
    v_and_b32 v95, 0xffff0000, v135
    v_fma_f32 v92, v92, v60, v68
    v_fma_f32 v93, v93, v61, v69
    v_fma_f32 v94, v94, v62, v70
    v_mfma_f32_16x16x32_bf16 a[60:63], a[28:31], v[52:55], a[60:63]
    v_fma_f32 v95, v95, v63, v71
    v_cvt_pk_bf16_f32 v46, v92, v93
    v_cvt_pk_bf16_f32 v47, v94, v95
    ds_read_b128 v[72:75], v35 offset:1408
    ds_read_b128 v[80:83], v35 offset:9600
    ds_read_b128 v[76:79], v35 offset:1472
    ds_read_b128 v[84:87], v35 offset:9664
    s_waitcnt lgkmcnt(10)
    v_mfma_f32_16x16x32_bf16 a[32:35], a[0:3], v[40:43], a[32:35]
    s_waitcnt vmcnt(12)
    s_barrier
    ds_read_b64_tr_b16 a[16:17], v36 offset:8192
    ds_read_b64_tr_b16 a[18:19], v36 offset:10240
    ds_read_b64_tr_b16 a[20:21], v37 offset:8192
    ds_read_b64_tr_b16 a[22:23], v37 offset:10240
    ds_read_b64_tr_b16 a[24:25], v38 offset:8192
    s_waitcnt lgkmcnt(13)
    v_mfma_f32_16x16x32_bf16 a[40:43], a[4:7], v[40:43], a[40:43]
    ds_read_b64_tr_b16 a[26:27], v38 offset:10240
    ds_read_b64_tr_b16 a[28:29], v39 offset:8192
    s_waitcnt lgkmcnt(13)
    ds_read_b64_tr_b16 a[30:31], v39 offset:10240
    v_lshlrev_b32 v88, 16, v136
    v_and_b32 v89, 0xffff0000, v136
    v_lshlrev_b32 v90, 16, v137
    v_and_b32 v91, 0xffff0000, v137
    v_mfma_f32_16x16x32_bf16 a[48:51], a[8:11], v[40:43], a[48:51]
    s_waitcnt lgkmcnt(10)
    v_fma_f32 v88, v88, v72, v80
    v_fma_f32 v89, v89, v73, v81
    v_fma_f32 v90, v90, v74, v82
    v_fma_f32 v91, v91, v75, v83
    v_cvt_pk_bf16_f32 v48, v88, v89
    v_cvt_pk_bf16_f32 v49, v90, v91
    v_lshlrev_b32 v92, 16, v138
    v_mfma_f32_16x16x32_bf16 a[56:59], a[12:15], v[40:43], a[56:59]
    v_and_b32 v93, 0xffff0000, v138
    v_lshlrev_b32 v94, 16, v139
    v_and_b32 v95, 0xffff0000, v139
    s_waitcnt lgkmcnt(8)
    v_fma_f32 v92, v92, v76, v84
    v_fma_f32 v93, v93, v77, v85
    v_fma_f32 v94, v94, v78, v86
    v_fma_f32 v95, v95, v79, v87
    v_mfma_f32_16x16x32_bf16 a[36:39], a[0:3], v[44:47], a[36:39]
    v_cvt_pk_bf16_f32 v50, v92, v93
    v_cvt_pk_bf16_f32 v51, v94, v95
    v_lshlrev_b32 v88, 16, v140
    v_and_b32 v89, 0xffff0000, v140
    s_lshr_b32 s44, s2, 3
    s_bfe_u32 s45, s2, 0x20001
    s_lshl_b32 s44, s44, 6
    s_lshl_b32 s46, s22, 3
    s_add_u32 s44, s44, s46
    v_and_b32 v98, 7, v1
    v_add_u32 v98, s44, v98
    v_lshlrev_b32 v98, 12, v98
    v_lshl_add_u32 v98, v3, 7, v98
    s_lshl_b32 s45, s45, 10
    v_add_u32 v98, s45, v98
    s_and_b32 s93, s93, 0xffff
    s_mov_b32 s94, 0x700000
    s_mov_b32 s95, 0x00020000
    v_lshlrev_b32 v90, 16, v141
    v_and_b32 v91, 0xffff0000, v141
    v_mfma_f32_16x16x32_bf16 a[44:47], a[4:7], v[44:47], a[44:47]
    v_fma_f32 v88, v88, v72, v80
    v_fma_f32 v89, v89, v73, v81
    v_fma_f32 v90, v90, v74, v82
    v_fma_f32 v91, v91, v75, v83
    v_cvt_pk_bf16_f32 v52, v88, v89
    v_cvt_pk_bf16_f32 v53, v90, v91
    v_lshlrev_b32 v92, 16, v142
    v_mfma_f32_16x16x32_bf16 a[52:55], a[8:11], v[44:47], a[52:55]
    v_and_b32 v93, 0xffff0000, v142
    v_lshlrev_b32 v94, 16, v143
    v_and_b32 v95, 0xffff0000, v143
    v_fma_f32 v92, v92, v76, v84
    v_fma_f32 v93, v93, v77, v85
    v_fma_f32 v94, v94, v78, v86
    v_fma_f32 v95, v95, v79, v87
    v_mfma_f32_16x16x32_bf16 a[60:63], a[12:15], v[44:47], a[60:63]
    v_cvt_pk_bf16_f32 v54, v92, v93
    v_cvt_pk_bf16_f32 v55, v94, v95
    ds_read_b128 v[56:59], v35 offset:1536
    ds_read_b128 v[64:67], v35 offset:9728
    ds_read_b128 v[60:63], v35 offset:1600
    ds_read_b128 v[68:71], v35 offset:9792
    buffer_load_dword v99, v98, s[92:95], 0 offen
    s_waitcnt lgkmcnt(10)
    v_mfma_f32_16x16x32_bf16 a[32:35], a[16:19], v[48:51], a[32:35]
    ds_read_b64_tr_b16 a[0:1], v36 offset:12288
    ds_read_b64_tr_b16 a[2:3], v36 offset:14336
    ds_read_b64_tr_b16 a[4:5], v37 offset:12288
    ds_read_b64_tr_b16 a[6:7], v37 offset:14336
    ds_read_b64_tr_b16 a[8:9], v38 offset:12288
    s_waitcnt lgkmcnt(13)
    ds_read_b64_tr_b16 a[10:11], v38 offset:14336
    v_mfma_f32_16x16x32_bf16 a[40:43], a[20:23], v[48:51], a[40:43]
    ds_read_b64_tr_b16 a[12:13], v39 offset:12288
    s_waitcnt lgkmcnt(13)
    ds_read_b64_tr_b16 a[14:15], v39 offset:14336
    v_lshlrev_b32 v88, 16, v144
    v_and_b32 v89, 0xffff0000, v144
    v_lshlrev_b32 v90, 16, v145
    v_and_b32 v91, 0xffff0000, v145
    s_waitcnt lgkmcnt(10)
    v_fma_f32 v88, v88, v56, v64
    v_mfma_f32_16x16x32_bf16 a[48:51], a[24:27], v[48:51], a[48:51]
    v_fma_f32 v89, v89, v57, v65
    v_fma_f32 v90, v90, v58, v66
    v_fma_f32 v91, v91, v59, v67
    v_cvt_pk_bf16_f32 v40, v88, v89
    v_cvt_pk_bf16_f32 v41, v90, v91
    v_lshlrev_b32 v92, 16, v146
    v_mfma_f32_16x16x32_bf16 a[56:59], a[28:31], v[48:51], a[56:59]
    v_and_b32 v93, 0xffff0000, v146
    v_lshlrev_b32 v94, 16, v147
    v_and_b32 v95, 0xffff0000, v147
    s_waitcnt lgkmcnt(8)
    v_fma_f32 v92, v92, v60, v68
    v_fma_f32 v93, v93, v61, v69
    v_fma_f32 v94, v94, v62, v70
    v_fma_f32 v95, v95, v63, v71
    v_mfma_f32_16x16x32_bf16 a[36:39], a[16:19], v[52:55], a[36:39]
    v_cvt_pk_bf16_f32 v42, v92, v93
    v_cvt_pk_bf16_f32 v43, v94, v95
    v_lshlrev_b32 v88, 16, v148
    v_and_b32 v89, 0xffff0000, v148
    v_lshlrev_b32 v90, 16, v149
    v_and_b32 v91, 0xffff0000, v149
    v_mfma_f32_16x16x32_bf16 a[44:47], a[20:23], v[52:55], a[44:47]
    v_fma_f32 v88, v88, v56, v64
    v_fma_f32 v89, v89, v57, v65
    v_fma_f32 v90, v90, v58, v66
    v_fma_f32 v91, v91, v59, v67
    v_cvt_pk_bf16_f32 v44, v88, v89
    v_cvt_pk_bf16_f32 v45, v90, v91
    v_lshlrev_b32 v92, 16, v150
    v_mfma_f32_16x16x32_bf16 a[52:55], a[24:27], v[52:55], a[52:55]
    v_and_b32 v93, 0xffff0000, v150
    v_lshlrev_b32 v94, 16, v151
    v_and_b32 v95, 0xffff0000, v151
    v_fma_f32 v92, v92, v60, v68
    v_fma_f32 v93, v93, v61, v69
    v_fma_f32 v94, v94, v62, v70
    v_mfma_f32_16x16x32_bf16 a[60:63], a[28:31], v[52:55], a[60:63]
    v_fma_f32 v95, v95, v63, v71
    v_cvt_pk_bf16_f32 v46, v92, v93
    v_cvt_pk_bf16_f32 v47, v94, v95
    ds_read_b128 v[72:75], v35 offset:1664
    ds_read_b128 v[80:83], v35 offset:9856
    ds_read_b128 v[76:79], v35 offset:1728
    ds_read_b128 v[84:87], v35 offset:9920
    s_waitcnt lgkmcnt(10)
    v_mfma_f32_16x16x32_bf16 a[32:35], a[0:3], v[40:43], a[32:35]
    s_waitcnt vmcnt(5)
    s_barrier
    ds_read_b64_tr_b16 a[16:17], v36 offset:16384
    ds_read_b64_tr_b16 a[18:19], v36 offset:18432
    ds_read_b64_tr_b16 a[20:21], v37 offset:16384
    ds_read_b64_tr_b16 a[22:23], v37 offset:18432
    ds_read_b64_tr_b16 a[24:25], v38 offset:16384
    s_waitcnt lgkmcnt(13)
    v_mfma_f32_16x16x32_bf16 a[40:43], a[4:7], v[40:43], a[40:43]
    ds_read_b64_tr_b16 a[26:27], v38 offset:18432
    ds_read_b64_tr_b16 a[28:29], v39 offset:16384
    s_waitcnt lgkmcnt(13)
    ds_read_b64_tr_b16 a[30:31], v39 offset:18432
    v_lshlrev_b32 v88, 16, v152
    v_and_b32 v89, 0xffff0000, v152
    v_lshlrev_b32 v90, 16, v153
    v_and_b32 v91, 0xffff0000, v153
    v_mfma_f32_16x16x32_bf16 a[48:51], a[8:11], v[40:43], a[48:51]
    s_waitcnt lgkmcnt(10)
    v_fma_f32 v88, v88, v72, v80
    v_fma_f32 v89, v89, v73, v81
    v_fma_f32 v90, v90, v74, v82
    v_fma_f32 v91, v91, v75, v83
    v_cvt_pk_bf16_f32 v48, v88, v89
    v_cvt_pk_bf16_f32 v49, v90, v91
    v_mfma_f32_16x16x32_bf16 a[56:59], a[12:15], v[40:43], a[56:59]
    v_lshlrev_b32 v92, 16, v154
    v_and_b32 v93, 0xffff0000, v154
    v_lshlrev_b32 v94, 16, v155
    v_and_b32 v95, 0xffff0000, v155
    s_waitcnt lgkmcnt(8)
    v_fma_f32 v92, v92, v76, v84
    v_fma_f32 v93, v93, v77, v85
    v_fma_f32 v94, v94, v78, v86
    v_mfma_f32_16x16x32_bf16 a[36:39], a[0:3], v[44:47], a[36:39]
    v_fma_f32 v95, v95, v79, v87
    v_cvt_pk_bf16_f32 v50, v92, v93
    v_cvt_pk_bf16_f32 v51, v94, v95
    v_lshlrev_b32 v88, 16, v156
    v_and_b32 v89, 0xffff0000, v156
    v_lshlrev_b32 v90, 16, v157
    v_and_b32 v91, 0xffff0000, v157
    v_mfma_f32_16x16x32_bf16 a[44:47], a[4:7], v[44:47], a[44:47]
    v_fma_f32 v88, v88, v72, v80
    v_fma_f32 v89, v89, v73, v81
    v_fma_f32 v90, v90, v74, v82
    v_fma_f32 v91, v91, v75, v83
    v_cvt_pk_bf16_f32 v52, v88, v89
    v_cvt_pk_bf16_f32 v53, v90, v91
    v_mfma_f32_16x16x32_bf16 a[52:55], a[8:11], v[44:47], a[52:55]
    v_lshlrev_b32 v92, 16, v158
    v_and_b32 v93, 0xffff0000, v158
    v_lshlrev_b32 v94, 16, v159
    v_and_b32 v95, 0xffff0000, v159
    v_fma_f32 v92, v92, v76, v84
    v_fma_f32 v93, v93, v77, v85
    v_fma_f32 v94, v94, v78, v86
    v_mfma_f32_16x16x32_bf16 a[60:63], a[12:15], v[44:47], a[60:63]
    v_fma_f32 v95, v95, v79, v87
    v_cvt_pk_bf16_f32 v54, v92, v93
    v_cvt_pk_bf16_f32 v55, v94, v95
    ds_read_b128 v[56:59], v35 offset:1792
    ds_read_b128 v[64:67], v35 offset:9984
    ds_read_b128 v[60:63], v35 offset:1856
    ds_read_b128 v[68:71], v35 offset:10048
    s_waitcnt lgkmcnt(10)
    v_mfma_f32_16x16x32_bf16 a[32:35], a[16:19], v[48:51], a[32:35]
    ds_read_b64_tr_b16 a[0:1], v36 offset:20480
    ds_read_b64_tr_b16 a[2:3], v36 offset:22528
    ds_read_b64_tr_b16 a[4:5], v37 offset:20480
    ds_read_b64_tr_b16 a[6:7], v37 offset:22528
    ds_read_b64_tr_b16 a[8:9], v38 offset:20480
    s_waitcnt lgkmcnt(13)
    ds_read_b64_tr_b16 a[10:11], v38 offset:22528
    v_mfma_f32_16x16x32_bf16 a[40:43], a[20:23], v[48:51], a[40:43]
    ds_read_b64_tr_b16 a[12:13], v39 offset:20480
    s_waitcnt lgkmcnt(13)
    ds_read_b64_tr_b16 a[14:15], v39 offset:22528
    v_lshlrev_b32 v88, 16, v160
    v_and_b32 v89, 0xffff0000, v160
    v_lshlrev_b32 v90, 16, v161
    v_and_b32 v91, 0xffff0000, v161
    s_waitcnt lgkmcnt(10)
    v_fma_f32 v88, v88, v56, v64
    v_mfma_f32_16x16x32_bf16 a[48:51], a[24:27], v[48:51], a[48:51]
    v_fma_f32 v89, v89, v57, v65
    v_fma_f32 v90, v90, v58, v66
    v_fma_f32 v91, v91, v59, v67
    v_cvt_pk_bf16_f32 v40, v88, v89
    v_cvt_pk_bf16_f32 v41, v90, v91
    v_lshlrev_b32 v92, 16, v162
    v_mfma_f32_16x16x32_bf16 a[56:59], a[28:31], v[48:51], a[56:59]
    v_and_b32 v93, 0xffff0000, v162
    v_lshlrev_b32 v94, 16, v163
    v_and_b32 v95, 0xffff0000, v163
    s_waitcnt lgkmcnt(8)
    v_fma_f32 v92, v92, v60, v68
    v_fma_f32 v93, v93, v61, v69
    v_fma_f32 v94, v94, v62, v70
    v_fma_f32 v95, v95, v63, v71
    v_mfma_f32_16x16x32_bf16 a[36:39], a[16:19], v[52:55], a[36:39]
    v_cvt_pk_bf16_f32 v42, v92, v93
    v_cvt_pk_bf16_f32 v43, v94, v95
    v_lshlrev_b32 v88, 16, v164
    v_and_b32 v89, 0xffff0000, v164
    v_lshlrev_b32 v90, 16, v165
    v_and_b32 v91, 0xffff0000, v165
    v_mfma_f32_16x16x32_bf16 a[44:47], a[20:23], v[52:55], a[44:47]
    v_fma_f32 v88, v88, v56, v64
    v_fma_f32 v89, v89, v57, v65
    v_fma_f32 v90, v90, v58, v66
    v_fma_f32 v91, v91, v59, v67
    v_cvt_pk_bf16_f32 v44, v88, v89
    v_cvt_pk_bf16_f32 v45, v90, v91
    v_lshlrev_b32 v92, 16, v166
    v_mfma_f32_16x16x32_bf16 a[52:55], a[24:27], v[52:55], a[52:55]
    v_and_b32 v93, 0xffff0000, v166
    v_lshlrev_b32 v94, 16, v167
    v_and_b32 v95, 0xffff0000, v167
    v_fma_f32 v92, v92, v60, v68
    v_fma_f32 v93, v93, v61, v69
    v_fma_f32 v94, v94, v62, v70
    v_mfma_f32_16x16x32_bf16 a[60:63], a[28:31], v[52:55], a[60:63]
    v_fma_f32 v95, v95, v63, v71
    v_cvt_pk_bf16_f32 v46, v92, v93
    v_cvt_pk_bf16_f32 v47, v94, v95
    ds_read_b128 v[72:75], v35 offset:1920
    ds_read_b128 v[80:83], v35 offset:10112
    ds_read_b128 v[76:79], v35 offset:1984
    ds_read_b128 v[84:87], v35 offset:10176
    s_waitcnt lgkmcnt(10)
    v_mfma_f32_16x16x32_bf16 a[32:35], a[0:3], v[40:43], a[32:35]
    s_waitcnt vmcnt(1)
    s_barrier
    ds_read_b64_tr_b16 a[16:17], v36 offset:24576
    ds_read_b64_tr_b16 a[18:19], v36 offset:26624
    ds_read_b64_tr_b16 a[20:21], v37 offset:24576
    ds_read_b64_tr_b16 a[22:23], v37 offset:26624
    ds_read_b64_tr_b16 a[24:25], v38 offset:24576
    s_waitcnt lgkmcnt(13)
    v_mfma_f32_16x16x32_bf16 a[40:43], a[4:7], v[40:43], a[40:43]
    ds_read_b64_tr_b16 a[26:27], v38 offset:26624
    ds_read_b64_tr_b16 a[28:29], v39 offset:24576
    s_waitcnt lgkmcnt(13)
    ds_read_b64_tr_b16 a[30:31], v39 offset:26624
    v_lshlrev_b32 v88, 16, v168
    v_and_b32 v89, 0xffff0000, v168
    v_lshlrev_b32 v90, 16, v169
    v_mfma_f32_16x16x32_bf16 a[48:51], a[8:11], v[40:43], a[48:51]
    v_and_b32 v91, 0xffff0000, v169
    s_waitcnt lgkmcnt(10)
    v_fma_f32 v88, v88, v72, v80
    v_fma_f32 v89, v89, v73, v81
    v_fma_f32 v90, v90, v74, v82
    v_fma_f32 v91, v91, v75, v83
    v_cvt_pk_bf16_f32 v48, v88, v89
    v_mfma_f32_16x16x32_bf16 a[56:59], a[12:15], v[40:43], a[56:59]
    v_cvt_pk_bf16_f32 v49, v90, v91
    v_lshlrev_b32 v92, 16, v170
    v_and_b32 v93, 0xffff0000, v170
    v_lshlrev_b32 v94, 16, v171
    v_and_b32 v95, 0xffff0000, v171
    s_waitcnt lgkmcnt(8)
    v_fma_f32 v92, v92, v76, v84
    v_mfma_f32_16x16x32_bf16 a[36:39], a[0:3], v[44:47], a[36:39]
    v_fma_f32 v93, v93, v77, v85
    v_fma_f32 v94, v94, v78, v86
    v_fma_f32 v95, v95, v79, v87
    v_cvt_pk_bf16_f32 v50, v92, v93
    v_cvt_pk_bf16_f32 v51, v94, v95
    v_lshlrev_b32 v88, 16, v172
    v_mfma_f32_16x16x32_bf16 a[44:47], a[4:7], v[44:47], a[44:47]
    v_and_b32 v89, 0xffff0000, v172
    v_lshlrev_b32 v90, 16, v173
    v_and_b32 v91, 0xffff0000, v173
    v_fma_f32 v88, v88, v72, v80
    v_fma_f32 v89, v89, v73, v81
    v_fma_f32 v90, v90, v74, v82
    v_mfma_f32_16x16x32_bf16 a[52:55], a[8:11], v[44:47], a[52:55]
    v_fma_f32 v91, v91, v75, v83
    v_cvt_pk_bf16_f32 v52, v88, v89
    v_cvt_pk_bf16_f32 v53, v90, v91
    v_lshlrev_b32 v92, 16, v174
    v_and_b32 v93, 0xffff0000, v174
    v_lshlrev_b32 v94, 16, v175
    v_mfma_f32_16x16x32_bf16 a[60:63], a[12:15], v[44:47], a[60:63]
    v_and_b32 v95, 0xffff0000, v175
    v_fma_f32 v92, v92, v76, v84
    v_fma_f32 v93, v93, v77, v85
    v_fma_f32 v94, v94, v78, v86
    v_fma_f32 v95, v95, v79, v87
    v_cvt_pk_bf16_f32 v54, v92, v93
    v_cvt_pk_bf16_f32 v55, v94, v95
    s_waitcnt lgkmcnt(6)
    v_mfma_f32_16x16x32_bf16 a[32:35], a[16:19], v[48:51], a[32:35]
    s_waitcnt lgkmcnt(4)
    v_mfma_f32_16x16x32_bf16 a[40:43], a[20:23], v[48:51], a[40:43]
    s_waitcnt lgkmcnt(2)
    v_mfma_f32_16x16x32_bf16 a[48:51], a[24:27], v[48:51], a[48:51]
    s_waitcnt lgkmcnt(0)
    v_mfma_f32_16x16x32_bf16 a[56:59], a[28:31], v[48:51], a[56:59]
    v_mfma_f32_16x16x32_bf16 a[36:39], a[16:19], v[52:55], a[36:39]
    v_mfma_f32_16x16x32_bf16 a[44:47], a[20:23], v[52:55], a[44:47]
    v_mfma_f32_16x16x32_bf16 a[52:55], a[24:27], v[52:55], a[52:55]
    v_mfma_f32_16x16x32_bf16 a[60:63], a[28:31], v[52:55], a[60:63]
    v_lshlrev_b32 v34, 4, v1
    s_lshl_b32 s35, s48, 13
    s_add_u32 s34, s31, s35
    s_add_u32 s34, s34, 0
    v_add_u32 v33, s34, v34
    ds_write_b128 v33, a[32:35] offset:0
    ds_write_b128 v33, a[36:39] offset:2048
    ds_write_b128 v33, a[40:43] offset:1024
    ds_write_b128 v33, a[44:47] offset:3072
    ds_write_b128 v33, a[48:51] offset:4096
    ds_write_b128 v33, a[52:55] offset:6144
    ds_write_b128 v33, a[56:59] offset:5120
    ds_write_b128 v33, a[60:63] offset:7168
    s_waitcnt lgkmcnt(0)
    s_barrier
    s_lshl_b32 s34, s47, 11
    s_add_u32 s34, s34, s35
    s_add_u32 s34, s34, 0
    v_add_u32 v33, s34, v34
    v_add_u32 v35, 73728, v33
    ds_read_b128 v[40:43], v33 offset:0
    ds_read_b128 v[48:51], v33 offset:36864
    ds_read_b128 v[56:59], v35 offset:0
    ds_read_b128 v[64:67], v35 offset:36864
    ds_read_b128 v[44:47], v33 offset:1024
    ds_read_b128 v[52:55], v33 offset:37888
    ds_read_b128 v[60:63], v35 offset:1024
    ds_read_b128 v[68:71], v35 offset:37888
    s_waitcnt lgkmcnt(6)
    v_add_f32 v40, v40, v48
    s_waitcnt lgkmcnt(4)
    v_add_f32 v56, v56, v64
    v_add_f32 v41, v41, v49
    v_add_f32 v57, v57, v65
    v_add_f32 v42, v42, v50
    v_add_f32 v58, v58, v66
    v_add_f32 v43, v43, v51
    v_add_f32 v59, v59, v67
    v_add_f32 v40, v40, v56
    v_add_f32 v41, v41, v57
    v_add_f32 v42, v42, v58
    v_add_f32 v43, v43, v59
    s_waitcnt lgkmcnt(2)
    v_add_f32 v44, v44, v52
    s_waitcnt lgkmcnt(0)
    v_add_f32 v60, v60, v68
    v_add_f32 v45, v45, v53
    v_add_f32 v61, v61, v69
    v_add_f32 v46, v46, v54
    v_add_f32 v62, v62, v70
    v_add_f32 v47, v47, v55
    v_add_f32 v63, v63, v71
    v_add_f32 v44, v44, v60
    v_add_f32 v45, v45, v61
    v_add_f32 v46, v46, v62
    v_add_f32 v47, v47, v63
    v_lshlrev_b32 v76, 16, v100
    v_and_b32 v77, 0xffff0000, v100
    v_lshlrev_b32 v78, 16, v101
    v_and_b32 v79, 0xffff0000, v101
    v_lshlrev_b32 v80, 16, v102
    v_and_b32 v81, 0xffff0000, v102
    v_lshlrev_b32 v82, 16, v103
    v_and_b32 v83, 0xffff0000, v103
    s_mov_b32 s39, 0xc0135761
    s_mov_b32 s40, 0xbdd2d3e8
    v_mov_b32 v84, s39
    v_add_f32 v40, v40, v76
    v_mul_f32 v85, v40, v40
    v_fma_f32 v85, v85, s40, v84
    v_mul_f32 v85, v85, v40
    v_exp_f32 v85, v85
    s_nop 0
    v_add_f32 v85, 1.0, v85
    v_rcp_f32 v85, v85
    s_nop 0
    v_mul_f32 v40, v40, v85
    v_add_f32 v41, v41, v77
    v_mul_f32 v86, v41, v41
    v_fma_f32 v86, v86, s40, v84
    v_mul_f32 v86, v86, v41
    v_exp_f32 v86, v86
    s_nop 0
    v_add_f32 v86, 1.0, v86
    v_rcp_f32 v86, v86
    s_nop 0
    v_mul_f32 v41, v41, v86
    v_add_f32 v42, v42, v78
    v_mul_f32 v85, v42, v42
    v_fma_f32 v85, v85, s40, v84
    v_mul_f32 v85, v85, v42
    v_exp_f32 v85, v85
    s_nop 0
    v_add_f32 v85, 1.0, v85
    v_rcp_f32 v85, v85
    s_nop 0
    v_mul_f32 v42, v42, v85
    v_add_f32 v43, v43, v79
    v_mul_f32 v86, v43, v43
    v_fma_f32 v86, v86, s40, v84
    v_mul_f32 v86, v86, v43
    v_exp_f32 v86, v86
    s_nop 0
    v_add_f32 v86, 1.0, v86
    v_rcp_f32 v86, v86
    s_nop 0
    v_mul_f32 v43, v43, v86
    v_add_f32 v44, v44, v80
    v_mul_f32 v85, v44, v44
    v_fma_f32 v85, v85, s40, v84
    v_mul_f32 v85, v85, v44
    v_exp_f32 v85, v85
    s_nop 0
    v_add_f32 v85, 1.0, v85
    v_rcp_f32 v85, v85
    s_nop 0
    v_mul_f32 v44, v44, v85
    v_add_f32 v45, v45, v81
    v_mul_f32 v86, v45, v45
    v_fma_f32 v86, v86, s40, v84
    v_mul_f32 v86, v86, v45
    v_exp_f32 v86, v86
    s_nop 0
    v_add_f32 v86, 1.0, v86
    v_rcp_f32 v86, v86
    s_nop 0
    v_mul_f32 v45, v45, v86
    v_add_f32 v46, v46, v82
    v_mul_f32 v85, v46, v46
    v_fma_f32 v85, v85, s40, v84
    v_mul_f32 v85, v85, v46
    v_exp_f32 v85, v85
    s_nop 0
    v_add_f32 v85, 1.0, v85
    v_rcp_f32 v85, v85
    s_nop 0
    v_mul_f32 v46, v46, v85
    v_add_f32 v47, v47, v83
    v_mul_f32 v86, v47, v47
    v_fma_f32 v86, v86, s40, v84
    v_mul_f32 v86, v86, v47
    v_exp_f32 v86, v86
    s_nop 0
    v_add_f32 v86, 1.0, v86
    v_rcp_f32 v86, v86
    s_nop 0
    v_mul_f32 v47, v47, v86
    v_cvt_pk_bf16_f32 v88, v40, v41
    v_cvt_pk_bf16_f32 v89, v42, v43
    v_cvt_pk_bf16_f32 v90, v44, v45
    v_cvt_pk_bf16_f32 v91, v46, v47
    s_mul_i32 s41, s24, 56
    s_lshl_b32 s42, s23, 1
    s_add_u32 s41, s41, s42
    s_add_u32 s41, s41, s36
    s_mul_i32 s41, s41, 3584
    s_add_u32 s41, s41, 0x2c00000
    s_and_b32 s42, s47, 1
    s_lshl_b32 s43, s48, 1
    s_add_u32 s42, s42, s43
    s_lshl_b32 s43, s42, 10
    s_add_u32 s41, s41, s43
    s_cmp_eq_u32 s42, 3
    s_cselect_b32 s44, 0x00ff00ff, -1
    s_mov_b32 s45, s44
    s_mov_b64 exec, s[44:45]
    buffer_store_dwordx4 v[88:91], v6, s[8:11], s41 offen sc0 sc1
    s_mov_b64 exec, -1
    s_lshl_b32 s34, s24, 7
    s_add_u32 s34, s34, 0x100c400
    s_waitcnt vmcnt(0) lgkmcnt(0)
    s_barrier
    v_mov_b32 v10, 0
    v_mov_b32 v11, 1
    v_cmp_eq_u32 vcc, 0, v0
    s_and_saveexec_b64 s[44:45], vcc
    s_cbranch_execz L_pub20
    buffer_atomic_add v11, v10, s[8:11], s34 offen sc1
L_pub20:
    s_mov_b64 exec, -1
L_pg1b_skip:
    s_branch L_pg1b_go
L_pk3b_idle:
    s_nop 1
    s_load_dwordx2 s[48:49], s[0:1], 32
    s_load_dwordx2 s[52:53], s[0:1], 48
    v_and_b32 v1, 63, v0
    v_lshrrev_b32 v2, 6, v0
    s_nop 0
    v_readfirstlane_b32 s22, v2
    s_lshr_b32 s34, s2, 3
    s_sub_u32 s34, s34, 28
    s_lshl_b32 s34, s34, 3
    s_add_u32 s34, s34, s22
    s_bfe_u32 s36, s2, 0x20001
    s_waitcnt lgkmcnt(0)
    s_and_b32 s49, s49, 0xffff
    s_mov_b32 s50, 0x700000
    s_mov_b32 s51, 0x00020000
    s_and_b32 s53, s53, 0xffff
    s_mov_b32 s54, 0x700000
    s_mov_b32 s55, 0x00020000
    s_mul_i32 s35, s34, 448
    s_mul_i32 s37, s36, 896
    s_add_u32 s38, s35, 0
    v_add_u32 v10, s38, v1
    s_mov_b32 s39, 149797
    v_mul_lo_u32 v11, v10, s39
    v_lshrrev_b32 v11, 20, v11
    v_mul_u32_u24 v12, 7, v11
    v_sub_u32 v12, v10, v12
    v_mul_u32_u24 v11, 3584, v11
    v_lshl_add_u32 v11, v12, 7, v11
    buffer_load_dword v13, v11, s[48:51], s37 offen
    s_add_u32 s38, s35, 64
    v_add_u32 v10, s38, v1
    s_mov_b32 s39, 149797
    v_mul_lo_u32 v11, v10, s39
    v_lshrrev_b32 v11, 20, v11
    v_mul_u32_u24 v12, 7, v11
    v_sub_u32 v12, v10, v12
    v_mul_u32_u24 v11, 3584, v11
    v_lshl_add_u32 v11, v12, 7, v11
    buffer_load_dword v13, v11, s[48:51], s37 offen
    s_add_u32 s38, s35, 128
    v_add_u32 v10, s38, v1
    s_mov_b32 s39, 149797
    v_mul_lo_u32 v11, v10, s39
    v_lshrrev_b32 v11, 20, v11
    v_mul_u32_u24 v12, 7, v11
    v_sub_u32 v12, v10, v12
    v_mul_u32_u24 v11, 3584, v11
    v_lshl_add_u32 v11, v12, 7, v11
    buffer_load_dword v13, v11, s[48:51], s37 offen
    s_add_u32 s38, s35, 192
    v_add_u32 v10, s38, v1
    s_mov_b32 s39, 149797
    v_mul_lo_u32 v11, v10, s39
    v_lshrrev_b32 v11, 20, v11
    v_mul_u32_u24 v12, 7, v11
    v_sub_u32 v12, v10, v12
    v_mul_u32_u24 v11, 3584, v11
    v_lshl_add_u32 v11, v12, 7, v11
    buffer_load_dword v13, v11, s[48:51], s37 offen
    s_add_u32 s38, s35, 256
    v_add_u32 v10, s38, v1
    s_mov_b32 s39, 149797
    v_mul_lo_u32 v11, v10, s39
    v_lshrrev_b32 v11, 20, v11
    v_mul_u32_u24 v12, 7, v11
    v_sub_u32 v12, v10, v12
    v_mul_u32_u24 v11, 3584, v11
    v_lshl_add_u32 v11, v12, 7, v11
    buffer_load_dword v13, v11, s[48:51], s37 offen
    s_add_u32 s38, s35, 320
    v_add_u32 v10, s38, v1
    s_mov_b32 s39, 149797
    v_mul_lo_u32 v11, v10, s39
    v_lshrrev_b32 v11, 20, v11
    v_mul_u32_u24 v12, 7, v11
    v_sub_u32 v12, v10, v12
    v_mul_u32_u24 v11, 3584, v11
    v_lshl_add_u32 v11, v12, 7, v11
    buffer_load_dword v13, v11, s[48:51], s37 offen
    s_add_u32 s38, s35, 384
    v_add_u32 v10, s38, v1
    s_mov_b32 s39, 149797
    v_mul_lo_u32 v11, v10, s39
    v_lshrrev_b32 v11, 20, v11
    v_mul_u32_u24 v12, 7, v11
    v_sub_u32 v12, v10, v12
    v_mul_u32_u24 v11, 3584, v11
    v_lshl_add_u32 v11, v12, 7, v11
    buffer_load_dword v13, v11, s[48:51], s37 offen
    s_mul_i32 s35, s34, 448
    s_lshl_b32 s37, s36, 10
    s_add_u32 s38, s35, 0
    v_add_u32 v10, s38, v1
    v_lshrrev_b32 v11, 3, v10
    v_lshlrev_b32 v11, 12, v11
    v_and_b32 v12, 7, v10
    v_lshl_add_u32 v11, v12, 7, v11
    buffer_load_dword v13, v11, s[52:55], s37 offen
    s_add_u32 s38, s35, 64
    v_add_u32 v10, s38, v1
    v_lshrrev_b32 v11, 3, v10
    v_lshlrev_b32 v11, 12, v11
    v_and_b32 v12, 7, v10
    v_lshl_add_u32 v11, v12, 7, v11
    buffer_load_dword v13, v11, s[52:55], s37 offen
    s_add_u32 s38, s35, 128
    v_add_u32 v10, s38, v1
    v_lshrrev_b32 v11, 3, v10
    v_lshlrev_b32 v11, 12, v11
    v_and_b32 v12, 7, v10
    v_lshl_add_u32 v11, v12, 7, v11
    buffer_load_dword v13, v11, s[52:55], s37 offen
    s_add_u32 s38, s35, 192
    v_add_u32 v10, s38, v1
    v_lshrrev_b32 v11, 3, v10
    v_lshlrev_b32 v11, 12, v11
    v_and_b32 v12, 7, v10
    v_lshl_add_u32 v11, v12, 7, v11
    buffer_load_dword v13, v11, s[52:55], s37 offen
    s_add_u32 s38, s35, 256
    v_add_u32 v10, s38, v1
    v_lshrrev_b32 v11, 3, v10
    v_lshlrev_b32 v11, 12, v11
    v_and_b32 v12, 7, v10
    v_lshl_add_u32 v11, v12, 7, v11
    buffer_load_dword v13, v11, s[52:55], s37 offen
    s_add_u32 s38, s35, 320
    v_add_u32 v10, s38, v1
    v_lshrrev_b32 v11, 3, v10
    v_lshlrev_b32 v11, 12, v11
    v_and_b32 v12, 7, v10
    v_lshl_add_u32 v11, v12, 7, v11
    buffer_load_dword v13, v11, s[52:55], s37 offen
    s_add_u32 s38, s35, 384
    v_add_u32 v10, s38, v1
    v_lshrrev_b32 v11, 3, v10
    v_lshlrev_b32 v11, 12, v11
    v_and_b32 v12, 7, v10
    v_lshl_add_u32 v11, v12, 7, v11
    buffer_load_dword v13, v11, s[52:55], s37 offen
L_pg1b_go:
    s_nop 1
    s_load_dwordx2 s[20:21], s[0:1], 80
    s_load_dwordx2 s[4:5], s[0:1], 48
    s_load_dwordx2 s[12:13], s[0:1], 56
    s_load_dwordx2 s[16:17], s[0:1], 64
    v_and_b32 v1, 63, v0
    v_lshrrev_b32 v2, 6, v0
    s_nop 0
    v_readfirstlane_b32 s22, v2
    s_and_b32 s25, s2, 7
    s_lshr_b32 s26, s2, 3
    s_and_b32 s24, s25, 1
    s_lshl_b32 s24, s24, 2
    s_and_b32 s27, s26, 3
    s_add_u32 s24, s24, s27
    s_lshr_b32 s23, s25, 1
    s_mul_i32 s23, s23, 8
    s_lshr_b32 s27, s26, 2
    s_add_u32 s23, s23, s27
    s_and_b32 s47, s22, 3
    s_lshr_b32 s48, s22, 2
    v_lshrrev_b32 v3, 3, v1
    v_bfe_u32 v4, v1, 4, 2
    v_lshlrev_b32 v4, 1, v4
    v_and_b32 v5, 7, v1
    v_xor_b32 v4, v4, v5
    v_mul_u32_u24 v5, 4096, v3
    v_lshl_add_u32 v5, v4, 4, v5
    s_mul_i32 s27, s47, 1835008
    s_mul_i32 s28, s48, 65536
    s_add_u32 s27, s27, s28
    s_lshl_b32 s28, s23, 7
    s_add_u32 s27, s27, s28
    v_add_u32 v5, s27, v5
    v_lshrrev_b32 v7, 4, v1
    v_and_b32 v8, 7, v1
    v_lshlrev_b32 v8, 4, v8
    v_lshl_add_u32 v8, v7, 7, v8
    v_bfe_u32 v9, v1, 3, 1
    v_lshl_add_u32 v6, v9, 9, v8
    s_cmp_eq_u32 s48, 0
    s_cselect_b64 s[50:51], -1, 0
    v_cndmask_b32 v9, v8, v6, s[50:51]
    s_waitcnt lgkmcnt(0)
    s_and_b32 s5, s5, 0xffff
    s_mov_b32 s6, 0x700000
    s_mov_b32 s7, 0x00020000
    s_mov_b32 s8, s20
    s_and_b32 s9, s21, 0xffff
    s_mov_b32 s10, 0x4000000
    s_mov_b32 s11, 0x00020000
    s_and_b32 s13, s13, 0xffff
    s_mov_b32 s14, 0x1000
    s_mov_b32 s15, 0x00020000
    s_and_b32 s17, s17, 0xffff
    s_mov_b32 s18, 0x1c0000
    s_mov_b32 s19, 0x00020000
    s_mul_i32 s29, s24, 56
    s_mul_i32 s30, s47, 14
    s_add_u32 s29, s29, s30
    s_mul_i32 s29, s29, 3584
    s_add_u32 s29, s29, 0x2c00000
    s_lshl_b32 s30, s48, 11
    s_add_u32 s29, s29, s30
    s_mul_i32 s31, s47, 36864
    s_lshl_b32 s30, s48, 11
    s_add_u32 s49, s31, s30
    v_add_u32 v4, 31744, v5
    s_add_u32 m0, s49, 0
    s_mov_b32 s32, 0
    buffer_load_dwordx4 v5, s[4:7], s32 offen sc1 lds
    buffer_load_dwordx4 v4, s[4:7], s32 offen offset:1024 sc1 lds
    s_add_u32 m0, s49, 4096
    s_mov_b32 s32, 131072
    buffer_load_dwordx4 v5, s[4:7], s32 offen sc1 lds
    buffer_load_dwordx4 v4, s[4:7], s32 offen offset:1024 sc1 lds
    s_add_u32 m0, s49, 8192
    s_mov_b32 s32, 262144
    buffer_load_dwordx4 v5, s[4:7], s32 offen sc1 lds
    buffer_load_dwordx4 v4, s[4:7], s32 offen offset:1024 sc1 lds
    s_add_u32 m0, s49, 12288
    s_mov_b32 s32, 393216
    buffer_load_dwordx4 v5, s[4:7], s32 offen sc1 lds
    buffer_load_dwordx4 v4, s[4:7], s32 offen offset:1024 sc1 lds
    s_add_u32 m0, s49, 16384
    s_mov_b32 s32, 524288
    buffer_load_dwordx4 v5, s[4:7], s32 offen sc1 lds
    buffer_load_dwordx4 v4, s[4:7], s32 offen offset:1024 sc1 lds
    s_add_u32 m0, s49, 20480
    s_mov_b32 s32, 655360
    buffer_load_dwordx4 v5, s[4:7], s32 offen sc1 lds
    buffer_load_dwordx4 v4, s[4:7], s32 offen offset:1024 sc1 lds
    s_add_u32 m0, s49, 24576
    s_mov_b32 s32, 786432
    buffer_load_dwordx4 v5, s[4:7], s32 offen sc1 lds
    buffer_load_dwordx4 v4, s[4:7], s32 offen offset:1024 sc1 lds
    s_add_u32 m0, s49, 28672
    s_mov_b32 s32, 917504
    buffer_load_dwordx4 v5, s[4:7], s32 offen sc1 lds
    buffer_load_dwordx4 v4, s[4:7], s32 offen offset:1024 sc1 lds
    s_add_u32 m0, s49, 32768
    s_mov_b32 s32, 1048576
    buffer_load_dwordx4 v5, s[4:7], s32 offen sc1 lds
    buffer_load_dwordx4 v4, s[4:7], s32 offen offset:1024 sc1 lds
    s_lshl_b32 s34, s24, 7
    s_add_u32 s34, s34, 0x100c400
    v_mov_b32 v10, 0
    s_cmp_lg_u32 s22, 0
    s_cbranch_scc1 L_aww21
    s_mov_b64 exec, 0x1
    s_mov_b32 s45, 0x40000
L_awp21:
    buffer_load_dword v168, v10, s[8:11], s34 offen sc0 sc1
    s_waitcnt vmcnt(0)
    v_cmp_gt_u32 vcc, 28, v168
    s_cbranch_vccz L_awd21
    s_sub_u32 s45, s45, 1
    s_cmp_lg_u32 s45, 0
    s_cbranch_scc1 L_awp21
L_awd21:
    s_mov_b64 exec, -1
L_aww21:
    s_nop 0
    s_barrier
    s_add_u32 s33, s29, 0
    buffer_load_dwordx4 v[112:115], v6, s[8:11], s33 offen sc1
    buffer_load_dwordx4 v[116:119], v9, s[8:11], s33 offen offset:1024 sc1
    s_barrier
    s_add_u32 s33, s29, 3584
    buffer_load_dwordx4 v[120:123], v6, s[8:11], s33 offen sc1
    buffer_load_dwordx4 v[124:127], v9, s[8:11], s33 offen offset:1024 sc1
    s_add_u32 s33, s29, 7168
    buffer_load_dwordx4 v[128:131], v6, s[8:11], s33 offen sc1
    buffer_load_dwordx4 v[132:135], v9, s[8:11], s33 offen offset:1024 sc1
    s_add_u32 s33, s29, 10752
    buffer_load_dwordx4 v[136:139], v6, s[8:11], s33 offen sc1
    buffer_load_dwordx4 v[140:143], v9, s[8:11], s33 offen offset:1024 sc1
    s_add_u32 s33, s29, 14336
    buffer_load_dwordx4 v[144:147], v6, s[8:11], s33 offen sc1
    buffer_load_dwordx4 v[148:151], v9, s[8:11], s33 offen offset:1024 sc1
    s_add_u32 s33, s29, 17920
    buffer_load_dwordx4 v[152:155], v6, s[8:11], s33 offen sc1
    buffer_load_dwordx4 v[156:159], v9, s[8:11], s33 offen offset:1024 sc1
    s_add_u32 s33, s29, 21504
    buffer_load_dwordx4 v[160:163], v6, s[8:11], s33 offen sc1
    buffer_load_dwordx4 v[164:167], v9, s[8:11], s33 offen offset:1024 sc1
    s_lshl_b32 s36, s23, 2
    s_add_u32 s36, s36, s47
    s_mul_i32 s37, s36, 14336
    s_mul_i32 s38, s24, 1792
    s_add_u32 s37, s37, s38
    s_lshl_b32 s38, s48, 10
    s_add_u32 s37, s37, s38
    s_add_u32 s37, s37, 0x2800000
    v_and_b32 v33, 15, v1
    v_lshlrev_b32 v35, 3, v33
    v_lshl_add_u32 v35, v7, 7, v35
    buffer_load_dwordx2 v[100:101], v35, s[8:11], s37 offen offset:0 sc1
    buffer_load_dwordx2 v[102:103], v35, s[8:11], s37 offen offset:512 sc1
    s_lshl_b32 s38, s36, 5
    v_lshlrev_b32 v36, 1, v33
    buffer_load_ushort v104, v36, s[12:15], s38 offen sc1
    v_bfe_u32 v12, v1, 2, 2
    v_and_b32 v13, 3, v1
    v_and_b32 v14, 1, v7
    v_lshlrev_b32 v15, 2, v7
    v_add_u32 v15, v15, v12
    v_lshlrev_b32 v15, 7, v15
    v_lshl_add_u32 v15, v13, 3, v15
    v_add_u32 v15, s31, v15
    v_lshrrev_b32 v32, 1, v12
    v_lshl_add_u32 v32, v14, 1, v32
    v_xor_b32 v33, 0, v32
    v_lshl_add_u32 v36, v33, 5, v15
    v_xor_b32 v33, 1, v32
    v_lshl_add_u32 v37, v33, 5, v15
    v_xor_b32 v33, 2, v32
    v_lshl_add_u32 v38, v33, 5, v15
    v_xor_b32 v33, 3, v32
    v_lshl_add_u32 v39, v33, 5, v15
    s_waitcnt vmcnt(15)
    s_barrier
    ds_read_b64_tr_b16 a[0:1], v36 offset:0
    ds_read_b64_tr_b16 a[2:3], v36 offset:2048
    ds_read_b64_tr_b16 a[4:5], v37 offset:0
    ds_read_b64_tr_b16 a[6:7], v37 offset:2048
    ds_read_b64_tr_b16 a[8:9], v38 offset:0
    ds_read_b64_tr_b16 a[10:11], v38 offset:2048
    ds_read_b64_tr_b16 a[12:13], v39 offset:0
    ds_read_b64_tr_b16 a[14:15], v39 offset:2048
    s_waitcnt lgkmcnt(6)
    v_mfma_f32_16x16x32_bf16 a[32:35], v[112:115], a[0:3], 0
    s_waitcnt vmcnt(11)
    s_barrier
    s_waitcnt lgkmcnt(4)
    v_mfma_f32_16x16x32_bf16 a[40:43], v[112:115], a[4:7], 0
    ds_read_b64_tr_b16 a[16:17], v36 offset:4096
    s_waitcnt lgkmcnt(3)
    v_mfma_f32_16x16x32_bf16 a[48:51], v[112:115], a[8:11], 0
    ds_read_b64_tr_b16 a[18:19], v36 offset:6144
    ds_read_b64_tr_b16 a[20:21], v37 offset:4096
    s_waitcnt lgkmcnt(3)
    v_mfma_f32_16x16x32_bf16 a[56:59], v[112:115], a[12:15], 0
    ds_read_b64_tr_b16 a[22:23], v37 offset:6144
    v_mfma_f32_16x16x32_bf16 a[36:39], v[116:119], a[0:3], 0
    ds_read_b64_tr_b16 a[24:25], v38 offset:4096
    v_mfma_f32_16x16x32_bf16 a[44:47], v[116:119], a[4:7], 0
    ds_read_b64_tr_b16 a[26:27], v38 offset:6144
    ds_read_b64_tr_b16 a[28:29], v39 offset:4096
    v_mfma_f32_16x16x32_bf16 a[52:55], v[116:119], a[8:11], 0
    ds_read_b64_tr_b16 a[30:31], v39 offset:6144
    v_mfma_f32_16x16x32_bf16 a[60:63], v[116:119], a[12:15], 0
    s_add_u32 s33, s29, 25088
    buffer_load_dwordx4 v[168:171], v6, s[8:11], s33 offen sc1
    buffer_load_dwordx4 v[172:175], v9, s[8:11], s33 offen offset:1024 sc1
    s_waitcnt lgkmcnt(6)
    v_mfma_f32_16x16x32_bf16 a[32:35], v[120:123], a[16:19], a[32:35]
    ds_read_b64_tr_b16 a[0:1], v36 offset:8192
    s_waitcnt lgkmcnt(5)
    v_mfma_f32_16x16x32_bf16 a[40:43], v[120:123], a[20:23], a[40:43]
    ds_read_b64_tr_b16 a[2:3], v36 offset:10240
    s_waitcnt lgkmcnt(4)
    v_mfma_f32_16x16x32_bf16 a[48:51], v[120:123], a[24:27], a[48:51]
    ds_read_b64_tr_b16 a[4:5], v37 offset:8192
    s_waitcnt lgkmcnt(3)
    v_mfma_f32_16x16x32_bf16 a[56:59], v[120:123], a[28:31], a[56:59]
    ds_read_b64_tr_b16 a[6:7], v37 offset:10240
    ds_read_b64_tr_b16 a[8:9], v38 offset:8192
    v_mfma_f32_16x16x32_bf16 a[36:39], v[124:127], a[16:19], a[36:39]
    ds_read_b64_tr_b16 a[10:11], v38 offset:10240
    v_mfma_f32_16x16x32_bf16 a[44:47], v[124:127], a[20:23], a[44:47]
    ds_read_b64_tr_b16 a[12:13], v39 offset:8192
    v_mfma_f32_16x16x32_bf16 a[52:55], v[124:127], a[24:27], a[52:55]
    ds_read_b64_tr_b16 a[14:15], v39 offset:10240
    v_mfma_f32_16x16x32_bf16 a[60:63], v[124:127], a[28:31], a[60:63]
    s_add_u32 s33, s29, 28672
    buffer_load_dwordx4 v[112:115], v6, s[8:11], s33 offen sc1
    buffer_load_dwordx4 v[116:119], v9, s[8:11], s33 offen offset:1024 sc1
    s_waitcnt lgkmcnt(6)
    v_mfma_f32_16x16x32_bf16 a[32:35], v[128:131], a[0:3], a[32:35]
    s_waitcnt vmcnt(11)
    s_barrier
    s_waitcnt lgkmcnt(4)
    v_mfma_f32_16x16x32_bf16 a[40:43], v[128:131], a[4:7], a[40:43]
    ds_read_b64_tr_b16 a[16:17], v36 offset:12288
    ds_read_b64_tr_b16 a[18:19], v36 offset:14336
    s_waitcnt lgkmcnt(4)
    v_mfma_f32_16x16x32_bf16 a[48:51], v[128:131], a[8:11], a[48:51]
    ds_read_b64_tr_b16 a[20:21], v37 offset:12288
    s_waitcnt lgkmcnt(3)
    v_mfma_f32_16x16x32_bf16 a[56:59], v[128:131], a[12:15], a[56:59]
    ds_read_b64_tr_b16 a[22:23], v37 offset:14336
    ds_read_b64_tr_b16 a[24:25], v38 offset:12288
    v_mfma_f32_16x16x32_bf16 a[36:39], v[132:135], a[0:3], a[36:39]
    ds_read_b64_tr_b16 a[26:27], v38 offset:14336
    ds_read_b64_tr_b16 a[28:29], v39 offset:12288
    v_mfma_f32_16x16x32_bf16 a[44:47], v[132:135], a[4:7], a[44:47]
    ds_read_b64_tr_b16 a[30:31], v39 offset:14336
    v_mfma_f32_16x16x32_bf16 a[52:55], v[132:135], a[8:11], a[52:55]
    s_add_u32 m0, s49, 0
    s_mov_b32 s32, 1179648
    buffer_load_dwordx4 v5, s[4:7], s32 offen sc1 lds
    buffer_load_dwordx4 v4, s[4:7], s32 offen offset:1024 sc1 lds
    v_mfma_f32_16x16x32_bf16 a[60:63], v[132:135], a[12:15], a[60:63]
    s_add_u32 s33, s29, 32256
    buffer_load_dwordx4 v[120:123], v6, s[8:11], s33 offen sc1
    buffer_load_dwordx4 v[124:127], v9, s[8:11], s33 offen offset:1024 sc1
    s_waitcnt lgkmcnt(6)
    v_mfma_f32_16x16x32_bf16 a[32:35], v[136:139], a[16:19], a[32:35]
    ds_read_b64_tr_b16 a[0:1], v36 offset:16384
    s_waitcnt lgkmcnt(5)
    v_mfma_f32_16x16x32_bf16 a[40:43], v[136:139], a[20:23], a[40:43]
    ds_read_b64_tr_b16 a[2:3], v36 offset:18432
    ds_read_b64_tr_b16 a[4:5], v37 offset:16384
    s_waitcnt lgkmcnt(5)
    v_mfma_f32_16x16x32_bf16 a[48:51], v[136:139], a[24:27], a[48:51]
    ds_read_b64_tr_b16 a[6:7], v37 offset:18432
    s_waitcnt lgkmcnt(4)
    v_mfma_f32_16x16x32_bf16 a[56:59], v[136:139], a[28:31], a[56:59]
    ds_read_b64_tr_b16 a[8:9], v38 offset:16384
    ds_read_b64_tr_b16 a[10:11], v38 offset:18432
    v_mfma_f32_16x16x32_bf16 a[36:39], v[140:143], a[16:19], a[36:39]
    ds_read_b64_tr_b16 a[12:13], v39 offset:16384
    v_mfma_f32_16x16x32_bf16 a[44:47], v[140:143], a[20:23], a[44:47]
    ds_read_b64_tr_b16 a[14:15], v39 offset:18432
    s_add_u32 m0, s49, 4096
    s_mov_b32 s32, 1310720
    buffer_load_dwordx4 v5, s[4:7], s32 offen sc1 lds
    v_mfma_f32_16x16x32_bf16 a[52:55], v[140:143], a[24:27], a[52:55]
    buffer_load_dwordx4 v4, s[4:7], s32 offen offset:1024 sc1 lds
    v_mfma_f32_16x16x32_bf16 a[60:63], v[140:143], a[28:31], a[60:63]
    s_add_u32 s33, s29, 35840
    buffer_load_dwordx4 v[128:131], v6, s[8:11], s33 offen sc1
    buffer_load_dwordx4 v[132:135], v9, s[8:11], s33 offen offset:1024 sc1
    s_waitcnt lgkmcnt(6)
    v_mfma_f32_16x16x32_bf16 a[32:35], v[144:147], a[0:3], a[32:35]
    s_waitcnt vmcnt(15)
    s_barrier
    s_waitcnt lgkmcnt(4)
    v_mfma_f32_16x16x32_bf16 a[40:43], v[144:147], a[4:7], a[40:43]
    ds_read_b64_tr_b16 a[16:17], v36 offset:20480
    ds_read_b64_tr_b16 a[18:19], v36 offset:22528
    s_waitcnt lgkmcnt(4)
    v_mfma_f32_16x16x32_bf16 a[48:51], v[144:147], a[8:11], a[48:51]
    ds_read_b64_tr_b16 a[20:21], v37 offset:20480
    s_waitcnt lgkmcnt(3)
    v_mfma_f32_16x16x32_bf16 a[56:59], v[144:147], a[12:15], a[56:59]
    ds_read_b64_tr_b16 a[22:23], v37 offset:22528
    ds_read_b64_tr_b16 a[24:25], v38 offset:20480
    v_mfma_f32_16x16x32_bf16 a[36:39], v[148:151], a[0:3], a[36:39]
    ds_read_b64_tr_b16 a[26:27], v38 offset:22528
    ds_read_b64_tr_b16 a[28:29], v39 offset:20480
    v_mfma_f32_16x16x32_bf16 a[44:47], v[148:151], a[4:7], a[44:47]
    ds_read_b64_tr_b16 a[30:31], v39 offset:22528
    v_mfma_f32_16x16x32_bf16 a[52:55], v[148:151], a[8:11], a[52:55]
    s_add_u32 m0, s49, 8192
    s_mov_b32 s32, 1441792
    buffer_load_dwordx4 v5, s[4:7], s32 offen sc1 lds
    buffer_load_dwordx4 v4, s[4:7], s32 offen offset:1024 sc1 lds
    v_mfma_f32_16x16x32_bf16 a[60:63], v[148:151], a[12:15], a[60:63]
    s_add_u32 s33, s29, 39424
    buffer_load_dwordx4 v[136:139], v6, s[8:11], s33 offen sc1
    buffer_load_dwordx4 v[140:143], v9, s[8:11], s33 offen offset:1024 sc1
    s_waitcnt lgkmcnt(6)
    v_mfma_f32_16x16x32_bf16 a[32:35], v[152:155], a[16:19], a[32:35]
    ds_read_b64_tr_b16 a[0:1], v36 offset:24576
    s_waitcnt lgkmcnt(5)
    v_mfma_f32_16x16x32_bf16 a[40:43], v[152:155], a[20:23], a[40:43]
    ds_read_b64_tr_b16 a[2:3], v36 offset:26624
    ds_read_b64_tr_b16 a[4:5], v37 offset:24576
    s_waitcnt lgkmcnt(5)
    v_mfma_f32_16x16x32_bf16 a[48:51], v[152:155], a[24:27], a[48:51]
    ds_read_b64_tr_b16 a[6:7], v37 offset:26624
    s_waitcnt lgkmcnt(4)
    v_mfma_f32_16x16x32_bf16 a[56:59], v[152:155], a[28:31], a[56:59]
    ds_read_b64_tr_b16 a[8:9], v38 offset:24576
    ds_read_b64_tr_b16 a[10:11], v38 offset:26624
    v_mfma_f32_16x16x32_bf16 a[36:39], v[156:159], a[16:19], a[36:39]
    ds_read_b64_tr_b16 a[12:13], v39 offset:24576
    v_mfma_f32_16x16x32_bf16 a[44:47], v[156:159], a[20:23], a[44:47]
    ds_read_b64_tr_b16 a[14:15], v39 offset:26624
    s_add_u32 m0, s49, 12288
    s_mov_b32 s32, 1572864
    buffer_load_dwordx4 v5, s[4:7], s32 offen sc1 lds
    v_mfma_f32_16x16x32_bf16 a[52:55], v[156:159], a[24:27], a[52:55]
    buffer_load_dwordx4 v4, s[4:7], s32 offen offset:1024 sc1 lds
    v_mfma_f32_16x16x32_bf16 a[60:63], v[156:159], a[28:31], a[60:63]
    s_add_u32 s33, s29, 43008
    buffer_load_dwordx4 v[144:147], v6, s[8:11], s33 offen sc1
    buffer_load_dwordx4 v[148:151], v9, s[8:11], s33 offen offset:1024 sc1
    s_waitcnt lgkmcnt(6)
    v_mfma_f32_16x16x32_bf16 a[32:35], v[160:163], a[0:3], a[32:35]
    s_waitcnt vmcnt(16)
    s_barrier
    s_waitcnt lgkmcnt(4)
    v_mfma_f32_16x16x32_bf16 a[40:43], v[160:163], a[4:7], a[40:43]
    ds_read_b64_tr_b16 a[16:17], v36 offset:28672
    ds_read_b64_tr_b16 a[18:19], v36 offset:30720
    s_waitcnt lgkmcnt(4)
    v_mfma_f32_16x16x32_bf16 a[48:51], v[160:163], a[8:11], a[48:51]
    ds_read_b64_tr_b16 a[20:21], v37 offset:28672
    s_waitcnt lgkmcnt(3)
    v_mfma_f32_16x16x32_bf16 a[56:59], v[160:163], a[12:15], a[56:59]
    ds_read_b64_tr_b16 a[22:23], v37 offset:30720
    ds_read_b64_tr_b16 a[24:25], v38 offset:28672
    v_mfma_f32_16x16x32_bf16 a[36:39], v[164:167], a[0:3], a[36:39]
    ds_read_b64_tr_b16 a[26:27], v38 offset:30720
    ds_read_b64_tr_b16 a[28:29], v39 offset:28672
    v_mfma_f32_16x16x32_bf16 a[44:47], v[164:167], a[4:7], a[44:47]
    ds_read_b64_tr_b16 a[30:31], v39 offset:30720
    v_mfma_f32_16x16x32_bf16 a[52:55], v[164:167], a[8:11], a[52:55]
    s_add_u32 m0, s49, 16384
    s_mov_b32 s32, 1703936
    buffer_load_dwordx4 v5, s[4:7], s32 offen sc1 lds
    buffer_load_dwordx4 v4, s[4:7], s32 offen offset:1024 sc1 lds
    v_mfma_f32_16x16x32_bf16 a[60:63], v[164:167], a[12:15], a[60:63]
    s_add_u32 s33, s29, 46592
    buffer_load_dwordx4 v[152:155], v6, s[8:11], s33 offen sc1
    buffer_load_dwordx4 v[156:159], v9, s[8:11], s33 offen offset:1024 sc1
    s_waitcnt lgkmcnt(6)
    v_mfma_f32_16x16x32_bf16 a[32:35], v[168:171], a[16:19], a[32:35]
    ds_read_b64_tr_b16 a[0:1], v36 offset:32768
    s_waitcnt lgkmcnt(5)
    v_mfma_f32_16x16x32_bf16 a[40:43], v[168:171], a[20:23], a[40:43]
    ds_read_b64_tr_b16 a[2:3], v36 offset:34816
    s_waitcnt lgkmcnt(4)
    v_mfma_f32_16x16x32_bf16 a[48:51], v[168:171], a[24:27], a[48:51]
    ds_read_b64_tr_b16 a[4:5], v37 offset:32768
    s_waitcnt lgkmcnt(3)
    v_mfma_f32_16x16x32_bf16 a[56:59], v[168:171], a[28:31], a[56:59]
    ds_read_b64_tr_b16 a[6:7], v37 offset:34816
    v_mfma_f32_16x16x32_bf16 a[36:39], v[172:175], a[16:19], a[36:39]
    ds_read_b64_tr_b16 a[8:9], v38 offset:32768
    v_mfma_f32_16x16x32_bf16 a[44:47], v[172:175], a[20:23], a[44:47]
    ds_read_b64_tr_b16 a[10:11], v38 offset:34816
    v_mfma_f32_16x16x32_bf16 a[52:55], v[172:175], a[24:27], a[52:55]
    ds_read_b64_tr_b16 a[12:13], v39 offset:32768
    v_mfma_f32_16x16x32_bf16 a[60:63], v[172:175], a[28:31], a[60:63]
    ds_read_b64_tr_b16 a[14:15], v39 offset:34816
    s_waitcnt lgkmcnt(6)
    v_mfma_f32_16x16x32_bf16 a[32:35], v[112:115], a[0:3], a[32:35]
    s_waitcnt vmcnt(12)
    s_barrier
    s_waitcnt lgkmcnt(4)
    v_mfma_f32_16x16x32_bf16 a[40:43], v[112:115], a[4:7], a[40:43]
    ds_read_b64_tr_b16 a[16:17], v36 offset:0
    s_waitcnt lgkmcnt(3)
    v_mfma_f32_16x16x32_bf16 a[48:51], v[112:115], a[8:11], a[48:51]
    ds_read_b64_tr_b16 a[18:19], v36 offset:2048
    s_waitcnt lgkmcnt(2)
    v_mfma_f32_16x16x32_bf16 a[56:59], v[112:115], a[12:15], a[56:59]
    ds_read_b64_tr_b16 a[20:21], v37 offset:0
    v_mfma_f32_16x16x32_bf16 a[36:39], v[116:119], a[0:3], a[36:39]
    ds_read_b64_tr_b16 a[22:23], v37 offset:2048
    v_mfma_f32_16x16x32_bf16 a[44:47], v[116:119], a[4:7], a[44:47]
    ds_read_b64_tr_b16 a[24:25], v38 offset:0
    v_mfma_f32_16x16x32_bf16 a[52:55], v[116:119], a[8:11], a[52:55]
    ds_read_b64_tr_b16 a[26:27], v38 offset:2048
    v_mfma_f32_16x16x32_bf16 a[60:63], v[116:119], a[12:15], a[60:63]
    ds_read_b64_tr_b16 a[28:29], v39 offset:0
    ds_read_b64_tr_b16 a[30:31], v39 offset:2048
    s_waitcnt lgkmcnt(6)
    v_mfma_f32_16x16x32_bf16 a[32:35], v[120:123], a[16:19], a[32:35]
    ds_read_b64_tr_b16 a[0:1], v36 offset:4096
    s_waitcnt lgkmcnt(5)
    v_mfma_f32_16x16x32_bf16 a[40:43], v[120:123], a[20:23], a[40:43]
    ds_read_b64_tr_b16 a[2:3], v36 offset:6144
    s_waitcnt lgkmcnt(4)
    v_mfma_f32_16x16x32_bf16 a[48:51], v[120:123], a[24:27], a[48:51]
    ds_read_b64_tr_b16 a[4:5], v37 offset:4096
    s_waitcnt lgkmcnt(3)
    v_mfma_f32_16x16x32_bf16 a[56:59], v[120:123], a[28:31], a[56:59]
    ds_read_b64_tr_b16 a[6:7], v37 offset:6144
    v_mfma_f32_16x16x32_bf16 a[36:39], v[124:127], a[16:19], a[36:39]
    ds_read_b64_tr_b16 a[8:9], v38 offset:4096
    v_mfma_f32_16x16x32_bf16 a[44:47], v[124:127], a[20:23], a[44:47]
    ds_read_b64_tr_b16 a[10:11], v38 offset:6144
    v_mfma_f32_16x16x32_bf16 a[52:55], v[124:127], a[24:27], a[52:55]
    ds_read_b64_tr_b16 a[12:13], v39 offset:4096
    v_mfma_f32_16x16x32_bf16 a[60:63], v[124:127], a[28:31], a[60:63]
    ds_read_b64_tr_b16 a[14:15], v39 offset:6144
    s_waitcnt lgkmcnt(6)
    v_mfma_f32_16x16x32_bf16 a[32:35], v[128:131], a[0:3], a[32:35]
    s_waitcnt vmcnt(4)
    s_barrier
    s_waitcnt lgkmcnt(4)
    v_mfma_f32_16x16x32_bf16 a[40:43], v[128:131], a[4:7], a[40:43]
    ds_read_b64_tr_b16 a[16:17], v36 offset:8192
    s_waitcnt lgkmcnt(3)
    v_mfma_f32_16x16x32_bf16 a[48:51], v[128:131], a[8:11], a[48:51]
    ds_read_b64_tr_b16 a[18:19], v36 offset:10240
    s_waitcnt lgkmcnt(2)
    v_mfma_f32_16x16x32_bf16 a[56:59], v[128:131], a[12:15], a[56:59]
    ds_read_b64_tr_b16 a[20:21], v37 offset:8192
    v_mfma_f32_16x16x32_bf16 a[36:39], v[132:135], a[0:3], a[36:39]
    ds_read_b64_tr_b16 a[22:23], v37 offset:10240
    v_mfma_f32_16x16x32_bf16 a[44:47], v[132:135], a[4:7], a[44:47]
    ds_read_b64_tr_b16 a[24:25], v38 offset:8192
    v_mfma_f32_16x16x32_bf16 a[52:55], v[132:135], a[8:11], a[52:55]
    ds_read_b64_tr_b16 a[26:27], v38 offset:10240
    v_mfma_f32_16x16x32_bf16 a[60:63], v[132:135], a[12:15], a[60:63]
    ds_read_b64_tr_b16 a[28:29], v39 offset:8192
    ds_read_b64_tr_b16 a[30:31], v39 offset:10240
    s_waitcnt lgkmcnt(6)
    v_mfma_f32_16x16x32_bf16 a[32:35], v[136:139], a[16:19], a[32:35]
    ds_read_b64_tr_b16 a[0:1], v36 offset:12288
    s_waitcnt lgkmcnt(5)
    v_mfma_f32_16x16x32_bf16 a[40:43], v[136:139], a[20:23], a[40:43]
    ds_read_b64_tr_b16 a[2:3], v36 offset:14336
    s_waitcnt lgkmcnt(4)
    v_mfma_f32_16x16x32_bf16 a[48:51], v[136:139], a[24:27], a[48:51]
    ds_read_b64_tr_b16 a[4:5], v37 offset:12288
    s_waitcnt lgkmcnt(3)
    v_mfma_f32_16x16x32_bf16 a[56:59], v[136:139], a[28:31], a[56:59]
    ds_read_b64_tr_b16 a[6:7], v37 offset:14336
    v_mfma_f32_16x16x32_bf16 a[36:39], v[140:143], a[16:19], a[36:39]
    ds_read_b64_tr_b16 a[8:9], v38 offset:12288
    v_mfma_f32_16x16x32_bf16 a[44:47], v[140:143], a[20:23], a[44:47]
    ds_read_b64_tr_b16 a[10:11], v38 offset:14336
    v_mfma_f32_16x16x32_bf16 a[52:55], v[140:143], a[24:27], a[52:55]
    ds_read_b64_tr_b16 a[12:13], v39 offset:12288
    v_mfma_f32_16x16x32_bf16 a[60:63], v[140:143], a[28:31], a[60:63]
    ds_read_b64_tr_b16 a[14:15], v39 offset:14336
    s_waitcnt lgkmcnt(6)
    v_mfma_f32_16x16x32_bf16 a[32:35], v[144:147], a[0:3], a[32:35]
    s_waitcnt vmcnt(0)
    s_barrier
    s_waitcnt lgkmcnt(4)
    v_mfma_f32_16x16x32_bf16 a[40:43], v[144:147], a[4:7], a[40:43]
    ds_read_b64_tr_b16 a[16:17], v36 offset:16384
    s_waitcnt lgkmcnt(3)
    v_mfma_f32_16x16x32_bf16 a[48:51], v[144:147], a[8:11], a[48:51]
    ds_read_b64_tr_b16 a[18:19], v36 offset:18432
    s_waitcnt lgkmcnt(2)
    v_mfma_f32_16x16x32_bf16 a[56:59], v[144:147], a[12:15], a[56:59]
    ds_read_b64_tr_b16 a[20:21], v37 offset:16384
    v_mfma_f32_16x16x32_bf16 a[36:39], v[148:151], a[0:3], a[36:39]
    ds_read_b64_tr_b16 a[22:23], v37 offset:18432
    v_mfma_f32_16x16x32_bf16 a[44:47], v[148:151], a[4:7], a[44:47]
    ds_read_b64_tr_b16 a[24:25], v38 offset:16384
    v_mfma_f32_16x16x32_bf16 a[52:55], v[148:151], a[8:11], a[52:55]
    ds_read_b64_tr_b16 a[26:27], v38 offset:18432
    v_mfma_f32_16x16x32_bf16 a[60:63], v[148:151], a[12:15], a[60:63]
    ds_read_b64_tr_b16 a[28:29], v39 offset:16384
    ds_read_b64_tr_b16 a[30:31], v39 offset:18432
    s_waitcnt lgkmcnt(6)
    v_mfma_f32_16x16x32_bf16 a[32:35], v[152:155], a[16:19], a[32:35]
    s_waitcnt lgkmcnt(4)
    v_mfma_f32_16x16x32_bf16 a[40:43], v[152:155], a[20:23], a[40:43]
    s_waitcnt lgkmcnt(2)
    v_mfma_f32_16x16x32_bf16 a[48:51], v[152:155], a[24:27], a[48:51]
    s_waitcnt lgkmcnt(0)
    v_mfma_f32_16x16x32_bf16 a[56:59], v[152:155], a[28:31], a[56:59]
    v_mfma_f32_16x16x32_bf16 a[36:39], v[156:159], a[16:19], a[36:39]
    v_mfma_f32_16x16x32_bf16 a[44:47], v[156:159], a[20:23], a[44:47]
    v_mfma_f32_16x16x32_bf16 a[52:55], v[156:159], a[24:27], a[52:55]
    v_mfma_f32_16x16x32_bf16 a[60:63], v[156:159], a[28:31], a[60:63]
    v_lshlrev_b32 v34, 4, v1
    s_lshl_b32 s35, s48, 13
    s_add_u32 s34, s31, s35
    s_add_u32 s34, s34, 20480
    v_add_u32 v33, s34, v34
    ds_write_b128 v33, a[32:35] offset:0
    ds_write_b128 v33, a[36:39] offset:1024
    ds_write_b128 v33, a[40:43] offset:2048
    ds_write_b128 v33, a[44:47] offset:3072
    ds_write_b128 v33, a[48:51] offset:4096
    ds_write_b128 v33, a[52:55] offset:5120
    ds_write_b128 v33, a[56:59] offset:6144
    ds_write_b128 v33, a[60:63] offset:7168
    s_waitcnt lgkmcnt(0)
    s_barrier
    s_lshl_b32 s34, s47, 11
    s_add_u32 s34, s34, s35
    s_add_u32 s34, s34, 20480
    v_add_u32 v33, s34, v34
    v_add_u32 v35, 73728, v33
    ds_read_b128 v[40:43], v33 offset:0
    ds_read_b128 v[48:51], v33 offset:36864
    ds_read_b128 v[56:59], v35 offset:0
    ds_read_b128 v[64:67], v35 offset:36864
    ds_read_b128 v[44:47], v33 offset:1024
    ds_read_b128 v[52:55], v33 offset:37888
    ds_read_b128 v[60:63], v35 offset:1024
    ds_read_b128 v[68:71], v35 offset:37888
    s_waitcnt lgkmcnt(6)
    v_add_f32 v40, v40, v48
    s_waitcnt lgkmcnt(4)
    v_add_f32 v56, v56, v64
    v_add_f32 v41, v41, v49
    v_add_f32 v57, v57, v65
    v_add_f32 v42, v42, v50
    v_add_f32 v58, v58, v66
    v_add_f32 v43, v43, v51
    v_add_f32 v59, v59, v67
    v_add_f32 v40, v40, v56
    v_add_f32 v41, v41, v57
    v_add_f32 v42, v42, v58
    v_add_f32 v43, v43, v59
    s_waitcnt lgkmcnt(2)
    v_add_f32 v44, v44, v52
    s_waitcnt lgkmcnt(0)
    v_add_f32 v60, v60, v68
    v_add_f32 v45, v45, v53
    v_add_f32 v61, v61, v69
    v_add_f32 v46, v46, v54
    v_add_f32 v62, v62, v70
    v_add_f32 v47, v47, v55
    v_add_f32 v63, v63, v71
    v_add_f32 v44, v44, v60
    v_add_f32 v45, v45, v61
    v_add_f32 v46, v46, v62
    v_add_f32 v47, v47, v63
    v_and_b32 v33, 15, v1
    v_lshlrev_b32 v76, 16, v104
    v_lshlrev_b32 v77, 16, v100
    v_and_b32 v78, 0xffff0000, v100
    v_add_f32 v40, v40, v76
    v_add_f32 v41, v41, v76
    v_add_f32 v40, v40, v77
    v_add_f32 v41, v41, v78
    v_cvt_pk_bf16_f32 v88, v40, v41
    v_lshlrev_b32 v77, 16, v101
    v_and_b32 v78, 0xffff0000, v101
    v_add_f32 v42, v42, v76
    v_add_f32 v43, v43, v76
    v_add_f32 v42, v42, v77
    v_add_f32 v43, v43, v78
    v_cvt_pk_bf16_f32 v89, v42, v43
    v_lshlrev_b32 v77, 16, v102
    v_and_b32 v78, 0xffff0000, v102
    v_add_f32 v44, v44, v76
    v_add_f32 v45, v45, v76
    v_add_f32 v44, v44, v77
    v_add_f32 v45, v45, v78
    v_cvt_pk_bf16_f32 v90, v44, v45
    v_lshlrev_b32 v77, 16, v103
    v_and_b32 v78, 0xffff0000, v103
    v_add_f32 v46, v46, v76
    v_add_f32 v47, v47, v76
    v_add_f32 v46, v46, v77
    v_add_f32 v47, v47, v78
    v_cvt_pk_bf16_f32 v91, v46, v47
    s_lshl_b32 s40, s22, 11
    s_add_u32 s40, s40, 147456
    v_mul_u32_u24 v36, 80, v33
    v_lshl_add_u32 v36, v7, 3, v36
    v_add_u32 v36, s40, v36
    ds_write_b64 v36, v[88:89] offset:0
    ds_write_b64 v36, v[90:91] offset:32
    v_lshrrev_b32 v37, 2, v1
    v_and_b32 v38, 3, v1
    v_mul_u32_u24 v39, 80, v37
    v_lshl_add_u32 v39, v38, 4, v39
    v_add_u32 v39, s40, v39
    ds_read_b128 v[92:95], v39
    s_lshl_b32 s39, s36, 4
    s_mul_i32 s39, s39, 896
    s_mul_i32 s41, s24, 112
    s_add_u32 s39, s39, s41
    s_lshl_b32 s41, s48, 6
    s_add_u32 s39, s39, s41
    v_mul_u32_u24 v37, 896, v37
    v_lshl_add_u32 v37, v38, 4, v37
    s_cmp_eq_u32 s48, 0
    s_cselect_b32 s44, -1, 0x77777777
    s_mov_b32 s45, s44
    s_mov_b64 exec, s[44:45]
    s_waitcnt lgkmcnt(0)
    buffer_store_dwordx4 v[92:95], v37, s[16:19], s39 offen sc0 sc1
    s_mov_b64 exec, -1
    s_nop 1
L_interleave_layers__sliding_block__mixer_token_mlp__prompt_kernel_end:
    s_endpgm
.section .rodata,"a"

.p2align 6
.amdhsa_kernel interleave_layers__sliding_block__mixer_token_mlp__prompt_kernel
  .amdhsa_next_free_vgpr 256
  .amdhsa_next_free_sgpr 102
  .amdhsa_accum_offset 176
  .amdhsa_group_segment_fixed_size 0
  .amdhsa_kernarg_size 88
  .amdhsa_user_sgpr_count 2
  .amdhsa_user_sgpr_kernarg_segment_ptr 1
  .amdhsa_system_sgpr_workgroup_id_x 1
.end_amdhsa_kernel
```
